```python
import torch

def _softmax(x, axis=-1):
    return torch.softmax(x, dim=axis)
def _gelu(x):
    return torch.nn.functional.gelu(x, approximate="tanh")
def _silu(x):
    return torch.nn.functional.silu(x)
def _sigmoid(x):
    return torch.sigmoid(x)
def _layernorm(x, axis=-1, eps=1e-5):
    m = x.mean(dim=axis, keepdim=True)
    v = x.var(dim=axis, keepdim=True, unbiased=False)
    return (x - m) / torch.sqrt(v + eps)
def _scatter_add(tgt, idx, src, axis=0):
    return tgt.clone().index_add_(axis, idx, src)
def _segment_sum(src, seg, n):
    out = torch.zeros((n,) + src.shape[1:], dtype=src.dtype)
    return out.index_add_(0, seg, src)
def _pad(x, pw):
    flat = tuple(v for pair in reversed(pw) for v in pair)
    return torch.nn.functional.pad(x, flat)

kernel_name = 'standalone__gqa_block_cached__near_ridge'

def setup_inputs():

    _w = (lambda a: (lambda t: t.to(torch.bfloat16) if t.is_floating_point() else t)(torch.as_tensor(a)))
    B, Sq, D = 8, 144, 448
    Hq, Hkv, Sk, Dh = 16, 8, 1024, 256
    assert Hq % Hkv == 0, (Hq, Hkv)
    return {
        "x": _w((lambda *s: torch.randn(*s, dtype=torch.bfloat16) * 0.8)(B, Sq, D)),
        "k_cache": _w((lambda *s: torch.randn(*s, dtype=torch.bfloat16) * 0.8)(B, Hkv, Sk, Dh)),
        "v_cache": _w((lambda *s: torch.randn(*s, dtype=torch.bfloat16) * 0.05)(B, Hkv, Sk, Dh)),
        "wq": _w((lambda *s: torch.randn(*s, dtype=torch.bfloat16) * 0.8)(D, Hq * Dh) * (D ** -0.5)),
        "wo": _w((lambda *s: torch.randn(*s, dtype=torch.bfloat16) * 0.05)(Hq * Dh, D) * ((Hq * Dh) ** -0.5)),
    }

def reference(x, k_cache, v_cache, wq, wo):
    B, Sq, D = x.shape
    Hq, Dh = 16, 256
    Hkv = k_cache.shape[1]
    rep = Hq // Hkv
    q = (lambda x, *d: x.permute(*d))((x @ wq).reshape(B, Sq, Hq, Dh), 0, 2, 1, 3)
    k = (lambda x, n, axis: torch.repeat_interleave(x, n, dim=axis))(k_cache, rep, axis=1)
    v = (lambda x, n, axis: torch.repeat_interleave(x, n, dim=axis))(v_cache, rep, axis=1)
    scores = torch.einsum("bhqd,bhkd->bhqk", q, k) * (Dh ** -0.5)
    p = _softmax(scores, axis=-1)
    o = torch.einsum("bhqk,bhkd->bhqd", p, v)
    return (lambda x, *d: x.permute(*d))(o, 0, 2, 1, 3).reshape(B, Sq, Hq * Dh) @ wo
```

```asm
; @launch kernel=gqa_attn_kernel grid=(256,1,1) block=(512,1,1) lds=163840
; @launch kernel=gqa_reduce_kernel grid=(252,1,1) block=(256,1,1) lds=0
.amdgcn_target "amdgcn-amd-amdhsa--gfx950"
.text
.globl gqa_attn_kernel
.p2align 8
.type gqa_attn_kernel,@function
gqa_attn_kernel:
  s_cmp_ge_u32 s2, 256
  s_cbranch_scc1 L_END
  s_load_dwordx16 s[52:67], s[0:1], 0
  s_mov_b32 s46, 0
  v_and_b32 v1, 63, v0
  v_lshrrev_b32 v4, 6, v0
  v_lshrrev_b32 v2, 4, v1
  v_and_b32 v3, 15, v1
  v_readfirstlane_b32 s70, v4
  s_nop 2
  s_and_b32 s28, s70, 3
  s_and_b32 s33, s2, 7
  s_lshr_b32 s34, s2, 3
  s_lshr_b32 s31, s34, 2
  s_and_b32 s29, s34, 3
  s_lshr_b32 s35, s29, 1
  s_lshl_b32 s30, s33, 1
  s_add_u32 s30, s30, s35
  s_and_b32 s35, s29, 1
  s_mul_i32 s44, s31, 144
  s_mul_i32 s34, s35, 72
  s_add_u32 s44, s44, s34
  s_mul_i32 s34, s44, 896
  s_waitcnt lgkmcnt(0)
  s_add_u32 s4, s52, s34
  s_addc_u32 s5, s53, 0
  s_mov_b32 s6, 64512
  s_mov_b32 s7, 0x00020000
  s_mul_i32 s34, s30, 512
  s_add_u32 s8, s58, s34
  s_addc_u32 s9, s59, 0
  s_mov_b32 s10, 0
  s_mov_b32 s11, 0x00020000
  s_sub_u32 s10, 3670016, s34
  s_lshl_b32 s34, s31, 3
  s_add_u32 s34, s34, s33
  s_lshl_b32 s34, s34, 19
  s_add_u32 s12, s54, s34
  s_addc_u32 s13, s55, 0
  s_mov_b32 s14, 524288
  s_mov_b32 s15, 0x00020000
  s_add_u32 s16, s56, s34
  s_addc_u32 s17, s57, 0
  s_mov_b32 s18, 524288
  s_mov_b32 s19, 0x00020000
  s_mul_i32 s34, s30, 229376
  s_add_u32 s20, s60, s34
  s_addc_u32 s21, s61, 0
  s_mov_b32 s22, 229376
  s_mov_b32 s23, 0x00020000
  s_mul_i32 s34, s30, 1152
  s_add_u32 s34, s34, s44
  s_mul_i32 s34, s34, 896
  s_add_u32 s24, s66, s34
  s_addc_u32 s25, s67, 0
  s_mov_b32 s26, 64512
  s_mov_b32 s27, 0x00020000
  s_mov_b32 s48, 0x41000000
  s_mov_b32 s49, 0x3db8aa3b
  s_mov_b32 s47, 0
  s_cmp_ge_u32 s70, 4
  s_cbranch_scc1 L_ROLE_P
  s_mul_i32 s32, s70, 10240
  s_add_u32 s32, s32, 73728
  v_lshrrev_b32 v4, 2, v1
  v_lshrrev_b32 v5, 5, v1
  v_lshlrev_b32 v5, 1, v5
  v_and_b32 v6, 3, v1
  v_xor_b32 v5, v5, v6
  v_lshlrev_b32 v5, 4, v5
  v_lshlrev_b32 v4, 13, v4
  v_add_u32 v84, v4, v5
  s_lshl_b32 s34, s70, 6
  v_add_u32 v84, s34, v84
  s_add_u32 m0, s32, 0
  s_mov_b32 s35, 0
  buffer_load_dwordx4 v84, s[8:11], s35 offen lds
  s_add_u32 m0, s32, 1024
  s_mov_b32 s35, 131072
  buffer_load_dwordx4 v84, s[8:11], s35 offen lds
  s_mul_i32 s33, s70, 9
  s_add_u32 s34, s33, 0
  s_and_b32 s35, s34, 15
  v_xor_b32 v4, s35, v1
  v_lshlrev_b32 v4, 4, v4
  s_lshl_b32 m0, s34, 10
  s_mul_i32 s35, s34, 896
  buffer_load_dwordx4 v4, s[4:7], s35 offen lds
  s_add_u32 s34, s33, 1
  s_and_b32 s35, s34, 15
  v_xor_b32 v5, s35, v1
  v_lshlrev_b32 v5, 4, v5
  s_lshl_b32 m0, s34, 10
  s_mul_i32 s35, s34, 896
  buffer_load_dwordx4 v5, s[4:7], s35 offen lds
  s_add_u32 s34, s33, 2
  s_and_b32 s35, s34, 15
  v_xor_b32 v6, s35, v1
  v_lshlrev_b32 v6, 4, v6
  s_lshl_b32 m0, s34, 10
  s_mul_i32 s35, s34, 896
  buffer_load_dwordx4 v6, s[4:7], s35 offen lds
  s_add_u32 s34, s33, 3
  s_and_b32 s35, s34, 15
  v_xor_b32 v7, s35, v1
  v_lshlrev_b32 v7, 4, v7
  s_lshl_b32 m0, s34, 10
  s_mul_i32 s35, s34, 896
  buffer_load_dwordx4 v7, s[4:7], s35 offen lds
  s_add_u32 s34, s33, 4
  s_and_b32 s35, s34, 15
  v_xor_b32 v4, s35, v1
  v_lshlrev_b32 v4, 4, v4
  s_lshl_b32 m0, s34, 10
  s_mul_i32 s35, s34, 896
  buffer_load_dwordx4 v4, s[4:7], s35 offen lds
  s_add_u32 s34, s33, 5
  s_and_b32 s35, s34, 15
  v_xor_b32 v5, s35, v1
  v_lshlrev_b32 v5, 4, v5
  s_lshl_b32 m0, s34, 10
  s_mul_i32 s35, s34, 896
  buffer_load_dwordx4 v5, s[4:7], s35 offen lds
  s_add_u32 s34, s33, 6
  s_and_b32 s35, s34, 15
  v_xor_b32 v6, s35, v1
  v_lshlrev_b32 v6, 4, v6
  s_lshl_b32 m0, s34, 10
  s_mul_i32 s35, s34, 896
  buffer_load_dwordx4 v6, s[4:7], s35 offen lds
  s_add_u32 s34, s33, 7
  s_and_b32 s35, s34, 15
  v_xor_b32 v7, s35, v1
  v_lshlrev_b32 v7, 4, v7
  s_lshl_b32 m0, s34, 10
  s_mul_i32 s35, s34, 896
  buffer_load_dwordx4 v7, s[4:7], s35 offen lds
  s_add_u32 s34, s33, 8
  s_and_b32 s35, s34, 15
  v_xor_b32 v4, s35, v1
  v_lshlrev_b32 v4, 4, v4
  s_lshl_b32 m0, s34, 10
  s_mul_i32 s35, s34, 896
  buffer_load_dwordx4 v4, s[4:7], s35 offen lds
  s_add_u32 m0, s32, 2048
  s_mov_b32 s35, 262144
  buffer_load_dwordx4 v84, s[8:11], s35 offen lds
  s_add_u32 m0, s32, 3072
  s_mov_b32 s35, 393216
  buffer_load_dwordx4 v84, s[8:11], s35 offen lds
  s_add_u32 m0, s32, 4096
  s_mov_b32 s35, 524288
  buffer_load_dwordx4 v84, s[8:11], s35 offen lds
  s_add_u32 m0, s32, 5120
  s_mov_b32 s35, 655360
  buffer_load_dwordx4 v84, s[8:11], s35 offen lds
  s_add_u32 m0, s32, 6144
  s_mov_b32 s35, 786432
  buffer_load_dwordx4 v84, s[8:11], s35 offen lds
  s_add_u32 m0, s32, 7168
  s_mov_b32 s35, 917504
  buffer_load_dwordx4 v84, s[8:11], s35 offen lds
  s_add_u32 m0, s32, 8192
  s_mov_b32 s35, 1048576
  buffer_load_dwordx4 v84, s[8:11], s35 offen lds
  s_add_u32 m0, s32, 9216
  s_mov_b32 s35, 1179648
  buffer_load_dwordx4 v84, s[8:11], s35 offen lds
  v_lshrrev_b32 v4, 2, v3
  v_and_b32 v5, 3, v3
  v_lshlrev_b32 v6, 9, v2
  v_lshl_add_u32 v6, v4, 6, v6
  v_lshl_add_u32 v6, v5, 3, v6
  v_and_b32 v7, 1, v2
  v_lshl_add_u32 v6, v7, 5, v6
  v_add_u32 v80, s32, v6
  v_xor_b32 v81, 32, v80
  v_xor_b32 v4, v2, v3
  v_lshlrev_b32 v4, 4, v4
  v_lshl_add_u32 v72, v3, 10, v4
  v_xor_b32 v73, 64, v72
  v_xor_b32 v74, 128, v72
  v_xor_b32 v75, 192, v72
  v_min_u32 v5, 7, v3
  v_xor_b32 v4, v2, v5
  v_lshlrev_b32 v4, 4, v4
  v_lshl_add_u32 v76, v5, 10, v4
  v_add_u32 v76, 65536, v76
  v_xor_b32 v77, 64, v76
  v_xor_b32 v78, 128, v76
  v_xor_b32 v79, 192, v76
  s_waitcnt vmcnt(8)
  s_nop 0
  s_barrier
  ds_read_b64_tr_b16 a[0:1], v80
  ds_read_b64_tr_b16 a[2:3], v80 offset:256
  ds_read_b64_tr_b16 a[4:5], v81
  ds_read_b64_tr_b16 a[6:7], v81 offset:256
  ds_read_b128 a[16:19], v72
  ds_read_b128 a[20:23], v72 offset:16384
  ds_read_b128 a[24:27], v72 offset:32768
  ds_read_b128 a[28:31], v72 offset:49152
  ds_read_b128 a[32:35], v76
  s_waitcnt lgkmcnt(4)
  v_mfma_f32_16x16x32_bf16 v[16:19], a[0:3], a[16:19], 0
  s_waitcnt vmcnt(6)
  ds_read_b64_tr_b16 a[8:9], v80 offset:2048
  ds_read_b64_tr_b16 a[10:11], v80 offset:2304
  v_mfma_f32_16x16x32_bf16 v[36:39], a[4:7], a[16:19], 0
  ds_read_b64_tr_b16 a[12:13], v81 offset:2048
  ds_read_b64_tr_b16 a[14:15], v81 offset:2304
  s_waitcnt lgkmcnt(7)
  v_mfma_f32_16x16x32_bf16 v[20:23], a[0:3], a[20:23], 0
  s_add_u32 m0, s32, 0
  s_mov_b32 s35, 1310720
  buffer_load_dwordx4 v84, s[8:11], s35 offen lds
  v_mfma_f32_16x16x32_bf16 v[40:43], a[4:7], a[20:23], 0
  ds_read_b128 a[36:39], v73
  ds_read_b128 a[40:43], v73 offset:16384
  s_waitcnt lgkmcnt(8)
  v_mfma_f32_16x16x32_bf16 v[24:27], a[0:3], a[24:27], 0
  ds_read_b128 a[44:47], v73 offset:32768
  ds_read_b128 a[48:51], v73 offset:49152
  v_mfma_f32_16x16x32_bf16 v[44:47], a[4:7], a[24:27], 0
  s_add_u32 m0, s32, 1024
  s_mov_b32 s35, 1441792
  buffer_load_dwordx4 v84, s[8:11], s35 offen lds
  s_waitcnt lgkmcnt(9)
  v_mfma_f32_16x16x32_bf16 v[28:31], a[0:3], a[28:31], 0
  ds_read_b128 a[52:55], v77
  v_mfma_f32_16x16x32_bf16 v[48:51], a[4:7], a[28:31], 0
  s_waitcnt lgkmcnt(9)
  v_mfma_f32_16x16x32_bf16 v[32:35], a[0:3], a[32:35], 0
  v_mfma_f32_16x16x32_bf16 v[52:55], a[4:7], a[32:35], 0
  s_waitcnt lgkmcnt(4)
  v_mfma_f32_16x16x32_bf16 v[16:19], a[8:11], a[36:39], v[16:19]
  s_waitcnt vmcnt(6)
  ds_read_b64_tr_b16 a[0:1], v80 offset:4096
  ds_read_b64_tr_b16 a[2:3], v80 offset:4352
  v_mfma_f32_16x16x32_bf16 v[36:39], a[12:15], a[36:39], v[36:39]
  ds_read_b64_tr_b16 a[4:5], v81 offset:4096
  ds_read_b64_tr_b16 a[6:7], v81 offset:4352
  s_waitcnt lgkmcnt(7)
  v_mfma_f32_16x16x32_bf16 v[20:23], a[8:11], a[40:43], v[20:23]
  s_add_u32 m0, s32, 2048
  s_mov_b32 s35, 1572864
  buffer_load_dwordx4 v84, s[8:11], s35 offen lds
  v_mfma_f32_16x16x32_bf16 v[40:43], a[12:15], a[40:43], v[40:43]
  ds_read_b128 a[16:19], v74
  ds_read_b128 a[20:23], v74 offset:16384
  s_waitcnt lgkmcnt(8)
  v_mfma_f32_16x16x32_bf16 v[24:27], a[8:11], a[44:47], v[24:27]
  ds_read_b128 a[24:27], v74 offset:32768
  ds_read_b128 a[28:31], v74 offset:49152
  v_mfma_f32_16x16x32_bf16 v[44:47], a[12:15], a[44:47], v[44:47]
  s_add_u32 m0, s32, 3072
  s_mov_b32 s35, 1703936
  buffer_load_dwordx4 v84, s[8:11], s35 offen lds
  s_waitcnt lgkmcnt(9)
  v_mfma_f32_16x16x32_bf16 v[28:31], a[8:11], a[48:51], v[28:31]
  ds_read_b128 a[32:35], v78
  v_mfma_f32_16x16x32_bf16 v[48:51], a[12:15], a[48:51], v[48:51]
  s_waitcnt lgkmcnt(9)
  v_mfma_f32_16x16x32_bf16 v[32:35], a[8:11], a[52:55], v[32:35]
  v_mfma_f32_16x16x32_bf16 v[52:55], a[12:15], a[52:55], v[52:55]
  s_waitcnt lgkmcnt(4)
  v_mfma_f32_16x16x32_bf16 v[16:19], a[0:3], a[16:19], v[16:19]
  s_waitcnt vmcnt(6)
  ds_read_b64_tr_b16 a[8:9], v80 offset:6144
  ds_read_b64_tr_b16 a[10:11], v80 offset:6400
  v_mfma_f32_16x16x32_bf16 v[36:39], a[4:7], a[16:19], v[36:39]
  ds_read_b64_tr_b16 a[12:13], v81 offset:6144
  ds_read_b64_tr_b16 a[14:15], v81 offset:6400
  s_waitcnt lgkmcnt(7)
  v_mfma_f32_16x16x32_bf16 v[20:23], a[0:3], a[20:23], v[20:23]
  s_add_u32 m0, s32, 4096
  s_mov_b32 s35, 1835008
  buffer_load_dwordx4 v84, s[8:11], s35 offen lds
  v_mfma_f32_16x16x32_bf16 v[40:43], a[4:7], a[20:23], v[40:43]
  ds_read_b128 a[36:39], v75
  ds_read_b128 a[40:43], v75 offset:16384
  s_waitcnt lgkmcnt(8)
  v_mfma_f32_16x16x32_bf16 v[24:27], a[0:3], a[24:27], v[24:27]
  ds_read_b128 a[44:47], v75 offset:32768
  ds_read_b128 a[48:51], v75 offset:49152
  v_mfma_f32_16x16x32_bf16 v[44:47], a[4:7], a[24:27], v[44:47]
  s_add_u32 m0, s32, 5120
  s_mov_b32 s35, 1966080
  buffer_load_dwordx4 v84, s[8:11], s35 offen lds
  s_waitcnt lgkmcnt(9)
  v_mfma_f32_16x16x32_bf16 v[28:31], a[0:3], a[28:31], v[28:31]
  ds_read_b128 a[52:55], v79
  v_mfma_f32_16x16x32_bf16 v[48:51], a[4:7], a[28:31], v[48:51]
  s_waitcnt lgkmcnt(9)
  v_mfma_f32_16x16x32_bf16 v[32:35], a[0:3], a[32:35], v[32:35]
  v_mfma_f32_16x16x32_bf16 v[52:55], a[4:7], a[32:35], v[52:55]
  s_waitcnt lgkmcnt(4)
  v_mfma_f32_16x16x32_bf16 v[16:19], a[8:11], a[36:39], v[16:19]
  s_waitcnt vmcnt(6)
  ds_read_b64_tr_b16 a[0:1], v80 offset:8192
  ds_read_b64_tr_b16 a[2:3], v80 offset:8448
  v_mfma_f32_16x16x32_bf16 v[36:39], a[12:15], a[36:39], v[36:39]
  ds_read_b64_tr_b16 a[4:5], v81 offset:8192
  ds_read_b64_tr_b16 a[6:7], v81 offset:8448
  s_waitcnt lgkmcnt(7)
  v_mfma_f32_16x16x32_bf16 v[20:23], a[8:11], a[40:43], v[20:23]
  s_add_u32 m0, s32, 6144
  s_mov_b32 s35, 2097152
  buffer_load_dwordx4 v84, s[8:11], s35 offen lds
  v_mfma_f32_16x16x32_bf16 v[40:43], a[12:15], a[40:43], v[40:43]
  ds_read_b128 a[16:19], v72 offset:256
  ds_read_b128 a[20:23], v72 offset:16640
  s_waitcnt lgkmcnt(8)
  v_mfma_f32_16x16x32_bf16 v[24:27], a[8:11], a[44:47], v[24:27]
  ds_read_b128 a[24:27], v72 offset:33024
  ds_read_b128 a[28:31], v72 offset:49408
  v_mfma_f32_16x16x32_bf16 v[44:47], a[12:15], a[44:47], v[44:47]
  s_add_u32 m0, s32, 7168
  s_mov_b32 s35, 2228224
  buffer_load_dwordx4 v84, s[8:11], s35 offen lds
  s_waitcnt lgkmcnt(9)
  v_mfma_f32_16x16x32_bf16 v[28:31], a[8:11], a[48:51], v[28:31]
  ds_read_b128 a[32:35], v76 offset:256
  v_mfma_f32_16x16x32_bf16 v[48:51], a[12:15], a[48:51], v[48:51]
  s_waitcnt lgkmcnt(9)
  v_mfma_f32_16x16x32_bf16 v[32:35], a[8:11], a[52:55], v[32:35]
  v_mfma_f32_16x16x32_bf16 v[52:55], a[12:15], a[52:55], v[52:55]
  s_waitcnt lgkmcnt(4)
  v_mfma_f32_16x16x32_bf16 v[16:19], a[0:3], a[16:19], v[16:19]
  s_waitcnt vmcnt(6)
  ds_read_b64_tr_b16 a[8:9], v80
  ds_read_b64_tr_b16 a[10:11], v80 offset:256
  v_mfma_f32_16x16x32_bf16 v[36:39], a[4:7], a[16:19], v[36:39]
  ds_read_b64_tr_b16 a[12:13], v81
  ds_read_b64_tr_b16 a[14:15], v81 offset:256
  s_waitcnt lgkmcnt(7)
  v_mfma_f32_16x16x32_bf16 v[20:23], a[0:3], a[20:23], v[20:23]
  s_add_u32 m0, s32, 8192
  s_mov_b32 s35, 2359296
  buffer_load_dwordx4 v84, s[8:11], s35 offen lds
  v_mfma_f32_16x16x32_bf16 v[40:43], a[4:7], a[20:23], v[40:43]
  ds_read_b128 a[36:39], v73 offset:256
  ds_read_b128 a[40:43], v73 offset:16640
  s_waitcnt lgkmcnt(8)
  v_mfma_f32_16x16x32_bf16 v[24:27], a[0:3], a[24:27], v[24:27]
  ds_read_b128 a[44:47], v73 offset:33024
  ds_read_b128 a[48:51], v73 offset:49408
  v_mfma_f32_16x16x32_bf16 v[44:47], a[4:7], a[24:27], v[44:47]
  s_add_u32 m0, s32, 9216
  s_mov_b32 s35, 2490368
  buffer_load_dwordx4 v84, s[8:11], s35 offen lds
  s_waitcnt lgkmcnt(9)
  v_mfma_f32_16x16x32_bf16 v[28:31], a[0:3], a[28:31], v[28:31]
  ds_read_b128 a[52:55], v77 offset:256
  v_mfma_f32_16x16x32_bf16 v[48:51], a[4:7], a[28:31], v[48:51]
  s_waitcnt lgkmcnt(9)
  v_mfma_f32_16x16x32_bf16 v[32:35], a[0:3], a[32:35], v[32:35]
  v_mfma_f32_16x16x32_bf16 v[52:55], a[4:7], a[32:35], v[52:55]
  s_waitcnt lgkmcnt(4)
  v_mfma_f32_16x16x32_bf16 v[16:19], a[8:11], a[36:39], v[16:19]
  s_waitcnt vmcnt(6)
  ds_read_b64_tr_b16 a[0:1], v80 offset:2048
  ds_read_b64_tr_b16 a[2:3], v80 offset:2304
  v_mfma_f32_16x16x32_bf16 v[36:39], a[12:15], a[36:39], v[36:39]
  ds_read_b64_tr_b16 a[4:5], v81 offset:2048
  ds_read_b64_tr_b16 a[6:7], v81 offset:2304
  s_waitcnt lgkmcnt(7)
  v_mfma_f32_16x16x32_bf16 v[20:23], a[8:11], a[40:43], v[20:23]
  s_add_u32 m0, s32, 0
  s_mov_b32 s35, 2621440
  buffer_load_dwordx4 v84, s[8:11], s35 offen lds
  v_mfma_f32_16x16x32_bf16 v[40:43], a[12:15], a[40:43], v[40:43]
  ds_read_b128 a[16:19], v74 offset:256
  ds_read_b128 a[20:23], v74 offset:16640
  s_waitcnt lgkmcnt(8)
  v_mfma_f32_16x16x32_bf16 v[24:27], a[8:11], a[44:47], v[24:27]
  ds_read_b128 a[24:27], v74 offset:33024
  ds_read_b128 a[28:31], v74 offset:49408
  v_mfma_f32_16x16x32_bf16 v[44:47], a[12:15], a[44:47], v[44:47]
  s_add_u32 m0, s32, 1024
  s_mov_b32 s35, 2752512
  buffer_load_dwordx4 v84, s[8:11], s35 offen lds
  s_waitcnt lgkmcnt(9)
  v_mfma_f32_16x16x32_bf16 v[28:31], a[8:11], a[48:51], v[28:31]
  ds_read_b128 a[32:35], v78 offset:256
  v_mfma_f32_16x16x32_bf16 v[48:51], a[12:15], a[48:51], v[48:51]
  s_waitcnt lgkmcnt(9)
  v_mfma_f32_16x16x32_bf16 v[32:35], a[8:11], a[52:55], v[32:35]
  v_mfma_f32_16x16x32_bf16 v[52:55], a[12:15], a[52:55], v[52:55]
  s_waitcnt lgkmcnt(4)
  v_mfma_f32_16x16x32_bf16 v[16:19], a[0:3], a[16:19], v[16:19]
  s_waitcnt vmcnt(6)
  ds_read_b64_tr_b16 a[8:9], v80 offset:4096
  ds_read_b64_tr_b16 a[10:11], v80 offset:4352
  v_mfma_f32_16x16x32_bf16 v[36:39], a[4:7], a[16:19], v[36:39]
  ds_read_b64_tr_b16 a[12:13], v81 offset:4096
  ds_read_b64_tr_b16 a[14:15], v81 offset:4352
  s_waitcnt lgkmcnt(7)
  v_mfma_f32_16x16x32_bf16 v[20:23], a[0:3], a[20:23], v[20:23]
  s_add_u32 m0, s32, 2048
  s_mov_b32 s35, 2883584
  buffer_load_dwordx4 v84, s[8:11], s35 offen lds
  v_mfma_f32_16x16x32_bf16 v[40:43], a[4:7], a[20:23], v[40:43]
  ds_read_b128 a[36:39], v75 offset:256
  ds_read_b128 a[40:43], v75 offset:16640
  s_waitcnt lgkmcnt(8)
  v_mfma_f32_16x16x32_bf16 v[24:27], a[0:3], a[24:27], v[24:27]
  ds_read_b128 a[44:47], v75 offset:33024
  ds_read_b128 a[48:51], v75 offset:49408
  v_mfma_f32_16x16x32_bf16 v[44:47], a[4:7], a[24:27], v[44:47]
  s_add_u32 m0, s32, 3072
  s_mov_b32 s35, 3014656
  buffer_load_dwordx4 v84, s[8:11], s35 offen lds
  s_waitcnt lgkmcnt(9)
  v_mfma_f32_16x16x32_bf16 v[28:31], a[0:3], a[28:31], v[28:31]
  ds_read_b128 a[52:55], v79 offset:256
  v_mfma_f32_16x16x32_bf16 v[48:51], a[4:7], a[28:31], v[48:51]
  s_waitcnt lgkmcnt(9)
  v_mfma_f32_16x16x32_bf16 v[32:35], a[0:3], a[32:35], v[32:35]
  v_mfma_f32_16x16x32_bf16 v[52:55], a[4:7], a[32:35], v[52:55]
  s_waitcnt lgkmcnt(4)
  v_mfma_f32_16x16x32_bf16 v[16:19], a[8:11], a[36:39], v[16:19]
  s_waitcnt vmcnt(6)
  ds_read_b64_tr_b16 a[0:1], v80 offset:6144
  ds_read_b64_tr_b16 a[2:3], v80 offset:6400
  v_mfma_f32_16x16x32_bf16 v[36:39], a[12:15], a[36:39], v[36:39]
  ds_read_b64_tr_b16 a[4:5], v81 offset:6144
  ds_read_b64_tr_b16 a[6:7], v81 offset:6400
  s_waitcnt lgkmcnt(7)
  v_mfma_f32_16x16x32_bf16 v[20:23], a[8:11], a[40:43], v[20:23]
  s_add_u32 m0, s32, 4096
  s_mov_b32 s35, 3145728
  buffer_load_dwordx4 v84, s[8:11], s35 offen lds
  v_mfma_f32_16x16x32_bf16 v[40:43], a[12:15], a[40:43], v[40:43]
  ds_read_b128 a[16:19], v72 offset:512
  ds_read_b128 a[20:23], v72 offset:16896
  s_waitcnt lgkmcnt(8)
  v_mfma_f32_16x16x32_bf16 v[24:27], a[8:11], a[44:47], v[24:27]
  ds_read_b128 a[24:27], v72 offset:33280
  ds_read_b128 a[28:31], v72 offset:49664
  v_mfma_f32_16x16x32_bf16 v[44:47], a[12:15], a[44:47], v[44:47]
  s_add_u32 m0, s32, 5120
  s_mov_b32 s35, 3276800
  buffer_load_dwordx4 v84, s[8:11], s35 offen lds
  s_waitcnt lgkmcnt(9)
  v_mfma_f32_16x16x32_bf16 v[28:31], a[8:11], a[48:51], v[28:31]
  ds_read_b128 a[32:35], v76 offset:512
  v_mfma_f32_16x16x32_bf16 v[48:51], a[12:15], a[48:51], v[48:51]
  s_waitcnt lgkmcnt(9)
  v_mfma_f32_16x16x32_bf16 v[32:35], a[8:11], a[52:55], v[32:35]
  v_mfma_f32_16x16x32_bf16 v[52:55], a[12:15], a[52:55], v[52:55]
  s_waitcnt lgkmcnt(4)
  v_mfma_f32_16x16x32_bf16 v[16:19], a[0:3], a[16:19], v[16:19]
  s_waitcnt vmcnt(6)
  ds_read_b64_tr_b16 a[8:9], v80 offset:8192
  ds_read_b64_tr_b16 a[10:11], v80 offset:8448
  v_mfma_f32_16x16x32_bf16 v[36:39], a[4:7], a[16:19], v[36:39]
  ds_read_b64_tr_b16 a[12:13], v81 offset:8192
  ds_read_b64_tr_b16 a[14:15], v81 offset:8448
  s_waitcnt lgkmcnt(7)
  v_mfma_f32_16x16x32_bf16 v[20:23], a[0:3], a[20:23], v[20:23]
  s_add_u32 m0, s32, 6144
  s_mov_b32 s35, 3407872
  buffer_load_dwordx4 v84, s[8:11], s35 offen lds
  v_mfma_f32_16x16x32_bf16 v[40:43], a[4:7], a[20:23], v[40:43]
  ds_read_b128 a[36:39], v73 offset:512
  ds_read_b128 a[40:43], v73 offset:16896
  s_waitcnt lgkmcnt(8)
  v_mfma_f32_16x16x32_bf16 v[24:27], a[0:3], a[24:27], v[24:27]
  ds_read_b128 a[44:47], v73 offset:33280
  ds_read_b128 a[48:51], v73 offset:49664
  v_mfma_f32_16x16x32_bf16 v[44:47], a[4:7], a[24:27], v[44:47]
  s_add_u32 m0, s32, 7168
  s_mov_b32 s35, 3538944
  buffer_load_dwordx4 v84, s[8:11], s35 offen lds
  s_waitcnt lgkmcnt(9)
  v_mfma_f32_16x16x32_bf16 v[28:31], a[0:3], a[28:31], v[28:31]
  ds_read_b128 a[52:55], v77 offset:512
  v_mfma_f32_16x16x32_bf16 v[48:51], a[4:7], a[28:31], v[48:51]
  s_waitcnt lgkmcnt(9)
  v_mfma_f32_16x16x32_bf16 v[32:35], a[0:3], a[32:35], v[32:35]
  v_mfma_f32_16x16x32_bf16 v[52:55], a[4:7], a[32:35], v[52:55]
  s_waitcnt lgkmcnt(4)
  v_mfma_f32_16x16x32_bf16 v[16:19], a[8:11], a[36:39], v[16:19]
  s_waitcnt vmcnt(6)
  ds_read_b64_tr_b16 a[0:1], v80
  ds_read_b64_tr_b16 a[2:3], v80 offset:256
  v_mfma_f32_16x16x32_bf16 v[36:39], a[12:15], a[36:39], v[36:39]
  ds_read_b64_tr_b16 a[4:5], v81
  ds_read_b64_tr_b16 a[6:7], v81 offset:256
  s_waitcnt lgkmcnt(7)
  v_mfma_f32_16x16x32_bf16 v[20:23], a[8:11], a[40:43], v[20:23]
  ds_read_b128 a[16:19], v74 offset:512
  ds_read_b128 a[20:23], v74 offset:16896
  v_mfma_f32_16x16x32_bf16 v[40:43], a[12:15], a[40:43], v[40:43]
  ds_read_b128 a[24:27], v74 offset:33280
  ds_read_b128 a[28:31], v74 offset:49664
  s_waitcnt lgkmcnt(10)
  v_mfma_f32_16x16x32_bf16 v[24:27], a[8:11], a[44:47], v[24:27]
  ds_read_b128 a[32:35], v78 offset:512
  v_mfma_f32_16x16x32_bf16 v[44:47], a[12:15], a[44:47], v[44:47]
  s_waitcnt lgkmcnt(10)
  v_mfma_f32_16x16x32_bf16 v[28:31], a[8:11], a[48:51], v[28:31]
  v_mfma_f32_16x16x32_bf16 v[48:51], a[12:15], a[48:51], v[48:51]
  s_waitcnt lgkmcnt(9)
  v_mfma_f32_16x16x32_bf16 v[32:35], a[8:11], a[52:55], v[32:35]
  v_mfma_f32_16x16x32_bf16 v[52:55], a[12:15], a[52:55], v[52:55]
  s_waitcnt lgkmcnt(4)
  v_mfma_f32_16x16x32_bf16 v[16:19], a[0:3], a[16:19], v[16:19]
  s_waitcnt vmcnt(4)
  ds_read_b64_tr_b16 a[8:9], v80 offset:2048
  ds_read_b64_tr_b16 a[10:11], v80 offset:2304
  v_mfma_f32_16x16x32_bf16 v[36:39], a[4:7], a[16:19], v[36:39]
  ds_read_b64_tr_b16 a[12:13], v81 offset:2048
  ds_read_b64_tr_b16 a[14:15], v81 offset:2304
  s_waitcnt lgkmcnt(7)
  v_mfma_f32_16x16x32_bf16 v[20:23], a[0:3], a[20:23], v[20:23]
  ds_read_b128 a[36:39], v75 offset:512
  ds_read_b128 a[40:43], v75 offset:16896
  v_mfma_f32_16x16x32_bf16 v[40:43], a[4:7], a[20:23], v[40:43]
  ds_read_b128 a[44:47], v75 offset:33280
  ds_read_b128 a[48:51], v75 offset:49664
  s_waitcnt lgkmcnt(10)
  v_mfma_f32_16x16x32_bf16 v[24:27], a[0:3], a[24:27], v[24:27]
  ds_read_b128 a[52:55], v79 offset:512
  v_mfma_f32_16x16x32_bf16 v[44:47], a[4:7], a[24:27], v[44:47]
  s_waitcnt lgkmcnt(10)
  v_mfma_f32_16x16x32_bf16 v[28:31], a[0:3], a[28:31], v[28:31]
  v_mfma_f32_16x16x32_bf16 v[48:51], a[4:7], a[28:31], v[48:51]
  s_waitcnt lgkmcnt(9)
  v_mfma_f32_16x16x32_bf16 v[32:35], a[0:3], a[32:35], v[32:35]
  v_mfma_f32_16x16x32_bf16 v[52:55], a[4:7], a[32:35], v[52:55]
  s_waitcnt lgkmcnt(4)
  v_mfma_f32_16x16x32_bf16 v[16:19], a[8:11], a[36:39], v[16:19]
  s_waitcnt vmcnt(2)
  ds_read_b64_tr_b16 a[0:1], v80 offset:4096
  ds_read_b64_tr_b16 a[2:3], v80 offset:4352
  v_mfma_f32_16x16x32_bf16 v[36:39], a[12:15], a[36:39], v[36:39]
  ds_read_b64_tr_b16 a[4:5], v81 offset:4096
  ds_read_b64_tr_b16 a[6:7], v81 offset:4352
  s_waitcnt lgkmcnt(7)
  v_mfma_f32_16x16x32_bf16 v[20:23], a[8:11], a[40:43], v[20:23]
  ds_read_b128 a[16:19], v72 offset:768
  ds_read_b128 a[20:23], v72 offset:17152
  v_mfma_f32_16x16x32_bf16 v[40:43], a[12:15], a[40:43], v[40:43]
  ds_read_b128 a[24:27], v72 offset:33536
  ds_read_b128 a[28:31], v72 offset:49920
  s_waitcnt lgkmcnt(10)
  v_mfma_f32_16x16x32_bf16 v[24:27], a[8:11], a[44:47], v[24:27]
  ds_read_b128 a[32:35], v76 offset:768
  v_mfma_f32_16x16x32_bf16 v[44:47], a[12:15], a[44:47], v[44:47]
  s_waitcnt lgkmcnt(10)
  v_mfma_f32_16x16x32_bf16 v[28:31], a[8:11], a[48:51], v[28:31]
  v_mfma_f32_16x16x32_bf16 v[48:51], a[12:15], a[48:51], v[48:51]
  s_waitcnt lgkmcnt(9)
  v_mfma_f32_16x16x32_bf16 v[32:35], a[8:11], a[52:55], v[32:35]
  v_mfma_f32_16x16x32_bf16 v[52:55], a[12:15], a[52:55], v[52:55]
  s_waitcnt lgkmcnt(4)
  v_mfma_f32_16x16x32_bf16 v[16:19], a[0:3], a[16:19], v[16:19]
  s_waitcnt vmcnt(0)
  ds_read_b64_tr_b16 a[8:9], v80 offset:6144
  ds_read_b64_tr_b16 a[10:11], v80 offset:6400
  v_mfma_f32_16x16x32_bf16 v[36:39], a[4:7], a[16:19], v[36:39]
  ds_read_b64_tr_b16 a[12:13], v81 offset:6144
  ds_read_b64_tr_b16 a[14:15], v81 offset:6400
  s_waitcnt lgkmcnt(7)
  v_mfma_f32_16x16x32_bf16 v[20:23], a[0:3], a[20:23], v[20:23]
  ds_read_b128 a[36:39], v73 offset:768
  ds_read_b128 a[40:43], v73 offset:17152
  v_mfma_f32_16x16x32_bf16 v[40:43], a[4:7], a[20:23], v[40:43]
  ds_read_b128 a[44:47], v73 offset:33536
  ds_read_b128 a[48:51], v73 offset:49920
  s_waitcnt lgkmcnt(10)
  v_mfma_f32_16x16x32_bf16 v[24:27], a[0:3], a[24:27], v[24:27]
  ds_read_b128 a[52:55], v77 offset:768
  v_mfma_f32_16x16x32_bf16 v[44:47], a[4:7], a[24:27], v[44:47]
  s_waitcnt lgkmcnt(10)
  v_mfma_f32_16x16x32_bf16 v[28:31], a[0:3], a[28:31], v[28:31]
  v_mfma_f32_16x16x32_bf16 v[48:51], a[4:7], a[28:31], v[48:51]
  s_waitcnt lgkmcnt(9)
  v_mfma_f32_16x16x32_bf16 v[32:35], a[0:3], a[32:35], v[32:35]
  v_mfma_f32_16x16x32_bf16 v[52:55], a[4:7], a[32:35], v[52:55]
  s_waitcnt lgkmcnt(4)
  v_mfma_f32_16x16x32_bf16 v[16:19], a[8:11], a[36:39], v[16:19]
  v_mfma_f32_16x16x32_bf16 v[36:39], a[12:15], a[36:39], v[36:39]
  s_waitcnt lgkmcnt(3)
  v_mfma_f32_16x16x32_bf16 v[20:23], a[8:11], a[40:43], v[20:23]
  v_mfma_f32_16x16x32_bf16 v[40:43], a[12:15], a[40:43], v[40:43]
  s_waitcnt lgkmcnt(2)
  v_mfma_f32_16x16x32_bf16 v[24:27], a[8:11], a[44:47], v[24:27]
  v_mfma_f32_16x16x32_bf16 v[44:47], a[12:15], a[44:47], v[44:47]
  s_waitcnt lgkmcnt(1)
  v_mfma_f32_16x16x32_bf16 v[28:31], a[8:11], a[48:51], v[28:31]
  v_mfma_f32_16x16x32_bf16 v[48:51], a[12:15], a[48:51], v[48:51]
  s_waitcnt lgkmcnt(0)
  v_mfma_f32_16x16x32_bf16 v[32:35], a[8:11], a[52:55], v[32:35]
  v_mfma_f32_16x16x32_bf16 v[52:55], a[12:15], a[52:55], v[52:55]
  s_waitcnt lgkmcnt(0)
  s_barrier
  s_lshl_b32 s32, s28, 14
  s_add_u32 s32, s32, 24576
  s_lshl_b32 s50, s28, 14
  v_lshrrev_b32 v4, 2, v1
  v_lshrrev_b32 v5, 4, v1
  v_and_b32 v6, 3, v1
  v_xor_b32 v5, v5, v6
  v_lshlrev_b32 v5, 4, v5
  v_lshl_add_u32 v8, v4, 9, v5
  s_add_u32 m0, s32, 0
  s_nop 0
  buffer_load_dwordx4 v8, s[12:15], s50 offen lds
  s_add_u32 m0, s32, 960
  s_nop 0
  buffer_load_dwordx4 v8, s[12:15], s50 offen offset:64 lds
  s_add_u32 m0, s32, 1920
  s_nop 0
  buffer_load_dwordx4 v8, s[12:15], s50 offen offset:128 lds
  s_add_u32 m0, s32, 2880
  s_nop 0
  buffer_load_dwordx4 v8, s[12:15], s50 offen offset:192 lds
  s_add_u32 m0, s32, 3840
  s_nop 0
  buffer_load_dwordx4 v8, s[12:15], s50 offen offset:256 lds
  s_add_u32 m0, s32, 4800
  s_nop 0
  buffer_load_dwordx4 v8, s[12:15], s50 offen offset:320 lds
  s_add_u32 m0, s32, 5760
  s_nop 0
  buffer_load_dwordx4 v8, s[12:15], s50 offen offset:384 lds
  s_add_u32 m0, s32, 6720
  s_nop 0
  buffer_load_dwordx4 v8, s[12:15], s50 offen offset:448 lds
  s_add_u32 s50, s50, 8192
  s_add_u32 m0, s32, 8192
  s_nop 0
  buffer_load_dwordx4 v8, s[12:15], s50 offen lds
  s_add_u32 m0, s32, 9152
  s_nop 0
  buffer_load_dwordx4 v8, s[12:15], s50 offen offset:64 lds
  s_add_u32 m0, s32, 10112
  s_nop 0
  buffer_load_dwordx4 v8, s[12:15], s50 offen offset:128 lds
  s_add_u32 m0, s32, 11072
  s_nop 0
  buffer_load_dwordx4 v8, s[12:15], s50 offen offset:192 lds
  s_add_u32 m0, s32, 12032
  s_nop 0
  buffer_load_dwordx4 v8, s[12:15], s50 offen offset:256 lds
  s_add_u32 m0, s32, 12992
  s_nop 0
  buffer_load_dwordx4 v8, s[12:15], s50 offen offset:320 lds
  s_add_u32 m0, s32, 13952
  s_nop 0
  buffer_load_dwordx4 v8, s[12:15], s50 offen offset:384 lds
  s_add_u32 m0, s32, 14912
  s_nop 0
  buffer_load_dwordx4 v8, s[12:15], s50 offen offset:448 lds
  s_add_u32 s50, s50, 57344
  v_lshrrev_b32 v4, 1, v2
  s_lshl_b32 s34, s70, 2
  v_add_u32 v4, s34, v4
  v_xor_b32 v4, v4, v3
  v_lshlrev_b32 v4, 4, v4
  v_lshl_add_u32 v4, v3, 9, v4
  v_and_b32 v5, 1, v2
  v_lshl_add_u32 v4, v5, 3, v4
  v_add_u32 v72, 90112, v4
  v_xor_b32 v73, 32, v72
  v_mul_f32 v16, s49, v16
  v_mul_f32 v17, s49, v17
  v_mul_f32 v18, s49, v18
  v_mul_f32 v19, s49, v19
  v_cvt_pk_bf16_f32 v16, v16, v17
  v_cvt_pk_bf16_f32 v17, v18, v19
  ds_write_b64 v72, v[16:17]
  v_mul_f32 v36, s49, v36
  v_mul_f32 v37, s49, v37
  v_mul_f32 v38, s49, v38
  v_mul_f32 v39, s49, v39
  v_cvt_pk_bf16_f32 v36, v36, v37
  v_cvt_pk_bf16_f32 v37, v38, v39
  ds_write_b64 v73, v[36:37]
  v_mul_f32 v20, s49, v20
  v_mul_f32 v21, s49, v21
  v_mul_f32 v22, s49, v22
  v_mul_f32 v23, s49, v23
  v_cvt_pk_bf16_f32 v20, v20, v21
  v_cvt_pk_bf16_f32 v21, v22, v23
  ds_write_b64 v72, v[20:21] offset:8192
  v_mul_f32 v40, s49, v40
  v_mul_f32 v41, s49, v41
  v_mul_f32 v42, s49, v42
  v_mul_f32 v43, s49, v43
  v_cvt_pk_bf16_f32 v40, v40, v41
  v_cvt_pk_bf16_f32 v41, v42, v43
  ds_write_b64 v73, v[40:41] offset:8192
  v_mul_f32 v24, s49, v24
  v_mul_f32 v25, s49, v25
  v_mul_f32 v26, s49, v26
  v_mul_f32 v27, s49, v27
  v_cvt_pk_bf16_f32 v24, v24, v25
  v_cvt_pk_bf16_f32 v25, v26, v27
  ds_write_b64 v72, v[24:25] offset:16384
  v_mul_f32 v44, s49, v44
  v_mul_f32 v45, s49, v45
  v_mul_f32 v46, s49, v46
  v_mul_f32 v47, s49, v47
  v_cvt_pk_bf16_f32 v44, v44, v45
  v_cvt_pk_bf16_f32 v45, v46, v47
  ds_write_b64 v73, v[44:45] offset:16384
  v_mul_f32 v28, s49, v28
  v_mul_f32 v29, s49, v29
  v_mul_f32 v30, s49, v30
  v_mul_f32 v31, s49, v31
  v_cvt_pk_bf16_f32 v28, v28, v29
  v_cvt_pk_bf16_f32 v29, v30, v31
  ds_write_b64 v72, v[28:29] offset:24576
  v_mul_f32 v48, s49, v48
  v_mul_f32 v49, s49, v49
  v_mul_f32 v50, s49, v50
  v_mul_f32 v51, s49, v51
  v_cvt_pk_bf16_f32 v48, v48, v49
  v_cvt_pk_bf16_f32 v49, v50, v51
  ds_write_b64 v73, v[48:49] offset:24576
  v_mul_f32 v32, s49, v32
  v_mul_f32 v33, s49, v33
  v_mul_f32 v34, s49, v34
  v_mul_f32 v35, s49, v35
  v_cvt_pk_bf16_f32 v32, v32, v33
  v_cvt_pk_bf16_f32 v33, v34, v35
  ds_write_b64 v72, v[32:33] offset:32768
  v_mul_f32 v52, s49, v52
  v_mul_f32 v53, s49, v53
  v_mul_f32 v54, s49, v54
  v_mul_f32 v55, s49, v55
  v_cvt_pk_bf16_f32 v52, v52, v53
  v_cvt_pk_bf16_f32 v53, v54, v55
  ds_write_b64 v73, v[52:53] offset:32768
  s_waitcnt lgkmcnt(0)
  s_barrier
  v_xor_b32 v4, v2, v3
  v_lshlrev_b32 v4, 4, v4
  v_lshl_add_u32 v4, v3, 9, v4
  v_add_u32 v72, 90112, v4
  v_xor_b32 v4, 0, v72
  ds_read_b128 a[0:3], v4
  ds_read_b128 a[32:35], v4 offset:8192
  ds_read_b128 a[64:67], v4 offset:16384
  ds_read_b128 a[96:99], v4 offset:24576
  ds_read_b128 a[128:131], v4 offset:32768
  v_xor_b32 v5, 64, v72
  ds_read_b128 a[4:7], v5
  ds_read_b128 a[36:39], v5 offset:8192
  ds_read_b128 a[68:71], v5 offset:16384
  ds_read_b128 a[100:103], v5 offset:24576
  ds_read_b128 a[132:135], v5 offset:32768
  v_xor_b32 v6, 128, v72
  ds_read_b128 a[8:11], v6
  ds_read_b128 a[40:43], v6 offset:8192
  ds_read_b128 a[72:75], v6 offset:16384
  ds_read_b128 a[104:107], v6 offset:24576
  ds_read_b128 a[136:139], v6 offset:32768
  v_xor_b32 v7, 192, v72
  ds_read_b128 a[12:15], v7
  ds_read_b128 a[44:47], v7 offset:8192
  ds_read_b128 a[76:79], v7 offset:16384
  ds_read_b128 a[108:111], v7 offset:24576
  ds_read_b128 a[140:143], v7 offset:32768
  v_xor_b32 v4, 256, v72
  ds_read_b128 a[16:19], v4
  ds_read_b128 a[48:51], v4 offset:8192
  ds_read_b128 a[80:83], v4 offset:16384
  ds_read_b128 a[112:115], v4 offset:24576
  ds_read_b128 a[144:147], v4 offset:32768
  v_xor_b32 v5, 320, v72
  ds_read_b128 a[20:23], v5
  ds_read_b128 a[52:55], v5 offset:8192
  ds_read_b128 a[84:87], v5 offset:16384
  ds_read_b128 a[116:119], v5 offset:24576
  ds_read_b128 a[148:151], v5 offset:32768
  v_xor_b32 v6, 384, v72
  ds_read_b128 a[24:27], v6
  ds_read_b128 a[56:59], v6 offset:8192
  ds_read_b128 a[88:91], v6 offset:16384
  ds_read_b128 a[120:123], v6 offset:24576
  ds_read_b128 a[152:155], v6 offset:32768
  v_xor_b32 v7, 448, v72
  ds_read_b128 a[28:31], v7
  ds_read_b128 a[60:63], v7 offset:8192
  ds_read_b128 a[92:95], v7 offset:16384
  ds_read_b128 a[124:127], v7 offset:24576
  ds_read_b128 a[156:159], v7 offset:32768
  v_lshrrev_b32 v4, 2, v3
  v_xor_b32 v4, v4, v2
  v_lshlrev_b32 v4, 4, v4
  v_lshl_add_u32 v4, v3, 6, v4
  v_add_u32 v9, s32, v4
  s_lshr_b32 s34, s28, 1
  s_lshl_b32 s34, s34, 2
  v_add_u32 v4, s34, v2
  v_lshrrev_b32 v5, 1, v3
  v_xor_b32 v4, v4, v5
  v_lshlrev_b32 v4, 4, v4
  v_lshl_add_u32 v4, v3, 7, v4
  s_and_b32 s34, s28, 1
  s_lshl_b32 s34, s34, 3
  v_add_u32 v10, s34, v4
  s_lshl_b32 s34, s28, 2
  v_lshlrev_b32 v4, 4, v1
  v_add_u32 v11, s34, v4
  v_and_b32 v13, 0xff, v11
  v_lshlrev_b32 v12, 4, v3
  s_setprio 1
  s_waitcnt lgkmcnt(0)
  s_barrier
  s_waitcnt vmcnt(15)
  ds_read_b128 v[16:19], v9
  s_waitcnt vmcnt(14)
  ds_read_b128 v[20:23], v9 offset:1024
  s_waitcnt vmcnt(13)
  ds_read_b128 v[24:27], v9 offset:2048
  s_waitcnt lgkmcnt(2)
  v_mfma_f32_16x16x32_bf16 v[32:35], v[16:19], a[0:3], 0
  v_mfma_f32_16x16x32_bf16 v[36:39], v[16:19], a[32:35], 0
  s_add_u32 m0, s32, 0
  s_nop 0
  buffer_load_dwordx4 v8, s[12:15], s50 offen lds
  v_mfma_f32_16x16x32_bf16 v[40:43], v[16:19], a[64:67], 0
  v_mfma_f32_16x16x32_bf16 v[44:47], v[16:19], a[96:99], 0
  v_mfma_f32_16x16x32_bf16 v[48:51], v[16:19], a[128:131], 0
  s_waitcnt vmcnt(13)
  ds_read_b128 v[28:31], v9 offset:3072
  s_waitcnt lgkmcnt(2)
  v_mfma_f32_16x16x32_bf16 v[32:35], v[20:23], a[4:7], v[32:35]
  v_mfma_f32_16x16x32_bf16 v[36:39], v[20:23], a[36:39], v[36:39]
  s_add_u32 m0, s32, 960
  s_nop 0
  buffer_load_dwordx4 v8, s[12:15], s50 offen offset:64 lds
  v_mfma_f32_16x16x32_bf16 v[40:43], v[20:23], a[68:71], v[40:43]
  v_mfma_f32_16x16x32_bf16 v[44:47], v[20:23], a[100:103], v[44:47]
  v_mfma_f32_16x16x32_bf16 v[48:51], v[20:23], a[132:135], v[48:51]
  s_waitcnt vmcnt(13)
  ds_read_b128 v[16:19], v9 offset:4096
  s_waitcnt lgkmcnt(2)
  v_mfma_f32_16x16x32_bf16 v[32:35], v[24:27], a[8:11], v[32:35]
  v_mfma_f32_16x16x32_bf16 v[36:39], v[24:27], a[40:43], v[36:39]
  s_add_u32 m0, s32, 1920
  s_nop 0
  buffer_load_dwordx4 v8, s[12:15], s50 offen offset:128 lds
  v_mfma_f32_16x16x32_bf16 v[40:43], v[24:27], a[72:75], v[40:43]
  v_mfma_f32_16x16x32_bf16 v[44:47], v[24:27], a[104:107], v[44:47]
  v_mfma_f32_16x16x32_bf16 v[48:51], v[24:27], a[136:139], v[48:51]
  s_waitcnt vmcnt(13)
  ds_read_b128 v[20:23], v9 offset:5120
  s_waitcnt lgkmcnt(2)
  v_mfma_f32_16x16x32_bf16 v[32:35], v[28:31], a[12:15], v[32:35]
  v_mfma_f32_16x16x32_bf16 v[36:39], v[28:31], a[44:47], v[36:39]
  s_add_u32 m0, s32, 2880
  s_nop 0
  buffer_load_dwordx4 v8, s[12:15], s50 offen offset:192 lds
  v_mfma_f32_16x16x32_bf16 v[40:43], v[28:31], a[76:79], v[40:43]
  v_mfma_f32_16x16x32_bf16 v[44:47], v[28:31], a[108:111], v[44:47]
  v_mfma_f32_16x16x32_bf16 v[48:51], v[28:31], a[140:143], v[48:51]
  s_waitcnt vmcnt(13)
  ds_read_b128 v[24:27], v9 offset:6144
  s_waitcnt lgkmcnt(2)
  v_mfma_f32_16x16x32_bf16 v[32:35], v[16:19], a[16:19], v[32:35]
  v_mfma_f32_16x16x32_bf16 v[36:39], v[16:19], a[48:51], v[36:39]
  s_add_u32 m0, s32, 3840
  s_nop 0
  buffer_load_dwordx4 v8, s[12:15], s50 offen offset:256 lds
  v_mfma_f32_16x16x32_bf16 v[40:43], v[16:19], a[80:83], v[40:43]
  v_mfma_f32_16x16x32_bf16 v[44:47], v[16:19], a[112:115], v[44:47]
  v_mfma_f32_16x16x32_bf16 v[48:51], v[16:19], a[144:147], v[48:51]
  s_waitcnt vmcnt(13)
  ds_read_b128 v[28:31], v9 offset:7168
  s_waitcnt lgkmcnt(2)
  v_mfma_f32_16x16x32_bf16 v[32:35], v[20:23], a[20:23], v[32:35]
  v_mfma_f32_16x16x32_bf16 v[36:39], v[20:23], a[52:55], v[36:39]
  s_add_u32 m0, s32, 4800
  s_nop 0
  buffer_load_dwordx4 v8, s[12:15], s50 offen offset:320 lds
  v_mfma_f32_16x16x32_bf16 v[40:43], v[20:23], a[84:87], v[40:43]
  v_mfma_f32_16x16x32_bf16 v[44:47], v[20:23], a[116:119], v[44:47]
  v_mfma_f32_16x16x32_bf16 v[48:51], v[20:23], a[148:151], v[48:51]
  s_waitcnt vmcnt(13)
  ds_read_b128 v[16:19], v9 offset:8192
  s_waitcnt lgkmcnt(2)
  v_mfma_f32_16x16x32_bf16 v[32:35], v[24:27], a[24:27], v[32:35]
  v_mfma_f32_16x16x32_bf16 v[36:39], v[24:27], a[56:59], v[36:39]
  s_add_u32 m0, s32, 5760
  s_nop 0
  buffer_load_dwordx4 v8, s[12:15], s50 offen offset:384 lds
  v_mfma_f32_16x16x32_bf16 v[40:43], v[24:27], a[88:91], v[40:43]
  v_mfma_f32_16x16x32_bf16 v[44:47], v[24:27], a[120:123], v[44:47]
  v_mfma_f32_16x16x32_bf16 v[48:51], v[24:27], a[152:155], v[48:51]
  s_waitcnt vmcnt(13)
  ds_read_b128 v[20:23], v9 offset:9216
  s_waitcnt lgkmcnt(2)
  v_mfma_f32_16x16x32_bf16 v[32:35], v[28:31], a[28:31], v[32:35]
  v_mfma_f32_16x16x32_bf16 v[36:39], v[28:31], a[60:63], v[36:39]
  s_add_u32 m0, s32, 6720
  s_nop 0
  buffer_load_dwordx4 v8, s[12:15], s50 offen offset:448 lds
  s_add_u32 s50, s50, 8192
  v_mfma_f32_16x16x32_bf16 v[40:43], v[28:31], a[92:95], v[40:43]
  v_mfma_f32_16x16x32_bf16 v[44:47], v[28:31], a[124:127], v[44:47]
  v_mfma_f32_16x16x32_bf16 v[48:51], v[28:31], a[156:159], v[48:51]
  s_waitcnt vmcnt(13)
  ds_read_b128 v[24:27], v9 offset:10240
  v_max3_f32 v82, v32, v33, v34
  v_max3_f32 v83, v36, v37, v38
  s_nop 1
  v_max3_f32 v84, v40, v41, v42
  v_max3_f32 v85, v44, v45, v46
  v_max3_f32 v86, v48, v49, v50
  v_max_f32 v82, v82, v35
  v_max_f32 v83, v83, v39
  v_max_f32 v84, v84, v43
  v_max_f32 v85, v85, v47
  v_max_f32 v86, v86, v51
  v_mov_b32 v87, v86
  v_permlane16_swap_b32 v82, v83
  v_permlane16_swap_b32 v84, v85
  v_permlane16_swap_b32 v86, v87
  v_max_f32 v82, v82, v83
  v_max_f32 v84, v84, v85
  v_max_f32 v86, v86, v87
  v_mov_b32 v87, v86
  v_permlane32_swap_b32 v82, v84
  s_nop 0
  v_permlane32_swap_b32 v86, v87
  v_max_f32 v82, v82, v84
  v_max_f32 v86, v86, v87
  ds_write_b32 v11, v82 offset:20480
  ds_write_b32 v13, v86 offset:21504
  s_waitcnt lgkmcnt(0)
  s_barrier
  s_setprio 2
  v_mfma_f32_16x16x32_bf16 v[52:55], v[16:19], a[0:3], 0
  v_mfma_f32_16x16x32_bf16 v[56:59], v[16:19], a[32:35], 0
  s_add_u32 m0, s32, 8192
  s_nop 0
  buffer_load_dwordx4 v8, s[12:15], s50 offen lds
  v_mfma_f32_16x16x32_bf16 v[60:63], v[16:19], a[64:67], 0
  v_mfma_f32_16x16x32_bf16 v[64:67], v[16:19], a[96:99], 0
  v_mfma_f32_16x16x32_bf16 v[68:71], v[16:19], a[128:131], 0
  s_waitcnt vmcnt(13)
  ds_read_b128 v[28:31], v9 offset:11264
  v_mfma_f32_16x16x32_bf16 v[52:55], v[20:23], a[4:7], v[52:55]
  v_mfma_f32_16x16x32_bf16 v[56:59], v[20:23], a[36:39], v[56:59]
  s_add_u32 m0, s32, 9152
  s_nop 0
  buffer_load_dwordx4 v8, s[12:15], s50 offen offset:64 lds
  ds_read_b128 v[72:75], v12 offset:20480
  ds_read_b128 v[76:79], v12 offset:20736
  v_mfma_f32_16x16x32_bf16 v[60:63], v[20:23], a[68:71], v[60:63]
  ds_read_b128 v[80:83], v12 offset:20992
  ds_read_b128 v[84:87], v12 offset:21248
  ds_read_b128 v[88:91], v12 offset:21504
  s_waitcnt lgkmcnt(4)
  v_max3_f32 v72, v72, v73, v74
  v_mfma_f32_16x16x32_bf16 v[64:67], v[20:23], a[100:103], v[64:67]
  s_waitcnt lgkmcnt(3)
  v_max3_f32 v76, v76, v77, v78
  s_waitcnt lgkmcnt(2)
  v_max3_f32 v80, v80, v81, v82
  s_waitcnt lgkmcnt(1)
  v_max3_f32 v84, v84, v85, v86
  s_waitcnt lgkmcnt(0)
  v_max3_f32 v88, v88, v89, v90
  v_mfma_f32_16x16x32_bf16 v[68:71], v[20:23], a[132:135], v[68:71]
  s_waitcnt vmcnt(13)
  ds_read_b128 v[16:19], v9 offset:12288
  v_max_f32 v72, v72, v75
  v_max_f32 v76, v76, v79
  v_max_f32 v80, v80, v83
  v_mfma_f32_16x16x32_bf16 v[52:55], v[24:27], a[8:11], v[52:55]
  v_max_f32 v84, v84, v87
  v_max_f32 v88, v88, v91
  v_mov_b32 v92, v72
  v_mov_b32 v93, v76
  v_mfma_f32_16x16x32_bf16 v[56:59], v[24:27], a[40:43], v[56:59]
  s_add_u32 m0, s32, 10112
  s_nop 0
  buffer_load_dwordx4 v8, s[12:15], s50 offen offset:128 lds
  v_mov_b32 v94, v80
  v_mov_b32 v14, v84
  v_mfma_f32_16x16x32_bf16 v[60:63], v[24:27], a[72:75], v[60:63]
  v_mov_b32 v15, v88
  v_sub_f32 v32, v32, v92
  v_sub_f32 v33, v33, v92
  v_sub_f32 v34, v34, v92
  v_mfma_f32_16x16x32_bf16 v[64:67], v[24:27], a[104:107], v[64:67]
  v_sub_f32 v35, v35, v92
  v_sub_f32 v36, v36, v93
  v_sub_f32 v37, v37, v93
  v_sub_f32 v38, v38, v93
  v_mfma_f32_16x16x32_bf16 v[68:71], v[24:27], a[136:139], v[68:71]
  s_waitcnt vmcnt(13)
  ds_read_b128 v[20:23], v9 offset:13312
  v_sub_f32 v39, v39, v93
  v_sub_f32 v40, v40, v94
  v_sub_f32 v41, v41, v94
  v_mfma_f32_16x16x32_bf16 v[52:55], v[28:31], a[12:15], v[52:55]
  v_sub_f32 v42, v42, v94
  v_sub_f32 v43, v43, v94
  v_sub_f32 v44, v44, v14
  v_sub_f32 v45, v45, v14
  v_mfma_f32_16x16x32_bf16 v[56:59], v[28:31], a[44:47], v[56:59]
  s_add_u32 m0, s32, 11072
  s_nop 0
  buffer_load_dwordx4 v8, s[12:15], s50 offen offset:192 lds
  v_sub_f32 v46, v46, v14
  v_sub_f32 v47, v47, v14
  v_mfma_f32_16x16x32_bf16 v[60:63], v[28:31], a[76:79], v[60:63]
  v_sub_f32 v48, v48, v15
  v_sub_f32 v49, v49, v15
  v_sub_f32 v50, v50, v15
  v_sub_f32 v51, v51, v15
  v_mfma_f32_16x16x32_bf16 v[64:67], v[28:31], a[108:111], v[64:67]
  v_exp_f32 v32, v32
  v_exp_f32 v33, v33
  v_mfma_f32_16x16x32_bf16 v[68:71], v[28:31], a[140:143], v[68:71]
  s_waitcnt vmcnt(13)
  ds_read_b128 v[24:27], v9 offset:14336
  v_exp_f32 v34, v34
  v_exp_f32 v35, v35
  s_waitcnt lgkmcnt(2)
  v_mfma_f32_16x16x32_bf16 v[52:55], v[16:19], a[16:19], v[52:55]
  v_exp_f32 v36, v36
  v_exp_f32 v37, v37
  v_mfma_f32_16x16x32_bf16 v[56:59], v[16:19], a[48:51], v[56:59]
  s_add_u32 m0, s32, 12032
  s_nop 0
  buffer_load_dwordx4 v8, s[12:15], s50 offen offset:256 lds
  v_exp_f32 v38, v38
  v_mfma_f32_16x16x32_bf16 v[60:63], v[16:19], a[80:83], v[60:63]
  v_exp_f32 v39, v39
  v_exp_f32 v40, v40
  v_mfma_f32_16x16x32_bf16 v[64:67], v[16:19], a[112:115], v[64:67]
  v_exp_f32 v41, v41
  v_exp_f32 v42, v42
  v_mfma_f32_16x16x32_bf16 v[68:71], v[16:19], a[144:147], v[68:71]
  s_waitcnt vmcnt(13)
  ds_read_b128 v[28:31], v9 offset:15360
  v_exp_f32 v43, v43
  v_exp_f32 v44, v44
  s_waitcnt lgkmcnt(2)
  v_mfma_f32_16x16x32_bf16 v[52:55], v[20:23], a[20:23], v[52:55]
  v_exp_f32 v45, v45
  v_exp_f32 v46, v46
  v_mfma_f32_16x16x32_bf16 v[56:59], v[20:23], a[52:55], v[56:59]
  s_add_u32 m0, s32, 12992
  s_nop 0
  buffer_load_dwordx4 v8, s[12:15], s50 offen offset:320 lds
  v_exp_f32 v47, v47
  v_mfma_f32_16x16x32_bf16 v[60:63], v[20:23], a[84:87], v[60:63]
  v_exp_f32 v48, v48
  v_exp_f32 v49, v49
  v_mfma_f32_16x16x32_bf16 v[64:67], v[20:23], a[116:119], v[64:67]
  v_exp_f32 v50, v50
  v_exp_f32 v51, v51
  v_mfma_f32_16x16x32_bf16 v[68:71], v[20:23], a[148:151], v[68:71]
  v_cvt_pk_bf16_f32 v32, v32, v33
  v_cvt_pk_bf16_f32 v33, v34, v35
  v_cvt_pk_bf16_f32 v36, v36, v37
  v_cvt_pk_bf16_f32 v37, v38, v39
  s_waitcnt lgkmcnt(1)
  v_mfma_f32_16x16x32_bf16 v[52:55], v[24:27], a[24:27], v[52:55]
  s_waitcnt vmcnt(13)
  ds_read_b128 v[16:19], v9
  v_mfma_f32_16x16x32_bf16 v[56:59], v[24:27], a[56:59], v[56:59]
  s_add_u32 m0, s32, 13952
  s_nop 0
  buffer_load_dwordx4 v8, s[12:15], s50 offen offset:384 lds
  v_mfma_f32_16x16x32_bf16 v[60:63], v[24:27], a[88:91], v[60:63]
  v_mfma_f32_16x16x32_bf16 v[64:67], v[24:27], a[120:123], v[64:67]
  v_mfma_f32_16x16x32_bf16 v[68:71], v[24:27], a[152:155], v[68:71]
  s_waitcnt vmcnt(13)
  ds_read_b128 v[20:23], v9 offset:1024
  s_waitcnt lgkmcnt(2)
  v_mfma_f32_16x16x32_bf16 v[52:55], v[28:31], a[28:31], v[52:55]
  v_mfma_f32_16x16x32_bf16 v[56:59], v[28:31], a[60:63], v[56:59]
  s_add_u32 m0, s32, 14912
  s_nop 0
  buffer_load_dwordx4 v8, s[12:15], s50 offen offset:448 lds
  s_add_u32 s50, s50, 57344
  v_mfma_f32_16x16x32_bf16 v[60:63], v[28:31], a[92:95], v[60:63]
  v_mfma_f32_16x16x32_bf16 v[64:67], v[28:31], a[124:127], v[64:67]
  v_mfma_f32_16x16x32_bf16 v[68:71], v[28:31], a[156:159], v[68:71]
  s_waitcnt vmcnt(13)
  ds_read_b128 v[24:27], v9 offset:2048
  s_setprio 0
  v_max3_f32 v82, v52, v53, v54
  v_max3_f32 v83, v56, v57, v58
  s_nop 0
  v_max3_f32 v84, v60, v61, v62
  v_max3_f32 v85, v64, v65, v66
  v_max3_f32 v86, v68, v69, v70
  v_max_f32 v82, v82, v55
  v_max_f32 v83, v83, v59
  v_max_f32 v84, v84, v63
  v_max_f32 v85, v85, v67
  v_max_f32 v86, v86, v71
  v_mov_b32 v87, v86
  v_permlane16_swap_b32 v82, v83
  v_permlane16_swap_b32 v84, v85
  v_permlane16_swap_b32 v86, v87
  v_max_f32 v82, v82, v83
  v_max_f32 v84, v84, v85
  v_max_f32 v86, v86, v87
  v_mov_b32 v87, v86
  v_permlane32_swap_b32 v82, v84
  s_nop 0
  v_permlane32_swap_b32 v86, v87
  v_max_f32 v82, v82, v84
  v_max_f32 v86, v86, v87
  ds_write_b32 v11, v82 offset:21760
  ds_write_b32 v13, v86 offset:22784
  v_cvt_pk_bf16_f32 v40, v40, v41
  v_cvt_pk_bf16_f32 v41, v42, v43
  v_cvt_pk_bf16_f32 v44, v44, v45
  v_cvt_pk_bf16_f32 v45, v46, v47
  v_cvt_pk_bf16_f32 v48, v48, v49
  v_cvt_pk_bf16_f32 v49, v50, v51
  ds_write_b64 v10, v[32:33]
  ds_write_b64 v10, v[36:37] offset:2048
  ds_write_b64 v10, v[40:41] offset:4096
  ds_write_b64 v10, v[44:45] offset:6144
  ds_write_b64 v10, v[48:49] offset:8192
  s_waitcnt lgkmcnt(0)
  s_barrier
  s_setprio 2
  v_mfma_f32_16x16x32_bf16 v[32:35], v[16:19], a[0:3], 0
  v_mfma_f32_16x16x32_bf16 v[36:39], v[16:19], a[32:35], 0
  s_add_u32 m0, s32, 0
  s_nop 0
  buffer_load_dwordx4 v8, s[12:15], s50 offen lds
  v_mfma_f32_16x16x32_bf16 v[40:43], v[16:19], a[64:67], 0
  v_mfma_f32_16x16x32_bf16 v[44:47], v[16:19], a[96:99], 0
  v_mfma_f32_16x16x32_bf16 v[48:51], v[16:19], a[128:131], 0
  s_waitcnt vmcnt(13)
  ds_read_b128 v[28:31], v9 offset:3072
  v_mfma_f32_16x16x32_bf16 v[32:35], v[20:23], a[4:7], v[32:35]
  v_mfma_f32_16x16x32_bf16 v[36:39], v[20:23], a[36:39], v[36:39]
  s_add_u32 m0, s32, 960
  s_nop 0
  buffer_load_dwordx4 v8, s[12:15], s50 offen offset:64 lds
  ds_read_b128 v[72:75], v12 offset:21760
  ds_read_b128 v[76:79], v12 offset:22016
  v_mfma_f32_16x16x32_bf16 v[40:43], v[20:23], a[68:71], v[40:43]
  ds_read_b128 v[80:83], v12 offset:22272
  ds_read_b128 v[84:87], v12 offset:22528
  ds_read_b128 v[88:91], v12 offset:22784
  s_waitcnt lgkmcnt(4)
  v_max3_f32 v72, v72, v73, v74
  v_mfma_f32_16x16x32_bf16 v[44:47], v[20:23], a[100:103], v[44:47]
  s_waitcnt lgkmcnt(3)
  v_max3_f32 v76, v76, v77, v78
  s_waitcnt lgkmcnt(2)
  v_max3_f32 v80, v80, v81, v82
  s_waitcnt lgkmcnt(1)
  v_max3_f32 v84, v84, v85, v86
  s_waitcnt lgkmcnt(0)
  v_max3_f32 v88, v88, v89, v90
  v_mfma_f32_16x16x32_bf16 v[48:51], v[20:23], a[132:135], v[48:51]
  s_waitcnt vmcnt(13)
  ds_read_b128 v[16:19], v9 offset:4096
  v_max_f32 v72, v72, v75
  v_max_f32 v76, v76, v79
  v_max_f32 v80, v80, v83
  v_mfma_f32_16x16x32_bf16 v[32:35], v[24:27], a[8:11], v[32:35]
  v_max_f32 v84, v84, v87
  v_max_f32 v88, v88, v91
  v_sub_f32 v73, v72, v92
  v_sub_f32 v77, v76, v93
  v_mfma_f32_16x16x32_bf16 v[36:39], v[24:27], a[40:43], v[36:39]
  s_add_u32 m0, s32, 1920
  s_nop 0
  buffer_load_dwordx4 v8, s[12:15], s50 offen offset:128 lds
  v_sub_f32 v81, v80, v94
  v_sub_f32 v85, v84, v14
  v_mfma_f32_16x16x32_bf16 v[40:43], v[24:27], a[72:75], v[40:43]
  v_sub_f32 v89, v88, v15
  v_max3_f32 v4, v73, v77, v81
  v_max3_f32 v4, v4, v85, v89
  v_cmp_lt_f32 vcc, s48, v4
  v_mfma_f32_16x16x32_bf16 v[44:47], v[24:27], a[104:107], v[44:47]
  s_cbranch_vccnz RS_h1
BS_h1:
  v_sub_f32 v52, v52, v92
  v_sub_f32 v53, v53, v92
  v_sub_f32 v54, v54, v92
  v_mfma_f32_16x16x32_bf16 v[48:51], v[24:27], a[136:139], v[48:51]
  s_waitcnt vmcnt(13)
  ds_read_b128 v[20:23], v9 offset:5120
  v_sub_f32 v55, v55, v92
  v_sub_f32 v56, v56, v93
  v_sub_f32 v57, v57, v93
  v_mfma_f32_16x16x32_bf16 v[32:35], v[28:31], a[12:15], v[32:35]
  v_sub_f32 v58, v58, v93
  v_sub_f32 v59, v59, v93
  v_sub_f32 v60, v60, v94
  v_sub_f32 v61, v61, v94
  v_mfma_f32_16x16x32_bf16 v[36:39], v[28:31], a[44:47], v[36:39]
  s_add_u32 m0, s32, 2880
  s_nop 0
  buffer_load_dwordx4 v8, s[12:15], s50 offen offset:192 lds
  v_sub_f32 v62, v62, v94
  v_sub_f32 v63, v63, v94
  v_mfma_f32_16x16x32_bf16 v[40:43], v[28:31], a[76:79], v[40:43]
  v_sub_f32 v64, v64, v14
  v_sub_f32 v65, v65, v14
  v_sub_f32 v66, v66, v14
  v_sub_f32 v67, v67, v14
  v_mfma_f32_16x16x32_bf16 v[44:47], v[28:31], a[108:111], v[44:47]
  v_sub_f32 v68, v68, v15
  v_sub_f32 v69, v69, v15
  v_sub_f32 v70, v70, v15
  v_sub_f32 v71, v71, v15
  v_mfma_f32_16x16x32_bf16 v[48:51], v[28:31], a[140:143], v[48:51]
  s_waitcnt vmcnt(13)
  ds_read_b128 v[24:27], v9 offset:6144
  v_exp_f32 v52, v52
  v_exp_f32 v53, v53
  s_waitcnt lgkmcnt(2)
  v_mfma_f32_16x16x32_bf16 v[32:35], v[16:19], a[16:19], v[32:35]
  v_exp_f32 v54, v54
  v_exp_f32 v55, v55
  v_mfma_f32_16x16x32_bf16 v[36:39], v[16:19], a[48:51], v[36:39]
  s_add_u32 m0, s32, 3840
  s_nop 0
  buffer_load_dwordx4 v8, s[12:15], s50 offen offset:256 lds
  v_exp_f32 v56, v56
  v_mfma_f32_16x16x32_bf16 v[40:43], v[16:19], a[80:83], v[40:43]
  v_exp_f32 v57, v57
  v_exp_f32 v58, v58
  v_mfma_f32_16x16x32_bf16 v[44:47], v[16:19], a[112:115], v[44:47]
  v_exp_f32 v59, v59
  v_exp_f32 v60, v60
  v_mfma_f32_16x16x32_bf16 v[48:51], v[16:19], a[144:147], v[48:51]
  s_waitcnt vmcnt(13)
  ds_read_b128 v[28:31], v9 offset:7168
  v_exp_f32 v61, v61
  v_exp_f32 v62, v62
  s_waitcnt lgkmcnt(2)
  v_mfma_f32_16x16x32_bf16 v[32:35], v[20:23], a[20:23], v[32:35]
  v_exp_f32 v63, v63
  v_exp_f32 v64, v64
  v_mfma_f32_16x16x32_bf16 v[36:39], v[20:23], a[52:55], v[36:39]
  s_add_u32 m0, s32, 4800
  s_nop 0
  buffer_load_dwordx4 v8, s[12:15], s50 offen offset:320 lds
  v_exp_f32 v65, v65
  v_mfma_f32_16x16x32_bf16 v[40:43], v[20:23], a[84:87], v[40:43]
  v_exp_f32 v66, v66
  v_exp_f32 v67, v67
  v_mfma_f32_16x16x32_bf16 v[44:47], v[20:23], a[116:119], v[44:47]
  v_exp_f32 v68, v68
  v_exp_f32 v69, v69
  v_mfma_f32_16x16x32_bf16 v[48:51], v[20:23], a[148:151], v[48:51]
  v_exp_f32 v70, v70
  v_exp_f32 v71, v71
  s_waitcnt lgkmcnt(1)
  v_mfma_f32_16x16x32_bf16 v[32:35], v[24:27], a[24:27], v[32:35]
  v_cvt_pk_bf16_f32 v52, v52, v53
  v_cvt_pk_bf16_f32 v53, v54, v55
  v_cvt_pk_bf16_f32 v56, v56, v57
  v_cvt_pk_bf16_f32 v57, v58, v59
  v_mfma_f32_16x16x32_bf16 v[36:39], v[24:27], a[56:59], v[36:39]
  s_add_u32 m0, s32, 5760
  s_nop 0
  buffer_load_dwordx4 v8, s[12:15], s50 offen offset:384 lds
  s_waitcnt vmcnt(14)
  ds_read_b128 v[16:19], v9 offset:8192
  v_mfma_f32_16x16x32_bf16 v[40:43], v[24:27], a[88:91], v[40:43]
  v_mfma_f32_16x16x32_bf16 v[44:47], v[24:27], a[120:123], v[44:47]
  v_mfma_f32_16x16x32_bf16 v[48:51], v[24:27], a[152:155], v[48:51]
  s_waitcnt vmcnt(13)
  ds_read_b128 v[20:23], v9 offset:9216
  s_waitcnt lgkmcnt(2)
  v_mfma_f32_16x16x32_bf16 v[32:35], v[28:31], a[28:31], v[32:35]
  v_mfma_f32_16x16x32_bf16 v[36:39], v[28:31], a[60:63], v[36:39]
  s_add_u32 m0, s32, 6720
  s_nop 0
  buffer_load_dwordx4 v8, s[12:15], s50 offen offset:448 lds
  s_add_u32 s50, s50, 8192
  v_mfma_f32_16x16x32_bf16 v[40:43], v[28:31], a[92:95], v[40:43]
  v_mfma_f32_16x16x32_bf16 v[44:47], v[28:31], a[124:127], v[44:47]
  v_mfma_f32_16x16x32_bf16 v[48:51], v[28:31], a[156:159], v[48:51]
  s_waitcnt vmcnt(13)
  ds_read_b128 v[24:27], v9 offset:10240
  s_setprio 0
  v_max3_f32 v82, v32, v33, v34
  v_max3_f32 v83, v36, v37, v38
  s_nop 0
  v_max3_f32 v84, v40, v41, v42
  v_max3_f32 v85, v44, v45, v46
  v_max3_f32 v86, v48, v49, v50
  v_max_f32 v82, v82, v35
  v_max_f32 v83, v83, v39
  v_max_f32 v84, v84, v43
  v_max_f32 v85, v85, v47
  v_max_f32 v86, v86, v51
  v_mov_b32 v87, v86
  v_permlane16_swap_b32 v82, v83
  v_permlane16_swap_b32 v84, v85
  v_permlane16_swap_b32 v86, v87
  v_max_f32 v82, v82, v83
  v_max_f32 v84, v84, v85
  v_max_f32 v86, v86, v87
  v_mov_b32 v87, v86
  v_permlane32_swap_b32 v82, v84
  s_nop 0
  v_permlane32_swap_b32 v86, v87
  v_max_f32 v82, v82, v84
  v_max_f32 v86, v86, v87
  ds_write_b32 v11, v82 offset:20480
  ds_write_b32 v13, v86 offset:21504
  v_cvt_pk_bf16_f32 v60, v60, v61
  v_cvt_pk_bf16_f32 v61, v62, v63
  v_cvt_pk_bf16_f32 v64, v64, v65
  v_cvt_pk_bf16_f32 v65, v66, v67
  v_cvt_pk_bf16_f32 v68, v68, v69
  v_cvt_pk_bf16_f32 v69, v70, v71
  ds_write_b64 v10, v[52:53] offset:10240
  ds_write_b64 v10, v[56:57] offset:12288
  ds_write_b64 v10, v[60:61] offset:14336
  ds_write_b64 v10, v[64:65] offset:16384
  ds_write_b64 v10, v[68:69] offset:18432
  s_waitcnt lgkmcnt(0)
  s_barrier
LS_MAIN:
  s_setprio 2
  v_mfma_f32_16x16x32_bf16 v[52:55], v[16:19], a[0:3], 0
  v_mfma_f32_16x16x32_bf16 v[56:59], v[16:19], a[32:35], 0
  s_add_u32 m0, s32, 8192
  s_nop 0
  buffer_load_dwordx4 v8, s[12:15], s50 offen lds
  v_mfma_f32_16x16x32_bf16 v[60:63], v[16:19], a[64:67], 0
  v_mfma_f32_16x16x32_bf16 v[64:67], v[16:19], a[96:99], 0
  v_mfma_f32_16x16x32_bf16 v[68:71], v[16:19], a[128:131], 0
  s_waitcnt vmcnt(13)
  ds_read_b128 v[28:31], v9 offset:11264
  v_mfma_f32_16x16x32_bf16 v[52:55], v[20:23], a[4:7], v[52:55]
  v_mfma_f32_16x16x32_bf16 v[56:59], v[20:23], a[36:39], v[56:59]
  s_add_u32 m0, s32, 9152
  s_nop 0
  buffer_load_dwordx4 v8, s[12:15], s50 offen offset:64 lds
  ds_read_b128 v[72:75], v12 offset:20480
  ds_read_b128 v[76:79], v12 offset:20736
  v_mfma_f32_16x16x32_bf16 v[60:63], v[20:23], a[68:71], v[60:63]
  ds_read_b128 v[80:83], v12 offset:20992
  ds_read_b128 v[84:87], v12 offset:21248
  ds_read_b128 v[88:91], v12 offset:21504
  s_waitcnt lgkmcnt(4)
  v_max3_f32 v72, v72, v73, v74
  v_mfma_f32_16x16x32_bf16 v[64:67], v[20:23], a[100:103], v[64:67]
  s_waitcnt lgkmcnt(3)
  v_max3_f32 v76, v76, v77, v78
  s_waitcnt lgkmcnt(2)
  v_max3_f32 v80, v80, v81, v82
  s_waitcnt lgkmcnt(1)
  v_max3_f32 v84, v84, v85, v86
  s_waitcnt lgkmcnt(0)
  v_max3_f32 v88, v88, v89, v90
  v_mfma_f32_16x16x32_bf16 v[68:71], v[20:23], a[132:135], v[68:71]
  s_waitcnt vmcnt(13)
  ds_read_b128 v[16:19], v9 offset:12288
  v_max_f32 v72, v72, v75
  v_max_f32 v76, v76, v79
  v_max_f32 v80, v80, v83
  v_mfma_f32_16x16x32_bf16 v[52:55], v[24:27], a[8:11], v[52:55]
  v_max_f32 v84, v84, v87
  v_max_f32 v88, v88, v91
  v_sub_f32 v73, v72, v92
  v_sub_f32 v77, v76, v93
  v_mfma_f32_16x16x32_bf16 v[56:59], v[24:27], a[40:43], v[56:59]
  s_add_u32 m0, s32, 10112
  s_nop 0
  buffer_load_dwordx4 v8, s[12:15], s50 offen offset:128 lds
  v_sub_f32 v81, v80, v94
  v_sub_f32 v85, v84, v14
  v_mfma_f32_16x16x32_bf16 v[60:63], v[24:27], a[72:75], v[60:63]
  v_sub_f32 v89, v88, v15
  v_max3_f32 v4, v73, v77, v81
  v_max3_f32 v4, v4, v85, v89
  v_cmp_lt_f32 vcc, s48, v4
  v_mfma_f32_16x16x32_bf16 v[64:67], v[24:27], a[104:107], v[64:67]
  s_cbranch_vccnz RS_hA
BS_hA:
  v_sub_f32 v32, v32, v92
  v_sub_f32 v33, v33, v92
  v_sub_f32 v34, v34, v92
  v_mfma_f32_16x16x32_bf16 v[68:71], v[24:27], a[136:139], v[68:71]
  s_waitcnt vmcnt(13)
  ds_read_b128 v[20:23], v9 offset:13312
  v_sub_f32 v35, v35, v92
  v_sub_f32 v36, v36, v93
  v_sub_f32 v37, v37, v93
  v_mfma_f32_16x16x32_bf16 v[52:55], v[28:31], a[12:15], v[52:55]
  v_sub_f32 v38, v38, v93
  v_sub_f32 v39, v39, v93
  v_sub_f32 v40, v40, v94
  v_sub_f32 v41, v41, v94
  v_mfma_f32_16x16x32_bf16 v[56:59], v[28:31], a[44:47], v[56:59]
  s_add_u32 m0, s32, 11072
  s_nop 0
  buffer_load_dwordx4 v8, s[12:15], s50 offen offset:192 lds
  v_sub_f32 v42, v42, v94
  v_sub_f32 v43, v43, v94
  v_mfma_f32_16x16x32_bf16 v[60:63], v[28:31], a[76:79], v[60:63]
  v_sub_f32 v44, v44, v14
  v_sub_f32 v45, v45, v14
  v_sub_f32 v46, v46, v14
  v_sub_f32 v47, v47, v14
  v_mfma_f32_16x16x32_bf16 v[64:67], v[28:31], a[108:111], v[64:67]
  v_sub_f32 v48, v48, v15
  v_sub_f32 v49, v49, v15
  v_sub_f32 v50, v50, v15
  v_sub_f32 v51, v51, v15
  v_mfma_f32_16x16x32_bf16 v[68:71], v[28:31], a[140:143], v[68:71]
  s_waitcnt vmcnt(13)
  ds_read_b128 v[24:27], v9 offset:14336
  v_exp_f32 v32, v32
  v_exp_f32 v33, v33
  s_waitcnt lgkmcnt(2)
  v_mfma_f32_16x16x32_bf16 v[52:55], v[16:19], a[16:19], v[52:55]
  v_exp_f32 v34, v34
  v_exp_f32 v35, v35
  v_mfma_f32_16x16x32_bf16 v[56:59], v[16:19], a[48:51], v[56:59]
  s_add_u32 m0, s32, 12032
  s_nop 0
  buffer_load_dwordx4 v8, s[12:15], s50 offen offset:256 lds
  v_exp_f32 v36, v36
  v_mfma_f32_16x16x32_bf16 v[60:63], v[16:19], a[80:83], v[60:63]
  v_exp_f32 v37, v37
  v_exp_f32 v38, v38
  v_mfma_f32_16x16x32_bf16 v[64:67], v[16:19], a[112:115], v[64:67]
  v_exp_f32 v39, v39
  v_exp_f32 v40, v40
  v_mfma_f32_16x16x32_bf16 v[68:71], v[16:19], a[144:147], v[68:71]
  s_waitcnt vmcnt(13)
  ds_read_b128 v[28:31], v9 offset:15360
  v_exp_f32 v41, v41
  v_exp_f32 v42, v42
  s_waitcnt lgkmcnt(2)
  v_mfma_f32_16x16x32_bf16 v[52:55], v[20:23], a[20:23], v[52:55]
  v_exp_f32 v43, v43
  v_exp_f32 v44, v44
  v_mfma_f32_16x16x32_bf16 v[56:59], v[20:23], a[52:55], v[56:59]
  s_add_u32 m0, s32, 12992
  s_nop 0
  buffer_load_dwordx4 v8, s[12:15], s50 offen offset:320 lds
  v_exp_f32 v45, v45
  v_mfma_f32_16x16x32_bf16 v[60:63], v[20:23], a[84:87], v[60:63]
  v_exp_f32 v46, v46
  v_exp_f32 v47, v47
  v_mfma_f32_16x16x32_bf16 v[64:67], v[20:23], a[116:119], v[64:67]
  v_exp_f32 v48, v48
  v_exp_f32 v49, v49
  v_mfma_f32_16x16x32_bf16 v[68:71], v[20:23], a[148:151], v[68:71]
  v_exp_f32 v50, v50
  v_exp_f32 v51, v51
  s_waitcnt lgkmcnt(1)
  v_mfma_f32_16x16x32_bf16 v[52:55], v[24:27], a[24:27], v[52:55]
  v_cvt_pk_bf16_f32 v32, v32, v33
  v_cvt_pk_bf16_f32 v33, v34, v35
  v_cvt_pk_bf16_f32 v36, v36, v37
  v_cvt_pk_bf16_f32 v37, v38, v39
  v_mfma_f32_16x16x32_bf16 v[56:59], v[24:27], a[56:59], v[56:59]
  s_add_u32 m0, s32, 13952
  s_nop 0
  buffer_load_dwordx4 v8, s[12:15], s50 offen offset:384 lds
  s_waitcnt vmcnt(14)
  ds_read_b128 v[16:19], v9
  v_mfma_f32_16x16x32_bf16 v[60:63], v[24:27], a[88:91], v[60:63]
  v_mfma_f32_16x16x32_bf16 v[64:67], v[24:27], a[120:123], v[64:67]
  v_mfma_f32_16x16x32_bf16 v[68:71], v[24:27], a[152:155], v[68:71]
  s_waitcnt vmcnt(13)
  ds_read_b128 v[20:23], v9 offset:1024
  s_waitcnt lgkmcnt(2)
  v_mfma_f32_16x16x32_bf16 v[52:55], v[28:31], a[28:31], v[52:55]
  v_mfma_f32_16x16x32_bf16 v[56:59], v[28:31], a[60:63], v[56:59]
  s_add_u32 m0, s32, 14912
  s_nop 0
  buffer_load_dwordx4 v8, s[12:15], s50 offen offset:448 lds
  s_add_u32 s50, s50, 57344
  v_mfma_f32_16x16x32_bf16 v[60:63], v[28:31], a[92:95], v[60:63]
  v_mfma_f32_16x16x32_bf16 v[64:67], v[28:31], a[124:127], v[64:67]
  v_mfma_f32_16x16x32_bf16 v[68:71], v[28:31], a[156:159], v[68:71]
  s_waitcnt vmcnt(13)
  ds_read_b128 v[24:27], v9 offset:2048
  s_setprio 0
  v_max3_f32 v82, v52, v53, v54
  v_max3_f32 v83, v56, v57, v58
  s_nop 0
  v_max3_f32 v84, v60, v61, v62
  v_max3_f32 v85, v64, v65, v66
  v_max3_f32 v86, v68, v69, v70
  v_max_f32 v82, v82, v55
  v_max_f32 v83, v83, v59
  v_max_f32 v84, v84, v63
  v_max_f32 v85, v85, v67
  v_max_f32 v86, v86, v71
  v_mov_b32 v87, v86
  v_permlane16_swap_b32 v82, v83
  v_permlane16_swap_b32 v84, v85
  v_permlane16_swap_b32 v86, v87
  v_max_f32 v82, v82, v83
  v_max_f32 v84, v84, v85
  v_max_f32 v86, v86, v87
  v_mov_b32 v87, v86
  v_permlane32_swap_b32 v82, v84
  s_nop 0
  v_permlane32_swap_b32 v86, v87
  v_max_f32 v82, v82, v84
  v_max_f32 v86, v86, v87
  ds_write_b32 v11, v82 offset:21760
  ds_write_b32 v13, v86 offset:22784
  v_cvt_pk_bf16_f32 v40, v40, v41
  v_cvt_pk_bf16_f32 v41, v42, v43
  v_cvt_pk_bf16_f32 v44, v44, v45
  v_cvt_pk_bf16_f32 v45, v46, v47
  v_cvt_pk_bf16_f32 v48, v48, v49
  v_cvt_pk_bf16_f32 v49, v50, v51
  ds_write_b64 v10, v[32:33]
  ds_write_b64 v10, v[36:37] offset:2048
  ds_write_b64 v10, v[40:41] offset:4096
  ds_write_b64 v10, v[44:45] offset:6144
  ds_write_b64 v10, v[48:49] offset:8192
  s_waitcnt lgkmcnt(0)
  s_barrier
  s_setprio 2
  v_mfma_f32_16x16x32_bf16 v[32:35], v[16:19], a[0:3], 0
  v_mfma_f32_16x16x32_bf16 v[36:39], v[16:19], a[32:35], 0
  s_add_u32 m0, s32, 0
  s_nop 0
  buffer_load_dwordx4 v8, s[12:15], s50 offen lds
  v_mfma_f32_16x16x32_bf16 v[40:43], v[16:19], a[64:67], 0
  v_mfma_f32_16x16x32_bf16 v[44:47], v[16:19], a[96:99], 0
  v_mfma_f32_16x16x32_bf16 v[48:51], v[16:19], a[128:131], 0
  s_waitcnt vmcnt(13)
  ds_read_b128 v[28:31], v9 offset:3072
  v_mfma_f32_16x16x32_bf16 v[32:35], v[20:23], a[4:7], v[32:35]
  v_mfma_f32_16x16x32_bf16 v[36:39], v[20:23], a[36:39], v[36:39]
  s_add_u32 m0, s32, 960
  s_nop 0
  buffer_load_dwordx4 v8, s[12:15], s50 offen offset:64 lds
  ds_read_b128 v[72:75], v12 offset:21760
  ds_read_b128 v[76:79], v12 offset:22016
  v_mfma_f32_16x16x32_bf16 v[40:43], v[20:23], a[68:71], v[40:43]
  ds_read_b128 v[80:83], v12 offset:22272
  ds_read_b128 v[84:87], v12 offset:22528
  ds_read_b128 v[88:91], v12 offset:22784
  s_waitcnt lgkmcnt(4)
  v_max3_f32 v72, v72, v73, v74
  v_mfma_f32_16x16x32_bf16 v[44:47], v[20:23], a[100:103], v[44:47]
  s_waitcnt lgkmcnt(3)
  v_max3_f32 v76, v76, v77, v78
  s_waitcnt lgkmcnt(2)
  v_max3_f32 v80, v80, v81, v82
  s_waitcnt lgkmcnt(1)
  v_max3_f32 v84, v84, v85, v86
  s_waitcnt lgkmcnt(0)
  v_max3_f32 v88, v88, v89, v90
  v_mfma_f32_16x16x32_bf16 v[48:51], v[20:23], a[132:135], v[48:51]
  s_waitcnt vmcnt(13)
  ds_read_b128 v[16:19], v9 offset:4096
  v_max_f32 v72, v72, v75
  v_max_f32 v76, v76, v79
  v_max_f32 v80, v80, v83
  v_mfma_f32_16x16x32_bf16 v[32:35], v[24:27], a[8:11], v[32:35]
  v_max_f32 v84, v84, v87
  v_max_f32 v88, v88, v91
  v_sub_f32 v73, v72, v92
  v_sub_f32 v77, v76, v93
  v_mfma_f32_16x16x32_bf16 v[36:39], v[24:27], a[40:43], v[36:39]
  s_add_u32 m0, s32, 1920
  s_nop 0
  buffer_load_dwordx4 v8, s[12:15], s50 offen offset:128 lds
  v_sub_f32 v81, v80, v94
  v_sub_f32 v85, v84, v14
  v_mfma_f32_16x16x32_bf16 v[40:43], v[24:27], a[72:75], v[40:43]
  v_sub_f32 v89, v88, v15
  v_max3_f32 v4, v73, v77, v81
  v_max3_f32 v4, v4, v85, v89
  v_cmp_lt_f32 vcc, s48, v4
  v_mfma_f32_16x16x32_bf16 v[44:47], v[24:27], a[104:107], v[44:47]
  s_cbranch_vccnz RS_hB
BS_hB:
  v_sub_f32 v52, v52, v92
  v_sub_f32 v53, v53, v92
  v_sub_f32 v54, v54, v92
  v_mfma_f32_16x16x32_bf16 v[48:51], v[24:27], a[136:139], v[48:51]
  s_waitcnt vmcnt(13)
  ds_read_b128 v[20:23], v9 offset:5120
  v_sub_f32 v55, v55, v92
  v_sub_f32 v56, v56, v93
  v_sub_f32 v57, v57, v93
  v_mfma_f32_16x16x32_bf16 v[32:35], v[28:31], a[12:15], v[32:35]
  v_sub_f32 v58, v58, v93
  v_sub_f32 v59, v59, v93
  v_sub_f32 v60, v60, v94
  v_sub_f32 v61, v61, v94
  v_mfma_f32_16x16x32_bf16 v[36:39], v[28:31], a[44:47], v[36:39]
  s_add_u32 m0, s32, 2880
  s_nop 0
  buffer_load_dwordx4 v8, s[12:15], s50 offen offset:192 lds
  v_sub_f32 v62, v62, v94
  v_sub_f32 v63, v63, v94
  v_mfma_f32_16x16x32_bf16 v[40:43], v[28:31], a[76:79], v[40:43]
  v_sub_f32 v64, v64, v14
  v_sub_f32 v65, v65, v14
  v_sub_f32 v66, v66, v14
  v_sub_f32 v67, v67, v14
  v_mfma_f32_16x16x32_bf16 v[44:47], v[28:31], a[108:111], v[44:47]
  v_sub_f32 v68, v68, v15
  v_sub_f32 v69, v69, v15
  v_sub_f32 v70, v70, v15
  v_sub_f32 v71, v71, v15
  v_mfma_f32_16x16x32_bf16 v[48:51], v[28:31], a[140:143], v[48:51]
  s_waitcnt vmcnt(13)
  ds_read_b128 v[24:27], v9 offset:6144
  v_exp_f32 v52, v52
  v_exp_f32 v53, v53
  s_waitcnt lgkmcnt(2)
  v_mfma_f32_16x16x32_bf16 v[32:35], v[16:19], a[16:19], v[32:35]
  v_exp_f32 v54, v54
  v_exp_f32 v55, v55
  v_mfma_f32_16x16x32_bf16 v[36:39], v[16:19], a[48:51], v[36:39]
  s_add_u32 m0, s32, 3840
  s_nop 0
  buffer_load_dwordx4 v8, s[12:15], s50 offen offset:256 lds
  v_exp_f32 v56, v56
  v_mfma_f32_16x16x32_bf16 v[40:43], v[16:19], a[80:83], v[40:43]
  v_exp_f32 v57, v57
  v_exp_f32 v58, v58
  v_mfma_f32_16x16x32_bf16 v[44:47], v[16:19], a[112:115], v[44:47]
  v_exp_f32 v59, v59
  v_exp_f32 v60, v60
  v_mfma_f32_16x16x32_bf16 v[48:51], v[16:19], a[144:147], v[48:51]
  s_waitcnt vmcnt(13)
  ds_read_b128 v[28:31], v9 offset:7168
  v_exp_f32 v61, v61
  v_exp_f32 v62, v62
  s_waitcnt lgkmcnt(2)
  v_mfma_f32_16x16x32_bf16 v[32:35], v[20:23], a[20:23], v[32:35]
  v_exp_f32 v63, v63
  v_exp_f32 v64, v64
  v_mfma_f32_16x16x32_bf16 v[36:39], v[20:23], a[52:55], v[36:39]
  s_add_u32 m0, s32, 4800
  s_nop 0
  buffer_load_dwordx4 v8, s[12:15], s50 offen offset:320 lds
  v_exp_f32 v65, v65
  v_mfma_f32_16x16x32_bf16 v[40:43], v[20:23], a[84:87], v[40:43]
  v_exp_f32 v66, v66
  v_exp_f32 v67, v67
  v_mfma_f32_16x16x32_bf16 v[44:47], v[20:23], a[116:119], v[44:47]
  v_exp_f32 v68, v68
  v_exp_f32 v69, v69
  v_mfma_f32_16x16x32_bf16 v[48:51], v[20:23], a[148:151], v[48:51]
  v_exp_f32 v70, v70
  v_exp_f32 v71, v71
  s_waitcnt lgkmcnt(1)
  v_mfma_f32_16x16x32_bf16 v[32:35], v[24:27], a[24:27], v[32:35]
  v_cvt_pk_bf16_f32 v52, v52, v53
  v_cvt_pk_bf16_f32 v53, v54, v55
  v_cvt_pk_bf16_f32 v56, v56, v57
  v_cvt_pk_bf16_f32 v57, v58, v59
  v_mfma_f32_16x16x32_bf16 v[36:39], v[24:27], a[56:59], v[36:39]
  s_add_u32 m0, s32, 5760
  s_nop 0
  buffer_load_dwordx4 v8, s[12:15], s50 offen offset:384 lds
  s_waitcnt vmcnt(14)
  ds_read_b128 v[16:19], v9 offset:8192
  v_mfma_f32_16x16x32_bf16 v[40:43], v[24:27], a[88:91], v[40:43]
  v_mfma_f32_16x16x32_bf16 v[44:47], v[24:27], a[120:123], v[44:47]
  v_mfma_f32_16x16x32_bf16 v[48:51], v[24:27], a[152:155], v[48:51]
  s_waitcnt vmcnt(13)
  ds_read_b128 v[20:23], v9 offset:9216
  s_waitcnt lgkmcnt(2)
  v_mfma_f32_16x16x32_bf16 v[32:35], v[28:31], a[28:31], v[32:35]
  v_mfma_f32_16x16x32_bf16 v[36:39], v[28:31], a[60:63], v[36:39]
  s_add_u32 m0, s32, 6720
  s_nop 0
  buffer_load_dwordx4 v8, s[12:15], s50 offen offset:448 lds
  s_add_u32 s50, s50, 8192
  v_mfma_f32_16x16x32_bf16 v[40:43], v[28:31], a[92:95], v[40:43]
  v_mfma_f32_16x16x32_bf16 v[44:47], v[28:31], a[124:127], v[44:47]
  v_mfma_f32_16x16x32_bf16 v[48:51], v[28:31], a[156:159], v[48:51]
  s_waitcnt vmcnt(13)
  ds_read_b128 v[24:27], v9 offset:10240
  s_setprio 0
  v_max3_f32 v82, v32, v33, v34
  v_max3_f32 v83, v36, v37, v38
  s_nop 0
  v_max3_f32 v84, v40, v41, v42
  v_max3_f32 v85, v44, v45, v46
  v_max3_f32 v86, v48, v49, v50
  v_max_f32 v82, v82, v35
  v_max_f32 v83, v83, v39
  v_max_f32 v84, v84, v43
  v_max_f32 v85, v85, v47
  v_max_f32 v86, v86, v51
  v_mov_b32 v87, v86
  v_permlane16_swap_b32 v82, v83
  v_permlane16_swap_b32 v84, v85
  v_permlane16_swap_b32 v86, v87
  v_max_f32 v82, v82, v83
  v_max_f32 v84, v84, v85
  v_max_f32 v86, v86, v87
  v_mov_b32 v87, v86
  v_permlane32_swap_b32 v82, v84
  s_nop 0
  v_permlane32_swap_b32 v86, v87
  v_max_f32 v82, v82, v84
  v_max_f32 v86, v86, v87
  ds_write_b32 v11, v82 offset:20480
  ds_write_b32 v13, v86 offset:21504
  v_cvt_pk_bf16_f32 v60, v60, v61
  v_cvt_pk_bf16_f32 v61, v62, v63
  v_cvt_pk_bf16_f32 v64, v64, v65
  v_cvt_pk_bf16_f32 v65, v66, v67
  v_cvt_pk_bf16_f32 v68, v68, v69
  v_cvt_pk_bf16_f32 v69, v70, v71
  ds_write_b64 v10, v[52:53] offset:10240
  ds_write_b64 v10, v[56:57] offset:12288
  ds_write_b64 v10, v[60:61] offset:14336
  ds_write_b64 v10, v[64:65] offset:16384
  ds_write_b64 v10, v[68:69] offset:18432
  s_waitcnt lgkmcnt(0)
  s_waitcnt lgkmcnt(0)
  s_barrier
  s_add_u32 s46, s46, 1
  s_cmp_lt_u32 s46, 6
  s_cbranch_scc1 LS_MAIN
  s_setprio 2
  v_mfma_f32_16x16x32_bf16 v[52:55], v[16:19], a[0:3], 0
  v_mfma_f32_16x16x32_bf16 v[56:59], v[16:19], a[32:35], 0
  v_mfma_f32_16x16x32_bf16 v[60:63], v[16:19], a[64:67], 0
  v_mfma_f32_16x16x32_bf16 v[64:67], v[16:19], a[96:99], 0
  v_mfma_f32_16x16x32_bf16 v[68:71], v[16:19], a[128:131], 0
  s_waitcnt vmcnt(12)
  ds_read_b128 v[28:31], v9 offset:11264
  v_mfma_f32_16x16x32_bf16 v[52:55], v[20:23], a[4:7], v[52:55]
  v_mfma_f32_16x16x32_bf16 v[56:59], v[20:23], a[36:39], v[56:59]
  ds_read_b128 v[72:75], v12 offset:20480
  ds_read_b128 v[76:79], v12 offset:20736
  ds_read_b128 v[80:83], v12 offset:20992
  ds_read_b128 v[84:87], v12 offset:21248
  v_mfma_f32_16x16x32_bf16 v[60:63], v[20:23], a[68:71], v[60:63]
  ds_read_b128 v[88:91], v12 offset:21504
  s_waitcnt lgkmcnt(4)
  v_max3_f32 v72, v72, v73, v74
  s_waitcnt lgkmcnt(3)
  v_max3_f32 v76, v76, v77, v78
  s_waitcnt lgkmcnt(2)
  v_max3_f32 v80, v80, v81, v82
  v_mfma_f32_16x16x32_bf16 v[64:67], v[20:23], a[100:103], v[64:67]
  s_waitcnt lgkmcnt(1)
  v_max3_f32 v84, v84, v85, v86
  s_waitcnt lgkmcnt(0)
  v_max3_f32 v88, v88, v89, v90
  v_max_f32 v72, v72, v75
  v_max_f32 v76, v76, v79
  v_mfma_f32_16x16x32_bf16 v[68:71], v[20:23], a[132:135], v[68:71]
  s_waitcnt vmcnt(11)
  ds_read_b128 v[16:19], v9 offset:12288
  v_max_f32 v80, v80, v83
  v_max_f32 v84, v84, v87
  v_max_f32 v88, v88, v91
  v_mfma_f32_16x16x32_bf16 v[52:55], v[24:27], a[8:11], v[52:55]
  v_sub_f32 v73, v72, v92
  v_sub_f32 v77, v76, v93
  v_sub_f32 v81, v80, v94
  v_sub_f32 v85, v84, v14
  v_mfma_f32_16x16x32_bf16 v[56:59], v[24:27], a[40:43], v[56:59]
  v_sub_f32 v89, v88, v15
  v_max3_f32 v4, v73, v77, v81
  v_max3_f32 v4, v4, v85, v89
  v_cmp_lt_f32 vcc, s48, v4
  v_mfma_f32_16x16x32_bf16 v[60:63], v[24:27], a[72:75], v[60:63]
  s_cbranch_vccnz RS_h14
BS_h14:
  v_sub_f32 v32, v32, v92
  v_sub_f32 v33, v33, v92
  v_sub_f32 v34, v34, v92
  v_mfma_f32_16x16x32_bf16 v[64:67], v[24:27], a[104:107], v[64:67]
  v_sub_f32 v35, v35, v92
  v_sub_f32 v36, v36, v93
  v_sub_f32 v37, v37, v93
  v_sub_f32 v38, v38, v93
  v_mfma_f32_16x16x32_bf16 v[68:71], v[24:27], a[136:139], v[68:71]
  s_waitcnt vmcnt(10)
  ds_read_b128 v[20:23], v9 offset:13312
  v_sub_f32 v39, v39, v93
  v_sub_f32 v40, v40, v94
  v_sub_f32 v41, v41, v94
  v_mfma_f32_16x16x32_bf16 v[52:55], v[28:31], a[12:15], v[52:55]
  v_sub_f32 v42, v42, v94
  v_sub_f32 v43, v43, v94
  v_sub_f32 v44, v44, v14
  v_sub_f32 v45, v45, v14
  v_mfma_f32_16x16x32_bf16 v[56:59], v[28:31], a[44:47], v[56:59]
  v_sub_f32 v46, v46, v14
  v_sub_f32 v47, v47, v14
  v_sub_f32 v48, v48, v15
  v_sub_f32 v49, v49, v15
  v_mfma_f32_16x16x32_bf16 v[60:63], v[28:31], a[76:79], v[60:63]
  v_sub_f32 v50, v50, v15
  v_sub_f32 v51, v51, v15
  v_exp_f32 v32, v32
  v_mfma_f32_16x16x32_bf16 v[64:67], v[28:31], a[108:111], v[64:67]
  v_exp_f32 v33, v33
  v_exp_f32 v34, v34
  v_mfma_f32_16x16x32_bf16 v[68:71], v[28:31], a[140:143], v[68:71]
  s_waitcnt vmcnt(9)
  ds_read_b128 v[24:27], v9 offset:14336
  v_exp_f32 v35, v35
  v_exp_f32 v36, v36
  s_waitcnt lgkmcnt(2)
  v_mfma_f32_16x16x32_bf16 v[52:55], v[16:19], a[16:19], v[52:55]
  v_exp_f32 v37, v37
  v_exp_f32 v38, v38
  v_mfma_f32_16x16x32_bf16 v[56:59], v[16:19], a[48:51], v[56:59]
  v_exp_f32 v39, v39
  v_exp_f32 v40, v40
  v_mfma_f32_16x16x32_bf16 v[60:63], v[16:19], a[80:83], v[60:63]
  v_exp_f32 v41, v41
  v_exp_f32 v42, v42
  v_mfma_f32_16x16x32_bf16 v[64:67], v[16:19], a[112:115], v[64:67]
  v_exp_f32 v43, v43
  v_exp_f32 v44, v44
  v_mfma_f32_16x16x32_bf16 v[68:71], v[16:19], a[144:147], v[68:71]
  s_waitcnt vmcnt(8)
  ds_read_b128 v[28:31], v9 offset:15360
  v_exp_f32 v45, v45
  v_exp_f32 v46, v46
  s_waitcnt lgkmcnt(2)
  v_mfma_f32_16x16x32_bf16 v[52:55], v[20:23], a[20:23], v[52:55]
  v_exp_f32 v47, v47
  v_exp_f32 v48, v48
  v_mfma_f32_16x16x32_bf16 v[56:59], v[20:23], a[52:55], v[56:59]
  v_exp_f32 v49, v49
  v_exp_f32 v50, v50
  v_mfma_f32_16x16x32_bf16 v[60:63], v[20:23], a[84:87], v[60:63]
  v_exp_f32 v51, v51
  v_cvt_pk_bf16_f32 v32, v32, v33
  v_cvt_pk_bf16_f32 v33, v34, v35
  v_mfma_f32_16x16x32_bf16 v[64:67], v[20:23], a[116:119], v[64:67]
  v_cvt_pk_bf16_f32 v36, v36, v37
  v_cvt_pk_bf16_f32 v37, v38, v39
  v_mfma_f32_16x16x32_bf16 v[68:71], v[20:23], a[148:151], v[68:71]
  s_waitcnt vmcnt(7)
  ds_read_b128 v[16:19], v9
  s_waitcnt lgkmcnt(2)
  v_mfma_f32_16x16x32_bf16 v[52:55], v[24:27], a[24:27], v[52:55]
  v_mfma_f32_16x16x32_bf16 v[56:59], v[24:27], a[56:59], v[56:59]
  v_mfma_f32_16x16x32_bf16 v[60:63], v[24:27], a[88:91], v[60:63]
  v_mfma_f32_16x16x32_bf16 v[64:67], v[24:27], a[120:123], v[64:67]
  v_mfma_f32_16x16x32_bf16 v[68:71], v[24:27], a[152:155], v[68:71]
  s_waitcnt vmcnt(6)
  ds_read_b128 v[20:23], v9 offset:1024
  s_waitcnt lgkmcnt(2)
  v_mfma_f32_16x16x32_bf16 v[52:55], v[28:31], a[28:31], v[52:55]
  v_mfma_f32_16x16x32_bf16 v[56:59], v[28:31], a[60:63], v[56:59]
  v_mfma_f32_16x16x32_bf16 v[60:63], v[28:31], a[92:95], v[60:63]
  v_mfma_f32_16x16x32_bf16 v[64:67], v[28:31], a[124:127], v[64:67]
  v_mfma_f32_16x16x32_bf16 v[68:71], v[28:31], a[156:159], v[68:71]
  s_waitcnt vmcnt(5)
  ds_read_b128 v[24:27], v9 offset:2048
  s_setprio 0
  s_nop 0
  v_max3_f32 v82, v52, v53, v54
  v_max3_f32 v83, v56, v57, v58
  v_max3_f32 v84, v60, v61, v62
  v_max3_f32 v85, v64, v65, v66
  v_max3_f32 v86, v68, v69, v70
  v_max_f32 v82, v82, v55
  v_max_f32 v83, v83, v59
  v_max_f32 v84, v84, v63
  v_max_f32 v85, v85, v67
  v_max_f32 v86, v86, v71
  v_mov_b32 v87, v86
  v_permlane16_swap_b32 v82, v83
  v_permlane16_swap_b32 v84, v85
  v_permlane16_swap_b32 v86, v87
  v_max_f32 v82, v82, v83
  v_max_f32 v84, v84, v85
  v_max_f32 v86, v86, v87
  v_mov_b32 v87, v86
  v_permlane32_swap_b32 v82, v84
  s_nop 0
  v_permlane32_swap_b32 v86, v87
  v_max_f32 v82, v82, v84
  v_max_f32 v86, v86, v87
  ds_write_b32 v11, v82 offset:21760
  ds_write_b32 v13, v86 offset:22784
  v_cvt_pk_bf16_f32 v40, v40, v41
  v_cvt_pk_bf16_f32 v41, v42, v43
  v_cvt_pk_bf16_f32 v44, v44, v45
  v_cvt_pk_bf16_f32 v45, v46, v47
  v_cvt_pk_bf16_f32 v48, v48, v49
  v_cvt_pk_bf16_f32 v49, v50, v51
  ds_write_b64 v10, v[32:33]
  ds_write_b64 v10, v[36:37] offset:2048
  ds_write_b64 v10, v[40:41] offset:4096
  ds_write_b64 v10, v[44:45] offset:6144
  ds_write_b64 v10, v[48:49] offset:8192
  s_waitcnt lgkmcnt(0)
  s_barrier
  s_lshl_b32 s97, s28, 14
  s_add_u32 s97, s97, 24576
  v_lshrrev_b32 v4, 3, v1
  v_and_b32 v5, 6, v4
  v_and_b32 v6, 7, v1
  v_xor_b32 v5, v5, v6
  v_lshlrev_b32 v5, 4, v5
  v_mul_u32_u24 v4, 896, v4
  v_add_u32 v4, v4, v5
  s_lshl_b32 s34, s70, 7
  v_add_u32 v95, s34, v4
  s_add_u32 m0, s97, 0
  s_mov_b32 s35, 0
  buffer_load_dwordx4 v95, s[20:23], s35 offen lds
  s_add_u32 m0, s97, 1024
  s_mov_b32 s35, 7168
  buffer_load_dwordx4 v95, s[20:23], s35 offen lds
  s_add_u32 m0, s97, 2048
  s_mov_b32 s35, 14336
  buffer_load_dwordx4 v95, s[20:23], s35 offen lds
  s_add_u32 m0, s97, 3072
  s_mov_b32 s35, 21504
  buffer_load_dwordx4 v95, s[20:23], s35 offen lds
  s_add_u32 m0, s97, 4096
  s_mov_b32 s35, 28672
  buffer_load_dwordx4 v95, s[20:23], s35 offen lds
  s_add_u32 m0, s97, 5120
  s_mov_b32 s35, 35840
  buffer_load_dwordx4 v95, s[20:23], s35 offen lds
  s_add_u32 m0, s97, 6144
  s_mov_b32 s35, 43008
  buffer_load_dwordx4 v95, s[20:23], s35 offen lds
  s_add_u32 m0, s97, 7168
  s_mov_b32 s35, 50176
  buffer_load_dwordx4 v95, s[20:23], s35 offen lds
  s_add_u32 m0, s97, 8192
  s_mov_b32 s35, 57344
  buffer_load_dwordx4 v95, s[20:23], s35 offen lds
  s_add_u32 m0, s97, 9216
  s_mov_b32 s35, 64512
  buffer_load_dwordx4 v95, s[20:23], s35 offen lds
  s_add_u32 m0, s97, 10240
  s_mov_b32 s35, 71680
  buffer_load_dwordx4 v95, s[20:23], s35 offen lds
  s_add_u32 m0, s97, 11264
  s_mov_b32 s35, 78848
  buffer_load_dwordx4 v95, s[20:23], s35 offen lds
  s_add_u32 m0, s97, 12288
  s_mov_b32 s35, 86016
  buffer_load_dwordx4 v95, s[20:23], s35 offen lds
  s_add_u32 m0, s97, 13312
  s_mov_b32 s35, 93184
  buffer_load_dwordx4 v95, s[20:23], s35 offen lds
  s_add_u32 m0, s97, 14336
  s_mov_b32 s35, 100352
  buffer_load_dwordx4 v95, s[20:23], s35 offen lds
  s_add_u32 m0, s97, 15360
  s_mov_b32 s35, 107520
  buffer_load_dwordx4 v95, s[20:23], s35 offen lds
  ds_read_b128 v[72:75], v12 offset:21760
  ds_read_b128 v[76:79], v12 offset:22016
  ds_read_b128 v[80:83], v12 offset:22272
  ds_read_b128 v[84:87], v12 offset:22528
  ds_read_b128 v[88:91], v12 offset:22784
  s_waitcnt lgkmcnt(4)
  v_max3_f32 v72, v72, v73, v74
  s_waitcnt lgkmcnt(3)
  v_max3_f32 v76, v76, v77, v78
  s_waitcnt lgkmcnt(2)
  v_max3_f32 v80, v80, v81, v82
  s_waitcnt lgkmcnt(1)
  v_max3_f32 v84, v84, v85, v86
  s_waitcnt lgkmcnt(0)
  v_max3_f32 v88, v88, v89, v90
  v_max_f32 v72, v72, v75
  v_max_f32 v76, v76, v79
  v_max_f32 v80, v80, v83
  v_max_f32 v84, v84, v87
  v_max_f32 v88, v88, v91
  v_sub_f32 v73, v72, v92
  v_sub_f32 v77, v76, v93
  v_sub_f32 v81, v80, v94
  v_sub_f32 v85, v84, v14
  v_sub_f32 v89, v88, v15
  v_max3_f32 v4, v73, v77, v81
  v_max3_f32 v4, v4, v85, v89
  v_cmp_lt_f32 vcc, s48, v4
  s_cbranch_vccnz RS_h15
BS_h15:
  v_sub_f32 v52, v52, v92
  v_sub_f32 v53, v53, v92
  v_sub_f32 v54, v54, v92
  v_sub_f32 v55, v55, v92
  v_sub_f32 v56, v56, v93
  v_sub_f32 v57, v57, v93
  v_sub_f32 v58, v58, v93
  v_sub_f32 v59, v59, v93
  v_sub_f32 v60, v60, v94
  v_sub_f32 v61, v61, v94
  v_sub_f32 v62, v62, v94
  v_sub_f32 v63, v63, v94
  v_sub_f32 v64, v64, v14
  v_sub_f32 v65, v65, v14
  v_sub_f32 v66, v66, v14
  v_sub_f32 v67, v67, v14
  v_sub_f32 v68, v68, v15
  v_sub_f32 v69, v69, v15
  v_sub_f32 v70, v70, v15
  v_sub_f32 v71, v71, v15
  v_exp_f32 v52, v52
  v_exp_f32 v53, v53
  v_exp_f32 v54, v54
  v_exp_f32 v55, v55
  v_exp_f32 v56, v56
  v_exp_f32 v57, v57
  v_exp_f32 v58, v58
  v_exp_f32 v59, v59
  v_exp_f32 v60, v60
  v_exp_f32 v61, v61
  v_exp_f32 v62, v62
  v_exp_f32 v63, v63
  v_exp_f32 v64, v64
  v_exp_f32 v65, v65
  v_exp_f32 v66, v66
  v_exp_f32 v67, v67
  v_exp_f32 v68, v68
  v_exp_f32 v69, v69
  v_exp_f32 v70, v70
  v_exp_f32 v71, v71
  v_cvt_pk_bf16_f32 v52, v52, v53
  v_cvt_pk_bf16_f32 v53, v54, v55
  v_cvt_pk_bf16_f32 v56, v56, v57
  v_cvt_pk_bf16_f32 v57, v58, v59
  v_cvt_pk_bf16_f32 v60, v60, v61
  v_cvt_pk_bf16_f32 v61, v62, v63
  v_cvt_pk_bf16_f32 v64, v64, v65
  v_cvt_pk_bf16_f32 v65, v66, v67
  v_cvt_pk_bf16_f32 v68, v68, v69
  v_cvt_pk_bf16_f32 v69, v70, v71
  ds_write_b64 v10, v[52:53] offset:10240
  ds_write_b64 v10, v[56:57] offset:12288
  ds_write_b64 v10, v[60:61] offset:14336
  ds_write_b64 v10, v[64:65] offset:16384
  ds_write_b64 v10, v[68:69] offset:18432
  s_waitcnt lgkmcnt(0)
  s_barrier
  s_setprio 0
  s_waitcnt lgkmcnt(0)
  s_waitcnt lgkmcnt(0)
  s_barrier
  s_waitcnt lgkmcnt(0)
  s_barrier
  v_xor_b32 v4, v2, v3
  v_lshlrev_b32 v4, 4, v4
  v_lshl_add_u32 v9, v3, 9, v4
  v_xor_b32 v11, 192, v9
  v_xor_b32 v10, 128, v9
  v_xor_b32 v76, 64, v9
  v_xor_b32 v8, 0, v9
  v_mov_b32 v9, v76
  v_add_u32 v12, 90112, v8
  v_add_u32 v13, 90112, v9
  v_add_u32 v14, 90112, v10
  v_add_u32 v15, 90112, v11
  v_lshrrev_b32 v4, 2, v3
  v_and_b32 v5, 3, v3
  v_lshlrev_b32 v6, 10, v2
  v_lshl_add_u32 v6, v4, 7, v6
  v_and_b32 v7, 2, v4
  v_lshl_add_u32 v6, v7, 4, v6
  v_lshl_add_u32 v6, v5, 3, v6
  v_add_u32 v72, s97, v6
  v_xor_b32 v73, 32, v72
  v_xor_b32 v74, 64, v72
  v_xor_b32 v75, 96, v72
  ds_read_b128 a[80:83], v8
  ds_read_b128 a[84:87], v8 offset:8192
  ds_read_b128 a[88:91], v8 offset:16384
  ds_read_b128 a[92:95], v12
  ds_read_b128 a[96:99], v12 offset:8192
  s_waitcnt vmcnt(12)
  ds_read_b64_tr_b16 v[16:17], v72
  ds_read_b64_tr_b16 v[18:19], v74 offset:512
  ds_read_b64_tr_b16 v[20:21], v73
  ds_read_b64_tr_b16 v[22:23], v75 offset:512
  ds_read_b64_tr_b16 v[24:25], v74
  ds_read_b64_tr_b16 v[26:27], v72 offset:512
  ds_read_b64_tr_b16 v[28:29], v75
  ds_read_b64_tr_b16 v[30:31], v73 offset:512
  s_waitcnt lgkmcnt(6)
  v_mfma_f32_16x16x32_bf16 a[0:3], v[16:19], a[80:83], 0
  ds_read_b128 a[100:103], v9
  ds_read_b128 a[104:107], v9 offset:8192
  s_waitcnt lgkmcnt(6)
  v_mfma_f32_16x16x32_bf16 a[20:23], v[20:23], a[80:83], 0
  ds_read_b128 a[108:111], v9 offset:16384
  ds_read_b128 a[112:115], v13
  s_waitcnt lgkmcnt(6)
  v_mfma_f32_16x16x32_bf16 a[40:43], v[24:27], a[80:83], 0
  ds_read_b128 a[116:119], v13 offset:8192
  s_waitcnt vmcnt(8)
  ds_read_b64_tr_b16 v[32:33], v72 offset:4096
  s_waitcnt lgkmcnt(6)
  v_mfma_f32_16x16x32_bf16 a[60:63], v[28:31], a[80:83], 0
  ds_read_b64_tr_b16 v[34:35], v74 offset:4608
  ds_read_b64_tr_b16 v[36:37], v73 offset:4096
  v_mfma_f32_16x16x32_bf16 a[4:7], v[16:19], a[84:87], 0
  s_add_u32 m0, s97, 0
  s_mov_b32 s35, 114688
  buffer_load_dwordx4 v95, s[20:23], s35 offen lds
  v_mfma_f32_16x16x32_bf16 a[24:27], v[20:23], a[84:87], 0
  ds_read_b64_tr_b16 v[38:39], v75 offset:4608
  ds_read_b64_tr_b16 v[40:41], v74 offset:4096
  v_mfma_f32_16x16x32_bf16 a[44:47], v[24:27], a[84:87], 0
  ds_read_b64_tr_b16 v[42:43], v72 offset:4608
  ds_read_b64_tr_b16 v[44:45], v75 offset:4096
  v_mfma_f32_16x16x32_bf16 a[64:67], v[28:31], a[84:87], 0
  ds_read_b64_tr_b16 v[46:47], v73 offset:4608
  v_mfma_f32_16x16x32_bf16 a[8:11], v[16:19], a[88:91], 0
  s_add_u32 m0, s97, 1024
  s_mov_b32 s35, 121856
  buffer_load_dwordx4 v95, s[20:23], s35 offen lds
  v_mfma_f32_16x16x32_bf16 a[28:31], v[20:23], a[88:91], 0
  v_mfma_f32_16x16x32_bf16 a[48:51], v[24:27], a[88:91], 0
  v_mfma_f32_16x16x32_bf16 a[68:71], v[28:31], a[88:91], 0
  v_mfma_f32_16x16x32_bf16 a[12:15], v[16:19], a[92:95], 0
  s_add_u32 m0, s97, 2048
  s_mov_b32 s35, 129024
  buffer_load_dwordx4 v95, s[20:23], s35 offen lds
  v_mfma_f32_16x16x32_bf16 a[32:35], v[20:23], a[92:95], 0
  v_mfma_f32_16x16x32_bf16 a[52:55], v[24:27], a[92:95], 0
  v_mfma_f32_16x16x32_bf16 a[72:75], v[28:31], a[92:95], 0
  v_mfma_f32_16x16x32_bf16 a[16:19], v[16:19], a[96:99], 0
  s_add_u32 m0, s97, 3072
  s_mov_b32 s35, 136192
  buffer_load_dwordx4 v95, s[20:23], s35 offen lds
  v_mfma_f32_16x16x32_bf16 a[36:39], v[20:23], a[96:99], 0
  v_mfma_f32_16x16x32_bf16 a[56:59], v[24:27], a[96:99], 0
  v_mfma_f32_16x16x32_bf16 a[76:79], v[28:31], a[96:99], 0
  s_waitcnt lgkmcnt(6)
  v_mfma_f32_16x16x32_bf16 a[0:3], v[32:35], a[100:103], a[0:3]
  ds_read_b128 a[80:83], v10
  ds_read_b128 a[84:87], v10 offset:8192
  s_waitcnt lgkmcnt(6)
  v_mfma_f32_16x16x32_bf16 a[20:23], v[36:39], a[100:103], a[20:23]
  ds_read_b128 a[88:91], v10 offset:16384
  ds_read_b128 a[92:95], v14
  s_waitcnt lgkmcnt(6)
  v_mfma_f32_16x16x32_bf16 a[40:43], v[40:43], a[100:103], a[40:43]
  ds_read_b128 a[96:99], v14 offset:8192
  s_waitcnt vmcnt(8)
  ds_read_b64_tr_b16 v[16:17], v72 offset:8192
  s_waitcnt lgkmcnt(6)
  v_mfma_f32_16x16x32_bf16 a[60:63], v[44:47], a[100:103], a[60:63]
  ds_read_b64_tr_b16 v[18:19], v74 offset:8704
  ds_read_b64_tr_b16 v[20:21], v73 offset:8192
  v_mfma_f32_16x16x32_bf16 a[4:7], v[32:35], a[104:107], a[4:7]
  s_add_u32 m0, s97, 4096
  s_mov_b32 s35, 143360
  buffer_load_dwordx4 v95, s[20:23], s35 offen lds
  v_mfma_f32_16x16x32_bf16 a[24:27], v[36:39], a[104:107], a[24:27]
  ds_read_b64_tr_b16 v[22:23], v75 offset:8704
  ds_read_b64_tr_b16 v[24:25], v74 offset:8192
  v_mfma_f32_16x16x32_bf16 a[44:47], v[40:43], a[104:107], a[44:47]
  ds_read_b64_tr_b16 v[26:27], v72 offset:8704
  ds_read_b64_tr_b16 v[28:29], v75 offset:8192
  v_mfma_f32_16x16x32_bf16 a[64:67], v[44:47], a[104:107], a[64:67]
  ds_read_b64_tr_b16 v[30:31], v73 offset:8704
  v_mfma_f32_16x16x32_bf16 a[8:11], v[32:35], a[108:111], a[8:11]
  s_add_u32 m0, s97, 5120
  s_mov_b32 s35, 150528
  buffer_load_dwordx4 v95, s[20:23], s35 offen lds
  v_mfma_f32_16x16x32_bf16 a[28:31], v[36:39], a[108:111], a[28:31]
  v_mfma_f32_16x16x32_bf16 a[48:51], v[40:43], a[108:111], a[48:51]
  v_mfma_f32_16x16x32_bf16 a[68:71], v[44:47], a[108:111], a[68:71]
  v_mfma_f32_16x16x32_bf16 a[12:15], v[32:35], a[112:115], a[12:15]
  s_add_u32 m0, s97, 6144
  s_mov_b32 s35, 157696
  buffer_load_dwordx4 v95, s[20:23], s35 offen lds
  v_mfma_f32_16x16x32_bf16 a[32:35], v[36:39], a[112:115], a[32:35]
  v_mfma_f32_16x16x32_bf16 a[52:55], v[40:43], a[112:115], a[52:55]
  v_mfma_f32_16x16x32_bf16 a[72:75], v[44:47], a[112:115], a[72:75]
  v_mfma_f32_16x16x32_bf16 a[16:19], v[32:35], a[116:119], a[16:19]
  s_add_u32 m0, s97, 7168
  s_mov_b32 s35, 164864
  buffer_load_dwordx4 v95, s[20:23], s35 offen lds
  v_mfma_f32_16x16x32_bf16 a[36:39], v[36:39], a[116:119], a[36:39]
  v_mfma_f32_16x16x32_bf16 a[56:59], v[40:43], a[116:119], a[56:59]
  v_mfma_f32_16x16x32_bf16 a[76:79], v[44:47], a[116:119], a[76:79]
  s_waitcnt lgkmcnt(6)
  v_mfma_f32_16x16x32_bf16 a[0:3], v[16:19], a[80:83], a[0:3]
  ds_read_b128 a[100:103], v11
  ds_read_b128 a[104:107], v11 offset:8192
  s_waitcnt lgkmcnt(6)
  v_mfma_f32_16x16x32_bf16 a[20:23], v[20:23], a[80:83], a[20:23]
  ds_read_b128 a[108:111], v11 offset:16384
  ds_read_b128 a[112:115], v15
  s_waitcnt lgkmcnt(6)
  v_mfma_f32_16x16x32_bf16 a[40:43], v[24:27], a[80:83], a[40:43]
  ds_read_b128 a[116:119], v15 offset:8192
  s_waitcnt vmcnt(8)
  ds_read_b64_tr_b16 v[32:33], v72 offset:12288
  s_waitcnt lgkmcnt(6)
  v_mfma_f32_16x16x32_bf16 a[60:63], v[28:31], a[80:83], a[60:63]
  ds_read_b64_tr_b16 v[34:35], v74 offset:12800
  ds_read_b64_tr_b16 v[36:37], v73 offset:12288
  v_mfma_f32_16x16x32_bf16 a[4:7], v[16:19], a[84:87], a[4:7]
  s_add_u32 m0, s97, 8192
  s_mov_b32 s35, 172032
  buffer_load_dwordx4 v95, s[20:23], s35 offen lds
  v_mfma_f32_16x16x32_bf16 a[24:27], v[20:23], a[84:87], a[24:27]
  ds_read_b64_tr_b16 v[38:39], v75 offset:12800
  ds_read_b64_tr_b16 v[40:41], v74 offset:12288
  v_mfma_f32_16x16x32_bf16 a[44:47], v[24:27], a[84:87], a[44:47]
  ds_read_b64_tr_b16 v[42:43], v72 offset:12800
  ds_read_b64_tr_b16 v[44:45], v75 offset:12288
  v_mfma_f32_16x16x32_bf16 a[64:67], v[28:31], a[84:87], a[64:67]
  ds_read_b64_tr_b16 v[46:47], v73 offset:12800
  v_mfma_f32_16x16x32_bf16 a[8:11], v[16:19], a[88:91], a[8:11]
  s_add_u32 m0, s97, 9216
  s_mov_b32 s35, 179200
  buffer_load_dwordx4 v95, s[20:23], s35 offen lds
  v_mfma_f32_16x16x32_bf16 a[28:31], v[20:23], a[88:91], a[28:31]
  v_mfma_f32_16x16x32_bf16 a[48:51], v[24:27], a[88:91], a[48:51]
  v_mfma_f32_16x16x32_bf16 a[68:71], v[28:31], a[88:91], a[68:71]
  v_mfma_f32_16x16x32_bf16 a[12:15], v[16:19], a[92:95], a[12:15]
  s_add_u32 m0, s97, 10240
  s_mov_b32 s35, 186368
  buffer_load_dwordx4 v95, s[20:23], s35 offen lds
  v_mfma_f32_16x16x32_bf16 a[32:35], v[20:23], a[92:95], a[32:35]
  v_mfma_f32_16x16x32_bf16 a[52:55], v[24:27], a[92:95], a[52:55]
  v_mfma_f32_16x16x32_bf16 a[72:75], v[28:31], a[92:95], a[72:75]
  v_mfma_f32_16x16x32_bf16 a[16:19], v[16:19], a[96:99], a[16:19]
  s_add_u32 m0, s97, 11264
  s_mov_b32 s35, 193536
  buffer_load_dwordx4 v95, s[20:23], s35 offen lds
  v_mfma_f32_16x16x32_bf16 a[36:39], v[20:23], a[96:99], a[36:39]
  v_mfma_f32_16x16x32_bf16 a[56:59], v[24:27], a[96:99], a[56:59]
  v_mfma_f32_16x16x32_bf16 a[76:79], v[28:31], a[96:99], a[76:79]
  s_waitcnt lgkmcnt(6)
  v_mfma_f32_16x16x32_bf16 a[0:3], v[32:35], a[100:103], a[0:3]
  ds_read_b128 a[80:83], v8 offset:256
  ds_read_b128 a[84:87], v8 offset:8448
  s_waitcnt lgkmcnt(6)
  v_mfma_f32_16x16x32_bf16 a[20:23], v[36:39], a[100:103], a[20:23]
  ds_read_b128 a[88:91], v8 offset:16640
  ds_read_b128 a[92:95], v12 offset:256
  s_waitcnt lgkmcnt(6)
  v_mfma_f32_16x16x32_bf16 a[40:43], v[40:43], a[100:103], a[40:43]
  ds_read_b128 a[96:99], v12 offset:8448
  s_waitcnt vmcnt(8)
  ds_read_b64_tr_b16 v[16:17], v72
  s_waitcnt lgkmcnt(6)
  v_mfma_f32_16x16x32_bf16 a[60:63], v[44:47], a[100:103], a[60:63]
  ds_read_b64_tr_b16 v[18:19], v74 offset:512
  ds_read_b64_tr_b16 v[20:21], v73
  v_mfma_f32_16x16x32_bf16 a[4:7], v[32:35], a[104:107], a[4:7]
  s_add_u32 m0, s97, 12288
  s_mov_b32 s35, 200704
  buffer_load_dwordx4 v95, s[20:23], s35 offen lds
  v_mfma_f32_16x16x32_bf16 a[24:27], v[36:39], a[104:107], a[24:27]
  ds_read_b64_tr_b16 v[22:23], v75 offset:512
  ds_read_b64_tr_b16 v[24:25], v74
  v_mfma_f32_16x16x32_bf16 a[44:47], v[40:43], a[104:107], a[44:47]
  ds_read_b64_tr_b16 v[26:27], v72 offset:512
  ds_read_b64_tr_b16 v[28:29], v75
  v_mfma_f32_16x16x32_bf16 a[64:67], v[44:47], a[104:107], a[64:67]
  ds_read_b64_tr_b16 v[30:31], v73 offset:512
  v_mfma_f32_16x16x32_bf16 a[8:11], v[32:35], a[108:111], a[8:11]
  s_add_u32 m0, s97, 13312
  s_mov_b32 s35, 207872
  buffer_load_dwordx4 v95, s[20:23], s35 offen lds
  v_mfma_f32_16x16x32_bf16 a[28:31], v[36:39], a[108:111], a[28:31]
  v_mfma_f32_16x16x32_bf16 a[48:51], v[40:43], a[108:111], a[48:51]
  v_mfma_f32_16x16x32_bf16 a[68:71], v[44:47], a[108:111], a[68:71]
  v_mfma_f32_16x16x32_bf16 a[12:15], v[32:35], a[112:115], a[12:15]
  s_add_u32 m0, s97, 14336
  s_mov_b32 s35, 215040
  buffer_load_dwordx4 v95, s[20:23], s35 offen lds
  v_mfma_f32_16x16x32_bf16 a[32:35], v[36:39], a[112:115], a[32:35]
  v_mfma_f32_16x16x32_bf16 a[52:55], v[40:43], a[112:115], a[52:55]
  v_mfma_f32_16x16x32_bf16 a[72:75], v[44:47], a[112:115], a[72:75]
  v_mfma_f32_16x16x32_bf16 a[16:19], v[32:35], a[116:119], a[16:19]
  s_add_u32 m0, s97, 15360
  s_mov_b32 s35, 222208
  buffer_load_dwordx4 v95, s[20:23], s35 offen lds
  v_mfma_f32_16x16x32_bf16 a[36:39], v[36:39], a[116:119], a[36:39]
  v_mfma_f32_16x16x32_bf16 a[56:59], v[40:43], a[116:119], a[56:59]
  v_mfma_f32_16x16x32_bf16 a[76:79], v[44:47], a[116:119], a[76:79]
  s_waitcnt lgkmcnt(6)
  v_mfma_f32_16x16x32_bf16 a[0:3], v[16:19], a[80:83], a[0:3]
  ds_read_b128 a[100:103], v9 offset:256
  ds_read_b128 a[104:107], v9 offset:8448
  s_waitcnt lgkmcnt(6)
  v_mfma_f32_16x16x32_bf16 a[20:23], v[20:23], a[80:83], a[20:23]
  ds_read_b128 a[108:111], v9 offset:16640
  ds_read_b128 a[112:115], v13 offset:256
  s_waitcnt lgkmcnt(6)
  v_mfma_f32_16x16x32_bf16 a[40:43], v[24:27], a[80:83], a[40:43]
  ds_read_b128 a[116:119], v13 offset:8448
  s_waitcnt vmcnt(8)
  ds_read_b64_tr_b16 v[32:33], v72 offset:4096
  s_waitcnt lgkmcnt(6)
  v_mfma_f32_16x16x32_bf16 a[60:63], v[28:31], a[80:83], a[60:63]
  ds_read_b64_tr_b16 v[34:35], v74 offset:4608
  ds_read_b64_tr_b16 v[36:37], v73 offset:4096
  v_mfma_f32_16x16x32_bf16 a[4:7], v[16:19], a[84:87], a[4:7]
  ds_read_b64_tr_b16 v[38:39], v75 offset:4608
  ds_read_b64_tr_b16 v[40:41], v74 offset:4096
  v_mfma_f32_16x16x32_bf16 a[24:27], v[20:23], a[84:87], a[24:27]
  ds_read_b64_tr_b16 v[42:43], v72 offset:4608
  ds_read_b64_tr_b16 v[44:45], v75 offset:4096
  v_mfma_f32_16x16x32_bf16 a[44:47], v[24:27], a[84:87], a[44:47]
  ds_read_b64_tr_b16 v[46:47], v73 offset:4608
  v_mfma_f32_16x16x32_bf16 a[64:67], v[28:31], a[84:87], a[64:67]
  v_mfma_f32_16x16x32_bf16 a[8:11], v[16:19], a[88:91], a[8:11]
  v_mfma_f32_16x16x32_bf16 a[28:31], v[20:23], a[88:91], a[28:31]
  v_mfma_f32_16x16x32_bf16 a[48:51], v[24:27], a[88:91], a[48:51]
  v_mfma_f32_16x16x32_bf16 a[68:71], v[28:31], a[88:91], a[68:71]
  v_mfma_f32_16x16x32_bf16 a[12:15], v[16:19], a[92:95], a[12:15]
  v_mfma_f32_16x16x32_bf16 a[32:35], v[20:23], a[92:95], a[32:35]
  v_mfma_f32_16x16x32_bf16 a[52:55], v[24:27], a[92:95], a[52:55]
  v_mfma_f32_16x16x32_bf16 a[72:75], v[28:31], a[92:95], a[72:75]
  v_mfma_f32_16x16x32_bf16 a[16:19], v[16:19], a[96:99], a[16:19]
  v_mfma_f32_16x16x32_bf16 a[36:39], v[20:23], a[96:99], a[36:39]
  v_mfma_f32_16x16x32_bf16 a[56:59], v[24:27], a[96:99], a[56:59]
  v_mfma_f32_16x16x32_bf16 a[76:79], v[28:31], a[96:99], a[76:79]
  s_waitcnt lgkmcnt(6)
  v_mfma_f32_16x16x32_bf16 a[0:3], v[32:35], a[100:103], a[0:3]
  ds_read_b128 a[80:83], v10 offset:256
  ds_read_b128 a[84:87], v10 offset:8448
  s_waitcnt lgkmcnt(6)
  v_mfma_f32_16x16x32_bf16 a[20:23], v[36:39], a[100:103], a[20:23]
  ds_read_b128 a[88:91], v10 offset:16640
  ds_read_b128 a[92:95], v14 offset:256
  s_waitcnt lgkmcnt(6)
  v_mfma_f32_16x16x32_bf16 a[40:43], v[40:43], a[100:103], a[40:43]
  ds_read_b128 a[96:99], v14 offset:8448
  s_waitcnt vmcnt(4)
  ds_read_b64_tr_b16 v[16:17], v72 offset:8192
  s_waitcnt lgkmcnt(6)
  v_mfma_f32_16x16x32_bf16 a[60:63], v[44:47], a[100:103], a[60:63]
  ds_read_b64_tr_b16 v[18:19], v74 offset:8704
  ds_read_b64_tr_b16 v[20:21], v73 offset:8192
  v_mfma_f32_16x16x32_bf16 a[4:7], v[32:35], a[104:107], a[4:7]
  ds_read_b64_tr_b16 v[22:23], v75 offset:8704
  ds_read_b64_tr_b16 v[24:25], v74 offset:8192
  v_mfma_f32_16x16x32_bf16 a[24:27], v[36:39], a[104:107], a[24:27]
  ds_read_b64_tr_b16 v[26:27], v72 offset:8704
  ds_read_b64_tr_b16 v[28:29], v75 offset:8192
  v_mfma_f32_16x16x32_bf16 a[44:47], v[40:43], a[104:107], a[44:47]
  ds_read_b64_tr_b16 v[30:31], v73 offset:8704
  v_mfma_f32_16x16x32_bf16 a[64:67], v[44:47], a[104:107], a[64:67]
  v_mfma_f32_16x16x32_bf16 a[8:11], v[32:35], a[108:111], a[8:11]
  v_mfma_f32_16x16x32_bf16 a[28:31], v[36:39], a[108:111], a[28:31]
  v_mfma_f32_16x16x32_bf16 a[48:51], v[40:43], a[108:111], a[48:51]
  v_mfma_f32_16x16x32_bf16 a[68:71], v[44:47], a[108:111], a[68:71]
  v_mfma_f32_16x16x32_bf16 a[12:15], v[32:35], a[112:115], a[12:15]
  v_mfma_f32_16x16x32_bf16 a[32:35], v[36:39], a[112:115], a[32:35]
  v_mfma_f32_16x16x32_bf16 a[52:55], v[40:43], a[112:115], a[52:55]
  v_mfma_f32_16x16x32_bf16 a[72:75], v[44:47], a[112:115], a[72:75]
  v_mfma_f32_16x16x32_bf16 a[16:19], v[32:35], a[116:119], a[16:19]
  v_mfma_f32_16x16x32_bf16 a[36:39], v[36:39], a[116:119], a[36:39]
  v_mfma_f32_16x16x32_bf16 a[56:59], v[40:43], a[116:119], a[56:59]
  v_mfma_f32_16x16x32_bf16 a[76:79], v[44:47], a[116:119], a[76:79]
  s_waitcnt lgkmcnt(6)
  v_mfma_f32_16x16x32_bf16 a[0:3], v[16:19], a[80:83], a[0:3]
  ds_read_b128 a[100:103], v11 offset:256
  ds_read_b128 a[104:107], v11 offset:8448
  s_waitcnt lgkmcnt(6)
  v_mfma_f32_16x16x32_bf16 a[20:23], v[20:23], a[80:83], a[20:23]
  ds_read_b128 a[108:111], v11 offset:16640
  ds_read_b128 a[112:115], v15 offset:256
  s_waitcnt lgkmcnt(6)
  v_mfma_f32_16x16x32_bf16 a[40:43], v[24:27], a[80:83], a[40:43]
  ds_read_b128 a[116:119], v15 offset:8448
  s_waitcnt vmcnt(0)
  ds_read_b64_tr_b16 v[32:33], v72 offset:12288
  s_waitcnt lgkmcnt(6)
  v_mfma_f32_16x16x32_bf16 a[60:63], v[28:31], a[80:83], a[60:63]
  ds_read_b64_tr_b16 v[34:35], v74 offset:12800
  ds_read_b64_tr_b16 v[36:37], v73 offset:12288
  v_mfma_f32_16x16x32_bf16 a[4:7], v[16:19], a[84:87], a[4:7]
  ds_read_b64_tr_b16 v[38:39], v75 offset:12800
  ds_read_b64_tr_b16 v[40:41], v74 offset:12288
  v_mfma_f32_16x16x32_bf16 a[24:27], v[20:23], a[84:87], a[24:27]
  ds_read_b64_tr_b16 v[42:43], v72 offset:12800
  ds_read_b64_tr_b16 v[44:45], v75 offset:12288
  v_mfma_f32_16x16x32_bf16 a[44:47], v[24:27], a[84:87], a[44:47]
  ds_read_b64_tr_b16 v[46:47], v73 offset:12800
  v_mfma_f32_16x16x32_bf16 a[64:67], v[28:31], a[84:87], a[64:67]
  v_mfma_f32_16x16x32_bf16 a[8:11], v[16:19], a[88:91], a[8:11]
  v_mfma_f32_16x16x32_bf16 a[28:31], v[20:23], a[88:91], a[28:31]
  v_mfma_f32_16x16x32_bf16 a[48:51], v[24:27], a[88:91], a[48:51]
  v_mfma_f32_16x16x32_bf16 a[68:71], v[28:31], a[88:91], a[68:71]
  v_mfma_f32_16x16x32_bf16 a[12:15], v[16:19], a[92:95], a[12:15]
  v_mfma_f32_16x16x32_bf16 a[32:35], v[20:23], a[92:95], a[32:35]
  v_mfma_f32_16x16x32_bf16 a[52:55], v[24:27], a[92:95], a[52:55]
  v_mfma_f32_16x16x32_bf16 a[72:75], v[28:31], a[92:95], a[72:75]
  v_mfma_f32_16x16x32_bf16 a[16:19], v[16:19], a[96:99], a[16:19]
  v_mfma_f32_16x16x32_bf16 a[36:39], v[20:23], a[96:99], a[36:39]
  v_mfma_f32_16x16x32_bf16 a[56:59], v[24:27], a[96:99], a[56:59]
  v_mfma_f32_16x16x32_bf16 a[76:79], v[28:31], a[96:99], a[76:79]
  s_waitcnt lgkmcnt(6)
  v_mfma_f32_16x16x32_bf16 a[0:3], v[32:35], a[100:103], a[0:3]
  s_waitcnt lgkmcnt(4)
  v_mfma_f32_16x16x32_bf16 a[20:23], v[36:39], a[100:103], a[20:23]
  s_waitcnt lgkmcnt(2)
  v_mfma_f32_16x16x32_bf16 a[40:43], v[40:43], a[100:103], a[40:43]
  s_waitcnt lgkmcnt(0)
  v_mfma_f32_16x16x32_bf16 a[60:63], v[44:47], a[100:103], a[60:63]
  v_mfma_f32_16x16x32_bf16 a[4:7], v[32:35], a[104:107], a[4:7]
  v_mfma_f32_16x16x32_bf16 a[24:27], v[36:39], a[104:107], a[24:27]
  v_mfma_f32_16x16x32_bf16 a[44:47], v[40:43], a[104:107], a[44:47]
  v_mfma_f32_16x16x32_bf16 a[64:67], v[44:47], a[104:107], a[64:67]
  v_mfma_f32_16x16x32_bf16 a[8:11], v[32:35], a[108:111], a[8:11]
  v_mfma_f32_16x16x32_bf16 a[28:31], v[36:39], a[108:111], a[28:31]
  v_mfma_f32_16x16x32_bf16 a[48:51], v[40:43], a[108:111], a[48:51]
  v_mfma_f32_16x16x32_bf16 a[68:71], v[44:47], a[108:111], a[68:71]
  v_mfma_f32_16x16x32_bf16 a[12:15], v[32:35], a[112:115], a[12:15]
  v_mfma_f32_16x16x32_bf16 a[32:35], v[36:39], a[112:115], a[32:35]
  v_mfma_f32_16x16x32_bf16 a[52:55], v[40:43], a[112:115], a[52:55]
  v_mfma_f32_16x16x32_bf16 a[72:75], v[44:47], a[112:115], a[72:75]
  v_mfma_f32_16x16x32_bf16 a[16:19], v[32:35], a[116:119], a[16:19]
  v_mfma_f32_16x16x32_bf16 a[36:39], v[36:39], a[116:119], a[36:39]
  v_mfma_f32_16x16x32_bf16 a[56:59], v[40:43], a[116:119], a[56:59]
  v_mfma_f32_16x16x32_bf16 a[76:79], v[44:47], a[116:119], a[76:79]
  s_waitcnt vmcnt(0) lgkmcnt(0)
  v_mul_u32_u24 v4, 144, v3
  v_lshl_add_u32 v4, v2, 3, v4
  v_add_u32 v8, s97, v4
  v_lshrrev_b32 v4, 3, v1
  v_and_b32 v5, 7, v1
  v_mul_u32_u24 v6, 144, v4
  v_lshl_add_u32 v6, v5, 4, v6
  v_add_u32 v9, s97, v6
  v_mul_u32_u24 v6, 896, v4
  v_lshl_add_u32 v10, v5, 4, v6
  s_lshl_b32 s34, s70, 7
  v_accvgpr_read_b32 v16, a0
  v_accvgpr_read_b32 v17, a1
  v_accvgpr_read_b32 v18, a2
  v_accvgpr_read_b32 v19, a3
  v_accvgpr_read_b32 v20, a20
  v_accvgpr_read_b32 v21, a21
  v_accvgpr_read_b32 v22, a22
  v_accvgpr_read_b32 v23, a23
  v_accvgpr_read_b32 v24, a40
  v_accvgpr_read_b32 v25, a41
  v_accvgpr_read_b32 v26, a42
  v_accvgpr_read_b32 v27, a43
  v_accvgpr_read_b32 v28, a60
  v_accvgpr_read_b32 v29, a61
  v_accvgpr_read_b32 v30, a62
  v_accvgpr_read_b32 v31, a63
  v_accvgpr_read_b32 v32, a4
  v_accvgpr_read_b32 v33, a5
  v_accvgpr_read_b32 v34, a6
  v_accvgpr_read_b32 v35, a7
  v_accvgpr_read_b32 v36, a24
  v_accvgpr_read_b32 v37, a25
  v_accvgpr_read_b32 v38, a26
  v_accvgpr_read_b32 v39, a27
  v_accvgpr_read_b32 v40, a44
  v_accvgpr_read_b32 v41, a45
  v_accvgpr_read_b32 v42, a46
  v_accvgpr_read_b32 v43, a47
  v_accvgpr_read_b32 v44, a64
  v_accvgpr_read_b32 v45, a65
  v_accvgpr_read_b32 v46, a66
  v_accvgpr_read_b32 v47, a67
  v_accvgpr_read_b32 v48, a8
  v_accvgpr_read_b32 v49, a9
  v_accvgpr_read_b32 v50, a10
  v_accvgpr_read_b32 v51, a11
  v_accvgpr_read_b32 v52, a28
  v_accvgpr_read_b32 v53, a29
  v_accvgpr_read_b32 v54, a30
  v_accvgpr_read_b32 v55, a31
  v_accvgpr_read_b32 v56, a48
  v_accvgpr_read_b32 v57, a49
  v_accvgpr_read_b32 v58, a50
  v_accvgpr_read_b32 v59, a51
  v_accvgpr_read_b32 v60, a68
  v_accvgpr_read_b32 v61, a69
  v_accvgpr_read_b32 v62, a70
  v_accvgpr_read_b32 v63, a71
  v_accvgpr_read_b32 v64, a12
  v_accvgpr_read_b32 v65, a13
  v_accvgpr_read_b32 v66, a14
  v_accvgpr_read_b32 v67, a15
  v_accvgpr_read_b32 v68, a32
  v_accvgpr_read_b32 v69, a33
  v_accvgpr_read_b32 v70, a34
  v_accvgpr_read_b32 v71, a35
  v_accvgpr_read_b32 v72, a52
  v_accvgpr_read_b32 v73, a53
  v_accvgpr_read_b32 v74, a54
  v_accvgpr_read_b32 v75, a55
  v_accvgpr_read_b32 v76, a72
  v_accvgpr_read_b32 v77, a73
  v_accvgpr_read_b32 v78, a74
  v_accvgpr_read_b32 v79, a75
  v_accvgpr_read_b32 v80, a16
  v_accvgpr_read_b32 v81, a17
  v_accvgpr_read_b32 v82, a18
  v_accvgpr_read_b32 v83, a19
  v_accvgpr_read_b32 v84, a36
  v_accvgpr_read_b32 v85, a37
  v_accvgpr_read_b32 v86, a38
  v_accvgpr_read_b32 v87, a39
  v_accvgpr_read_b32 v88, a56
  v_accvgpr_read_b32 v89, a57
  v_accvgpr_read_b32 v90, a58
  v_accvgpr_read_b32 v91, a59
  v_accvgpr_read_b32 v92, a76
  v_accvgpr_read_b32 v93, a77
  v_accvgpr_read_b32 v94, a78
  v_accvgpr_read_b32 v95, a79
  v_cvt_pk_bf16_f32 v16, v16, v17
  v_cvt_pk_bf16_f32 v17, v18, v19
  v_cvt_pk_bf16_f32 v20, v20, v21
  v_cvt_pk_bf16_f32 v21, v22, v23
  v_cvt_pk_bf16_f32 v24, v24, v25
  v_cvt_pk_bf16_f32 v25, v26, v27
  v_cvt_pk_bf16_f32 v28, v28, v29
  v_cvt_pk_bf16_f32 v29, v30, v31
  v_cvt_pk_bf16_f32 v32, v32, v33
  v_cvt_pk_bf16_f32 v33, v34, v35
  v_cvt_pk_bf16_f32 v36, v36, v37
  v_cvt_pk_bf16_f32 v37, v38, v39
  v_cvt_pk_bf16_f32 v40, v40, v41
  v_cvt_pk_bf16_f32 v41, v42, v43
  v_cvt_pk_bf16_f32 v44, v44, v45
  v_cvt_pk_bf16_f32 v45, v46, v47
  v_cvt_pk_bf16_f32 v48, v48, v49
  v_cvt_pk_bf16_f32 v49, v50, v51
  v_cvt_pk_bf16_f32 v52, v52, v53
  v_cvt_pk_bf16_f32 v53, v54, v55
  v_cvt_pk_bf16_f32 v56, v56, v57
  v_cvt_pk_bf16_f32 v57, v58, v59
  v_cvt_pk_bf16_f32 v60, v60, v61
  v_cvt_pk_bf16_f32 v61, v62, v63
  v_cvt_pk_bf16_f32 v64, v64, v65
  v_cvt_pk_bf16_f32 v65, v66, v67
  v_cvt_pk_bf16_f32 v68, v68, v69
  v_cvt_pk_bf16_f32 v69, v70, v71
  v_cvt_pk_bf16_f32 v72, v72, v73
  v_cvt_pk_bf16_f32 v73, v74, v75
  v_cvt_pk_bf16_f32 v76, v76, v77
  v_cvt_pk_bf16_f32 v77, v78, v79
  v_cvt_pk_bf16_f32 v80, v80, v81
  v_cvt_pk_bf16_f32 v81, v82, v83
  v_cvt_pk_bf16_f32 v84, v84, v85
  v_cvt_pk_bf16_f32 v85, v86, v87
  v_cvt_pk_bf16_f32 v88, v88, v89
  v_cvt_pk_bf16_f32 v89, v90, v91
  v_cvt_pk_bf16_f32 v92, v92, v93
  v_cvt_pk_bf16_f32 v93, v94, v95
  ds_write_b64 v8, v[16:17]
  ds_write_b64 v8, v[20:21] offset:32
  ds_write_b64 v8, v[24:25] offset:64
  ds_write_b64 v8, v[28:29] offset:96
  ds_write_b64 v8, v[32:33] offset:2304
  ds_write_b64 v8, v[36:37] offset:2336
  ds_write_b64 v8, v[40:41] offset:2368
  ds_write_b64 v8, v[44:45] offset:2400
  ds_write_b64 v8, v[48:49] offset:4608
  ds_write_b64 v8, v[52:53] offset:4640
  ds_write_b64 v8, v[56:57] offset:4672
  ds_write_b64 v8, v[60:61] offset:4704
  ds_write_b64 v8, v[64:65] offset:6912
  ds_write_b64 v8, v[68:69] offset:6944
  ds_write_b64 v8, v[72:73] offset:6976
  ds_write_b64 v8, v[76:77] offset:7008
  ds_write_b64 v8, v[80:81] offset:9216
  ds_write_b64 v8, v[84:85] offset:9248
  ds_write_b64 v8, v[88:89] offset:9280
  ds_write_b64 v8, v[92:93] offset:9312
  ds_read_b128 v[16:19], v9
  ds_read_b128 v[20:23], v9 offset:1152
  ds_read_b128 v[24:27], v9 offset:2304
  ds_read_b128 v[28:31], v9 offset:3456
  ds_read_b128 v[32:35], v9 offset:4608
  ds_read_b128 v[36:39], v9 offset:5760
  ds_read_b128 v[40:43], v9 offset:6912
  ds_read_b128 v[44:47], v9 offset:8064
  ds_read_b128 v[48:51], v9 offset:9216
  ds_read_b128 v[52:55], v9 offset:10368
  s_add_u32 s35, s34, 0
  s_waitcnt lgkmcnt(9)
  buffer_store_dwordx4 v[16:19], v10, s[24:27], s35 offen
  s_add_u32 s35, s34, 7168
  s_waitcnt lgkmcnt(8)
  buffer_store_dwordx4 v[20:23], v10, s[24:27], s35 offen
  s_add_u32 s35, s34, 14336
  s_waitcnt lgkmcnt(7)
  buffer_store_dwordx4 v[24:27], v10, s[24:27], s35 offen
  s_add_u32 s35, s34, 21504
  s_waitcnt lgkmcnt(6)
  buffer_store_dwordx4 v[28:31], v10, s[24:27], s35 offen
  s_add_u32 s35, s34, 28672
  s_waitcnt lgkmcnt(5)
  buffer_store_dwordx4 v[32:35], v10, s[24:27], s35 offen
  s_add_u32 s35, s34, 35840
  s_waitcnt lgkmcnt(4)
  buffer_store_dwordx4 v[36:39], v10, s[24:27], s35 offen
  s_add_u32 s35, s34, 43008
  s_waitcnt lgkmcnt(3)
  buffer_store_dwordx4 v[40:43], v10, s[24:27], s35 offen
  s_add_u32 s35, s34, 50176
  s_waitcnt lgkmcnt(2)
  buffer_store_dwordx4 v[44:47], v10, s[24:27], s35 offen
  s_add_u32 s35, s34, 57344
  s_waitcnt lgkmcnt(1)
  buffer_store_dwordx4 v[48:51], v10, s[24:27], s35 offen
  s_add_u32 s35, s34, 64512
  s_waitcnt lgkmcnt(0)
  buffer_store_dwordx4 v[52:55], v10, s[24:27], s35 offen
  s_waitcnt vmcnt(0) lgkmcnt(0)
  s_endpgm
L_ROLE_P:
  s_mul_i32 s32, s70, 10240
  s_add_u32 s32, s32, 73728
  v_lshrrev_b32 v4, 2, v1
  v_lshrrev_b32 v5, 5, v1
  v_lshlrev_b32 v5, 1, v5
  v_and_b32 v6, 3, v1
  v_xor_b32 v5, v5, v6
  v_lshlrev_b32 v5, 4, v5
  v_lshlrev_b32 v4, 13, v4
  v_add_u32 v84, v4, v5
  s_lshl_b32 s34, s70, 6
  v_add_u32 v84, s34, v84
  s_add_u32 m0, s32, 0
  s_mov_b32 s35, 0
  buffer_load_dwordx4 v84, s[8:11], s35 offen lds
  s_add_u32 m0, s32, 1024
  s_mov_b32 s35, 131072
  buffer_load_dwordx4 v84, s[8:11], s35 offen lds
  s_mul_i32 s33, s70, 9
  s_add_u32 s34, s33, 0
  s_and_b32 s35, s34, 15
  v_xor_b32 v4, s35, v1
  v_lshlrev_b32 v4, 4, v4
  s_lshl_b32 m0, s34, 10
  s_mul_i32 s35, s34, 896
  buffer_load_dwordx4 v4, s[4:7], s35 offen lds
  s_add_u32 s34, s33, 1
  s_and_b32 s35, s34, 15
  v_xor_b32 v5, s35, v1
  v_lshlrev_b32 v5, 4, v5
  s_lshl_b32 m0, s34, 10
  s_mul_i32 s35, s34, 896
  buffer_load_dwordx4 v5, s[4:7], s35 offen lds
  s_add_u32 s34, s33, 2
  s_and_b32 s35, s34, 15
  v_xor_b32 v6, s35, v1
  v_lshlrev_b32 v6, 4, v6
  s_lshl_b32 m0, s34, 10
  s_mul_i32 s35, s34, 896
  buffer_load_dwordx4 v6, s[4:7], s35 offen lds
  s_add_u32 s34, s33, 3
  s_and_b32 s35, s34, 15
  v_xor_b32 v7, s35, v1
  v_lshlrev_b32 v7, 4, v7
  s_lshl_b32 m0, s34, 10
  s_mul_i32 s35, s34, 896
  buffer_load_dwordx4 v7, s[4:7], s35 offen lds
  s_add_u32 s34, s33, 4
  s_and_b32 s35, s34, 15
  v_xor_b32 v4, s35, v1
  v_lshlrev_b32 v4, 4, v4
  s_lshl_b32 m0, s34, 10
  s_mul_i32 s35, s34, 896
  buffer_load_dwordx4 v4, s[4:7], s35 offen lds
  s_add_u32 s34, s33, 5
  s_and_b32 s35, s34, 15
  v_xor_b32 v5, s35, v1
  v_lshlrev_b32 v5, 4, v5
  s_lshl_b32 m0, s34, 10
  s_mul_i32 s35, s34, 896
  buffer_load_dwordx4 v5, s[4:7], s35 offen lds
  s_add_u32 s34, s33, 6
  s_and_b32 s35, s34, 15
  v_xor_b32 v6, s35, v1
  v_lshlrev_b32 v6, 4, v6
  s_lshl_b32 m0, s34, 10
  s_mul_i32 s35, s34, 896
  buffer_load_dwordx4 v6, s[4:7], s35 offen lds
  s_add_u32 s34, s33, 7
  s_and_b32 s35, s34, 15
  v_xor_b32 v7, s35, v1
  v_lshlrev_b32 v7, 4, v7
  s_lshl_b32 m0, s34, 10
  s_mul_i32 s35, s34, 896
  buffer_load_dwordx4 v7, s[4:7], s35 offen lds
  s_add_u32 s34, s33, 8
  s_and_b32 s35, s34, 15
  v_xor_b32 v4, s35, v1
  v_lshlrev_b32 v4, 4, v4
  s_lshl_b32 m0, s34, 10
  s_mul_i32 s35, s34, 896
  buffer_load_dwordx4 v4, s[4:7], s35 offen lds
  s_add_u32 m0, s32, 2048
  s_mov_b32 s35, 262144
  buffer_load_dwordx4 v84, s[8:11], s35 offen lds
  s_add_u32 m0, s32, 3072
  s_mov_b32 s35, 393216
  buffer_load_dwordx4 v84, s[8:11], s35 offen lds
  s_add_u32 m0, s32, 4096
  s_mov_b32 s35, 524288
  buffer_load_dwordx4 v84, s[8:11], s35 offen lds
  s_add_u32 m0, s32, 5120
  s_mov_b32 s35, 655360
  buffer_load_dwordx4 v84, s[8:11], s35 offen lds
  s_add_u32 m0, s32, 6144
  s_mov_b32 s35, 786432
  buffer_load_dwordx4 v84, s[8:11], s35 offen lds
  s_add_u32 m0, s32, 7168
  s_mov_b32 s35, 917504
  buffer_load_dwordx4 v84, s[8:11], s35 offen lds
  s_add_u32 m0, s32, 8192
  s_mov_b32 s35, 1048576
  buffer_load_dwordx4 v84, s[8:11], s35 offen lds
  s_add_u32 m0, s32, 9216
  s_mov_b32 s35, 1179648
  buffer_load_dwordx4 v84, s[8:11], s35 offen lds
  v_lshrrev_b32 v4, 2, v3
  v_and_b32 v5, 3, v3
  v_lshlrev_b32 v6, 9, v2
  v_lshl_add_u32 v6, v4, 6, v6
  v_lshl_add_u32 v6, v5, 3, v6
  v_and_b32 v7, 1, v2
  v_lshl_add_u32 v6, v7, 5, v6
  v_add_u32 v80, s32, v6
  v_xor_b32 v81, 32, v80
  v_xor_b32 v4, v2, v3
  v_lshlrev_b32 v4, 4, v4
  v_lshl_add_u32 v72, v3, 10, v4
  v_xor_b32 v73, 64, v72
  v_xor_b32 v74, 128, v72
  v_xor_b32 v75, 192, v72
  v_min_u32 v5, 7, v3
  v_xor_b32 v4, v2, v5
  v_lshlrev_b32 v4, 4, v4
  v_lshl_add_u32 v76, v5, 10, v4
  v_add_u32 v76, 65536, v76
  v_xor_b32 v77, 64, v76
  v_xor_b32 v78, 128, v76
  v_xor_b32 v79, 192, v76
  s_waitcnt vmcnt(8)
  s_nop 0
  s_barrier
  ds_read_b64_tr_b16 a[0:1], v80
  ds_read_b64_tr_b16 a[2:3], v80 offset:256
  ds_read_b64_tr_b16 a[4:5], v81
  ds_read_b64_tr_b16 a[6:7], v81 offset:256
  ds_read_b128 a[16:19], v72
  ds_read_b128 a[20:23], v72 offset:16384
  ds_read_b128 a[24:27], v72 offset:32768
  ds_read_b128 a[28:31], v72 offset:49152
  ds_read_b128 a[32:35], v76
  s_waitcnt lgkmcnt(4)
  v_mfma_f32_16x16x32_bf16 v[16:19], a[0:3], a[16:19], 0
  s_waitcnt vmcnt(6)
  ds_read_b64_tr_b16 a[8:9], v80 offset:2048
  ds_read_b64_tr_b16 a[10:11], v80 offset:2304
  v_mfma_f32_16x16x32_bf16 v[36:39], a[4:7], a[16:19], 0
  ds_read_b64_tr_b16 a[12:13], v81 offset:2048
  ds_read_b64_tr_b16 a[14:15], v81 offset:2304
  s_waitcnt lgkmcnt(7)
  v_mfma_f32_16x16x32_bf16 v[20:23], a[0:3], a[20:23], 0
  s_add_u32 m0, s32, 0
  s_mov_b32 s35, 1310720
  buffer_load_dwordx4 v84, s[8:11], s35 offen lds
  v_mfma_f32_16x16x32_bf16 v[40:43], a[4:7], a[20:23], 0
  ds_read_b128 a[36:39], v73
  ds_read_b128 a[40:43], v73 offset:16384
  s_waitcnt lgkmcnt(8)
  v_mfma_f32_16x16x32_bf16 v[24:27], a[0:3], a[24:27], 0
  ds_read_b128 a[44:47], v73 offset:32768
  ds_read_b128 a[48:51], v73 offset:49152
  v_mfma_f32_16x16x32_bf16 v[44:47], a[4:7], a[24:27], 0
  s_add_u32 m0, s32, 1024
  s_mov_b32 s35, 1441792
  buffer_load_dwordx4 v84, s[8:11], s35 offen lds
  s_waitcnt lgkmcnt(9)
  v_mfma_f32_16x16x32_bf16 v[28:31], a[0:3], a[28:31], 0
  ds_read_b128 a[52:55], v77
  v_mfma_f32_16x16x32_bf16 v[48:51], a[4:7], a[28:31], 0
  s_waitcnt lgkmcnt(9)
  v_mfma_f32_16x16x32_bf16 v[32:35], a[0:3], a[32:35], 0
  v_mfma_f32_16x16x32_bf16 v[52:55], a[4:7], a[32:35], 0
  s_waitcnt lgkmcnt(4)
  v_mfma_f32_16x16x32_bf16 v[16:19], a[8:11], a[36:39], v[16:19]
  s_waitcnt vmcnt(6)
  ds_read_b64_tr_b16 a[0:1], v80 offset:4096
  ds_read_b64_tr_b16 a[2:3], v80 offset:4352
  v_mfma_f32_16x16x32_bf16 v[36:39], a[12:15], a[36:39], v[36:39]
  ds_read_b64_tr_b16 a[4:5], v81 offset:4096
  ds_read_b64_tr_b16 a[6:7], v81 offset:4352
  s_waitcnt lgkmcnt(7)
  v_mfma_f32_16x16x32_bf16 v[20:23], a[8:11], a[40:43], v[20:23]
  s_add_u32 m0, s32, 2048
  s_mov_b32 s35, 1572864
  buffer_load_dwordx4 v84, s[8:11], s35 offen lds
  v_mfma_f32_16x16x32_bf16 v[40:43], a[12:15], a[40:43], v[40:43]
  ds_read_b128 a[16:19], v74
  ds_read_b128 a[20:23], v74 offset:16384
  s_waitcnt lgkmcnt(8)
  v_mfma_f32_16x16x32_bf16 v[24:27], a[8:11], a[44:47], v[24:27]
  ds_read_b128 a[24:27], v74 offset:32768
  ds_read_b128 a[28:31], v74 offset:49152
  v_mfma_f32_16x16x32_bf16 v[44:47], a[12:15], a[44:47], v[44:47]
  s_add_u32 m0, s32, 3072
  s_mov_b32 s35, 1703936
  buffer_load_dwordx4 v84, s[8:11], s35 offen lds
  s_waitcnt lgkmcnt(9)
  v_mfma_f32_16x16x32_bf16 v[28:31], a[8:11], a[48:51], v[28:31]
  ds_read_b128 a[32:35], v78
  v_mfma_f32_16x16x32_bf16 v[48:51], a[12:15], a[48:51], v[48:51]
  s_waitcnt lgkmcnt(9)
  v_mfma_f32_16x16x32_bf16 v[32:35], a[8:11], a[52:55], v[32:35]
  v_mfma_f32_16x16x32_bf16 v[52:55], a[12:15], a[52:55], v[52:55]
  s_waitcnt lgkmcnt(4)
  v_mfma_f32_16x16x32_bf16 v[16:19], a[0:3], a[16:19], v[16:19]
  s_waitcnt vmcnt(6)
  ds_read_b64_tr_b16 a[8:9], v80 offset:6144
  ds_read_b64_tr_b16 a[10:11], v80 offset:6400
  v_mfma_f32_16x16x32_bf16 v[36:39], a[4:7], a[16:19], v[36:39]
  ds_read_b64_tr_b16 a[12:13], v81 offset:6144
  ds_read_b64_tr_b16 a[14:15], v81 offset:6400
  s_waitcnt lgkmcnt(7)
  v_mfma_f32_16x16x32_bf16 v[20:23], a[0:3], a[20:23], v[20:23]
  s_add_u32 m0, s32, 4096
  s_mov_b32 s35, 1835008
  buffer_load_dwordx4 v84, s[8:11], s35 offen lds
  v_mfma_f32_16x16x32_bf16 v[40:43], a[4:7], a[20:23], v[40:43]
  ds_read_b128 a[36:39], v75
  ds_read_b128 a[40:43], v75 offset:16384
  s_waitcnt lgkmcnt(8)
  v_mfma_f32_16x16x32_bf16 v[24:27], a[0:3], a[24:27], v[24:27]
  ds_read_b128 a[44:47], v75 offset:32768
  ds_read_b128 a[48:51], v75 offset:49152
  v_mfma_f32_16x16x32_bf16 v[44:47], a[4:7], a[24:27], v[44:47]
  s_add_u32 m0, s32, 5120
  s_mov_b32 s35, 1966080
  buffer_load_dwordx4 v84, s[8:11], s35 offen lds
  s_waitcnt lgkmcnt(9)
  v_mfma_f32_16x16x32_bf16 v[28:31], a[0:3], a[28:31], v[28:31]
  ds_read_b128 a[52:55], v79
  v_mfma_f32_16x16x32_bf16 v[48:51], a[4:7], a[28:31], v[48:51]
  s_waitcnt lgkmcnt(9)
  v_mfma_f32_16x16x32_bf16 v[32:35], a[0:3], a[32:35], v[32:35]
  v_mfma_f32_16x16x32_bf16 v[52:55], a[4:7], a[32:35], v[52:55]
  s_waitcnt lgkmcnt(4)
  v_mfma_f32_16x16x32_bf16 v[16:19], a[8:11], a[36:39], v[16:19]
  s_waitcnt vmcnt(6)
  ds_read_b64_tr_b16 a[0:1], v80 offset:8192
  ds_read_b64_tr_b16 a[2:3], v80 offset:8448
  v_mfma_f32_16x16x32_bf16 v[36:39], a[12:15], a[36:39], v[36:39]
  ds_read_b64_tr_b16 a[4:5], v81 offset:8192
  ds_read_b64_tr_b16 a[6:7], v81 offset:8448
  s_waitcnt lgkmcnt(7)
  v_mfma_f32_16x16x32_bf16 v[20:23], a[8:11], a[40:43], v[20:23]
  s_add_u32 m0, s32, 6144
  s_mov_b32 s35, 2097152
  buffer_load_dwordx4 v84, s[8:11], s35 offen lds
  v_mfma_f32_16x16x32_bf16 v[40:43], a[12:15], a[40:43], v[40:43]
  ds_read_b128 a[16:19], v72 offset:256
  ds_read_b128 a[20:23], v72 offset:16640
  s_waitcnt lgkmcnt(8)
  v_mfma_f32_16x16x32_bf16 v[24:27], a[8:11], a[44:47], v[24:27]
  ds_read_b128 a[24:27], v72 offset:33024
  ds_read_b128 a[28:31], v72 offset:49408
  v_mfma_f32_16x16x32_bf16 v[44:47], a[12:15], a[44:47], v[44:47]
  s_add_u32 m0, s32, 7168
  s_mov_b32 s35, 2228224
  buffer_load_dwordx4 v84, s[8:11], s35 offen lds
  s_waitcnt lgkmcnt(9)
  v_mfma_f32_16x16x32_bf16 v[28:31], a[8:11], a[48:51], v[28:31]
  ds_read_b128 a[32:35], v76 offset:256
  v_mfma_f32_16x16x32_bf16 v[48:51], a[12:15], a[48:51], v[48:51]
  s_waitcnt lgkmcnt(9)
  v_mfma_f32_16x16x32_bf16 v[32:35], a[8:11], a[52:55], v[32:35]
  v_mfma_f32_16x16x32_bf16 v[52:55], a[12:15], a[52:55], v[52:55]
  s_waitcnt lgkmcnt(4)
  v_mfma_f32_16x16x32_bf16 v[16:19], a[0:3], a[16:19], v[16:19]
  s_waitcnt vmcnt(6)
  ds_read_b64_tr_b16 a[8:9], v80
  ds_read_b64_tr_b16 a[10:11], v80 offset:256
  v_mfma_f32_16x16x32_bf16 v[36:39], a[4:7], a[16:19], v[36:39]
  ds_read_b64_tr_b16 a[12:13], v81
  ds_read_b64_tr_b16 a[14:15], v81 offset:256
  s_waitcnt lgkmcnt(7)
  v_mfma_f32_16x16x32_bf16 v[20:23], a[0:3], a[20:23], v[20:23]
  s_add_u32 m0, s32, 8192
  s_mov_b32 s35, 2359296
  buffer_load_dwordx4 v84, s[8:11], s35 offen lds
  v_mfma_f32_16x16x32_bf16 v[40:43], a[4:7], a[20:23], v[40:43]
  ds_read_b128 a[36:39], v73 offset:256
  ds_read_b128 a[40:43], v73 offset:16640
  s_waitcnt lgkmcnt(8)
  v_mfma_f32_16x16x32_bf16 v[24:27], a[0:3], a[24:27], v[24:27]
  ds_read_b128 a[44:47], v73 offset:33024
  ds_read_b128 a[48:51], v73 offset:49408
  v_mfma_f32_16x16x32_bf16 v[44:47], a[4:7], a[24:27], v[44:47]
  s_add_u32 m0, s32, 9216
  s_mov_b32 s35, 2490368
  buffer_load_dwordx4 v84, s[8:11], s35 offen lds
  s_waitcnt lgkmcnt(9)
  v_mfma_f32_16x16x32_bf16 v[28:31], a[0:3], a[28:31], v[28:31]
  ds_read_b128 a[52:55], v77 offset:256
  v_mfma_f32_16x16x32_bf16 v[48:51], a[4:7], a[28:31], v[48:51]
  s_waitcnt lgkmcnt(9)
  v_mfma_f32_16x16x32_bf16 v[32:35], a[0:3], a[32:35], v[32:35]
  v_mfma_f32_16x16x32_bf16 v[52:55], a[4:7], a[32:35], v[52:55]
  s_waitcnt lgkmcnt(4)
  v_mfma_f32_16x16x32_bf16 v[16:19], a[8:11], a[36:39], v[16:19]
  s_waitcnt vmcnt(6)
  ds_read_b64_tr_b16 a[0:1], v80 offset:2048
  ds_read_b64_tr_b16 a[2:3], v80 offset:2304
  v_mfma_f32_16x16x32_bf16 v[36:39], a[12:15], a[36:39], v[36:39]
  ds_read_b64_tr_b16 a[4:5], v81 offset:2048
  ds_read_b64_tr_b16 a[6:7], v81 offset:2304
  s_waitcnt lgkmcnt(7)
  v_mfma_f32_16x16x32_bf16 v[20:23], a[8:11], a[40:43], v[20:23]
  s_add_u32 m0, s32, 0
  s_mov_b32 s35, 2621440
  buffer_load_dwordx4 v84, s[8:11], s35 offen lds
  v_mfma_f32_16x16x32_bf16 v[40:43], a[12:15], a[40:43], v[40:43]
  ds_read_b128 a[16:19], v74 offset:256
  ds_read_b128 a[20:23], v74 offset:16640
  s_waitcnt lgkmcnt(8)
  v_mfma_f32_16x16x32_bf16 v[24:27], a[8:11], a[44:47], v[24:27]
  ds_read_b128 a[24:27], v74 offset:33024
  ds_read_b128 a[28:31], v74 offset:49408
  v_mfma_f32_16x16x32_bf16 v[44:47], a[12:15], a[44:47], v[44:47]
  s_add_u32 m0, s32, 1024
  s_mov_b32 s35, 2752512
  buffer_load_dwordx4 v84, s[8:11], s35 offen lds
  s_waitcnt lgkmcnt(9)
  v_mfma_f32_16x16x32_bf16 v[28:31], a[8:11], a[48:51], v[28:31]
  ds_read_b128 a[32:35], v78 offset:256
  v_mfma_f32_16x16x32_bf16 v[48:51], a[12:15], a[48:51], v[48:51]
  s_waitcnt lgkmcnt(9)
  v_mfma_f32_16x16x32_bf16 v[32:35], a[8:11], a[52:55], v[32:35]
  v_mfma_f32_16x16x32_bf16 v[52:55], a[12:15], a[52:55], v[52:55]
  s_waitcnt lgkmcnt(4)
  v_mfma_f32_16x16x32_bf16 v[16:19], a[0:3], a[16:19], v[16:19]
  s_waitcnt vmcnt(6)
  ds_read_b64_tr_b16 a[8:9], v80 offset:4096
  ds_read_b64_tr_b16 a[10:11], v80 offset:4352
  v_mfma_f32_16x16x32_bf16 v[36:39], a[4:7], a[16:19], v[36:39]
  ds_read_b64_tr_b16 a[12:13], v81 offset:4096
  ds_read_b64_tr_b16 a[14:15], v81 offset:4352
  s_waitcnt lgkmcnt(7)
  v_mfma_f32_16x16x32_bf16 v[20:23], a[0:3], a[20:23], v[20:23]
  s_add_u32 m0, s32, 2048
  s_mov_b32 s35, 2883584
  buffer_load_dwordx4 v84, s[8:11], s35 offen lds
  v_mfma_f32_16x16x32_bf16 v[40:43], a[4:7], a[20:23], v[40:43]
  ds_read_b128 a[36:39], v75 offset:256
  ds_read_b128 a[40:43], v75 offset:16640
  s_waitcnt lgkmcnt(8)
  v_mfma_f32_16x16x32_bf16 v[24:27], a[0:3], a[24:27], v[24:27]
  ds_read_b128 a[44:47], v75 offset:33024
  ds_read_b128 a[48:51], v75 offset:49408
  v_mfma_f32_16x16x32_bf16 v[44:47], a[4:7], a[24:27], v[44:47]
  s_add_u32 m0, s32, 3072
  s_mov_b32 s35, 3014656
  buffer_load_dwordx4 v84, s[8:11], s35 offen lds
  s_waitcnt lgkmcnt(9)
  v_mfma_f32_16x16x32_bf16 v[28:31], a[0:3], a[28:31], v[28:31]
  ds_read_b128 a[52:55], v79 offset:256
  v_mfma_f32_16x16x32_bf16 v[48:51], a[4:7], a[28:31], v[48:51]
  s_waitcnt lgkmcnt(9)
  v_mfma_f32_16x16x32_bf16 v[32:35], a[0:3], a[32:35], v[32:35]
  v_mfma_f32_16x16x32_bf16 v[52:55], a[4:7], a[32:35], v[52:55]
  s_waitcnt lgkmcnt(4)
  v_mfma_f32_16x16x32_bf16 v[16:19], a[8:11], a[36:39], v[16:19]
  s_waitcnt vmcnt(6)
  ds_read_b64_tr_b16 a[0:1], v80 offset:6144
  ds_read_b64_tr_b16 a[2:3], v80 offset:6400
  v_mfma_f32_16x16x32_bf16 v[36:39], a[12:15], a[36:39], v[36:39]
  ds_read_b64_tr_b16 a[4:5], v81 offset:6144
  ds_read_b64_tr_b16 a[6:7], v81 offset:6400
  s_waitcnt lgkmcnt(7)
  v_mfma_f32_16x16x32_bf16 v[20:23], a[8:11], a[40:43], v[20:23]
  s_add_u32 m0, s32, 4096
  s_mov_b32 s35, 3145728
  buffer_load_dwordx4 v84, s[8:11], s35 offen lds
  v_mfma_f32_16x16x32_bf16 v[40:43], a[12:15], a[40:43], v[40:43]
  ds_read_b128 a[16:19], v72 offset:512
  ds_read_b128 a[20:23], v72 offset:16896
  s_waitcnt lgkmcnt(8)
  v_mfma_f32_16x16x32_bf16 v[24:27], a[8:11], a[44:47], v[24:27]
  ds_read_b128 a[24:27], v72 offset:33280
  ds_read_b128 a[28:31], v72 offset:49664
  v_mfma_f32_16x16x32_bf16 v[44:47], a[12:15], a[44:47], v[44:47]
  s_add_u32 m0, s32, 5120
  s_mov_b32 s35, 3276800
  buffer_load_dwordx4 v84, s[8:11], s35 offen lds
  s_waitcnt lgkmcnt(9)
  v_mfma_f32_16x16x32_bf16 v[28:31], a[8:11], a[48:51], v[28:31]
  ds_read_b128 a[32:35], v76 offset:512
  v_mfma_f32_16x16x32_bf16 v[48:51], a[12:15], a[48:51], v[48:51]
  s_waitcnt lgkmcnt(9)
  v_mfma_f32_16x16x32_bf16 v[32:35], a[8:11], a[52:55], v[32:35]
  v_mfma_f32_16x16x32_bf16 v[52:55], a[12:15], a[52:55], v[52:55]
  s_waitcnt lgkmcnt(4)
  v_mfma_f32_16x16x32_bf16 v[16:19], a[0:3], a[16:19], v[16:19]
  s_waitcnt vmcnt(6)
  ds_read_b64_tr_b16 a[8:9], v80 offset:8192
  ds_read_b64_tr_b16 a[10:11], v80 offset:8448
  v_mfma_f32_16x16x32_bf16 v[36:39], a[4:7], a[16:19], v[36:39]
  ds_read_b64_tr_b16 a[12:13], v81 offset:8192
  ds_read_b64_tr_b16 a[14:15], v81 offset:8448
  s_waitcnt lgkmcnt(7)
  v_mfma_f32_16x16x32_bf16 v[20:23], a[0:3], a[20:23], v[20:23]
  s_add_u32 m0, s32, 6144
  s_mov_b32 s35, 3407872
  buffer_load_dwordx4 v84, s[8:11], s35 offen lds
  v_mfma_f32_16x16x32_bf16 v[40:43], a[4:7], a[20:23], v[40:43]
  ds_read_b128 a[36:39], v73 offset:512
  ds_read_b128 a[40:43], v73 offset:16896
  s_waitcnt lgkmcnt(8)
  v_mfma_f32_16x16x32_bf16 v[24:27], a[0:3], a[24:27], v[24:27]
  ds_read_b128 a[44:47], v73 offset:33280
  ds_read_b128 a[48:51], v73 offset:49664
  v_mfma_f32_16x16x32_bf16 v[44:47], a[4:7], a[24:27], v[44:47]
  s_add_u32 m0, s32, 7168
  s_mov_b32 s35, 3538944
  buffer_load_dwordx4 v84, s[8:11], s35 offen lds
  s_waitcnt lgkmcnt(9)
  v_mfma_f32_16x16x32_bf16 v[28:31], a[0:3], a[28:31], v[28:31]
  ds_read_b128 a[52:55], v77 offset:512
  v_mfma_f32_16x16x32_bf16 v[48:51], a[4:7], a[28:31], v[48:51]
  s_waitcnt lgkmcnt(9)
  v_mfma_f32_16x16x32_bf16 v[32:35], a[0:3], a[32:35], v[32:35]
  v_mfma_f32_16x16x32_bf16 v[52:55], a[4:7], a[32:35], v[52:55]
  s_waitcnt lgkmcnt(4)
  v_mfma_f32_16x16x32_bf16 v[16:19], a[8:11], a[36:39], v[16:19]
  s_waitcnt vmcnt(6)
  ds_read_b64_tr_b16 a[0:1], v80
  ds_read_b64_tr_b16 a[2:3], v80 offset:256
  v_mfma_f32_16x16x32_bf16 v[36:39], a[12:15], a[36:39], v[36:39]
  ds_read_b64_tr_b16 a[4:5], v81
  ds_read_b64_tr_b16 a[6:7], v81 offset:256
  s_waitcnt lgkmcnt(7)
  v_mfma_f32_16x16x32_bf16 v[20:23], a[8:11], a[40:43], v[20:23]
  ds_read_b128 a[16:19], v74 offset:512
  ds_read_b128 a[20:23], v74 offset:16896
  v_mfma_f32_16x16x32_bf16 v[40:43], a[12:15], a[40:43], v[40:43]
  ds_read_b128 a[24:27], v74 offset:33280
  ds_read_b128 a[28:31], v74 offset:49664
  s_waitcnt lgkmcnt(10)
  v_mfma_f32_16x16x32_bf16 v[24:27], a[8:11], a[44:47], v[24:27]
  ds_read_b128 a[32:35], v78 offset:512
  v_mfma_f32_16x16x32_bf16 v[44:47], a[12:15], a[44:47], v[44:47]
  s_waitcnt lgkmcnt(10)
  v_mfma_f32_16x16x32_bf16 v[28:31], a[8:11], a[48:51], v[28:31]
  v_mfma_f32_16x16x32_bf16 v[48:51], a[12:15], a[48:51], v[48:51]
  s_waitcnt lgkmcnt(9)
  v_mfma_f32_16x16x32_bf16 v[32:35], a[8:11], a[52:55], v[32:35]
  v_mfma_f32_16x16x32_bf16 v[52:55], a[12:15], a[52:55], v[52:55]
  s_waitcnt lgkmcnt(4)
  v_mfma_f32_16x16x32_bf16 v[16:19], a[0:3], a[16:19], v[16:19]
  s_waitcnt vmcnt(4)
  ds_read_b64_tr_b16 a[8:9], v80 offset:2048
  ds_read_b64_tr_b16 a[10:11], v80 offset:2304
  v_mfma_f32_16x16x32_bf16 v[36:39], a[4:7], a[16:19], v[36:39]
  ds_read_b64_tr_b16 a[12:13], v81 offset:2048
  ds_read_b64_tr_b16 a[14:15], v81 offset:2304
  s_waitcnt lgkmcnt(7)
  v_mfma_f32_16x16x32_bf16 v[20:23], a[0:3], a[20:23], v[20:23]
  ds_read_b128 a[36:39], v75 offset:512
  ds_read_b128 a[40:43], v75 offset:16896
  v_mfma_f32_16x16x32_bf16 v[40:43], a[4:7], a[20:23], v[40:43]
  ds_read_b128 a[44:47], v75 offset:33280
  ds_read_b128 a[48:51], v75 offset:49664
  s_waitcnt lgkmcnt(10)
  v_mfma_f32_16x16x32_bf16 v[24:27], a[0:3], a[24:27], v[24:27]
  ds_read_b128 a[52:55], v79 offset:512
  v_mfma_f32_16x16x32_bf16 v[44:47], a[4:7], a[24:27], v[44:47]
  s_waitcnt lgkmcnt(10)
  v_mfma_f32_16x16x32_bf16 v[28:31], a[0:3], a[28:31], v[28:31]
  v_mfma_f32_16x16x32_bf16 v[48:51], a[4:7], a[28:31], v[48:51]
  s_waitcnt lgkmcnt(9)
  v_mfma_f32_16x16x32_bf16 v[32:35], a[0:3], a[32:35], v[32:35]
  v_mfma_f32_16x16x32_bf16 v[52:55], a[4:7], a[32:35], v[52:55]
  s_waitcnt lgkmcnt(4)
  v_mfma_f32_16x16x32_bf16 v[16:19], a[8:11], a[36:39], v[16:19]
  s_waitcnt vmcnt(2)
  ds_read_b64_tr_b16 a[0:1], v80 offset:4096
  ds_read_b64_tr_b16 a[2:3], v80 offset:4352
  v_mfma_f32_16x16x32_bf16 v[36:39], a[12:15], a[36:39], v[36:39]
  ds_read_b64_tr_b16 a[4:5], v81 offset:4096
  ds_read_b64_tr_b16 a[6:7], v81 offset:4352
  s_waitcnt lgkmcnt(7)
  v_mfma_f32_16x16x32_bf16 v[20:23], a[8:11], a[40:43], v[20:23]
  ds_read_b128 a[16:19], v72 offset:768
  ds_read_b128 a[20:23], v72 offset:17152
  v_mfma_f32_16x16x32_bf16 v[40:43], a[12:15], a[40:43], v[40:43]
  ds_read_b128 a[24:27], v72 offset:33536
  ds_read_b128 a[28:31], v72 offset:49920
  s_waitcnt lgkmcnt(10)
  v_mfma_f32_16x16x32_bf16 v[24:27], a[8:11], a[44:47], v[24:27]
  ds_read_b128 a[32:35], v76 offset:768
  v_mfma_f32_16x16x32_bf16 v[44:47], a[12:15], a[44:47], v[44:47]
  s_waitcnt lgkmcnt(10)
  v_mfma_f32_16x16x32_bf16 v[28:31], a[8:11], a[48:51], v[28:31]
  v_mfma_f32_16x16x32_bf16 v[48:51], a[12:15], a[48:51], v[48:51]
  s_waitcnt lgkmcnt(9)
  v_mfma_f32_16x16x32_bf16 v[32:35], a[8:11], a[52:55], v[32:35]
  v_mfma_f32_16x16x32_bf16 v[52:55], a[12:15], a[52:55], v[52:55]
  s_waitcnt lgkmcnt(4)
  v_mfma_f32_16x16x32_bf16 v[16:19], a[0:3], a[16:19], v[16:19]
  s_waitcnt vmcnt(0)
  ds_read_b64_tr_b16 a[8:9], v80 offset:6144
  ds_read_b64_tr_b16 a[10:11], v80 offset:6400
  v_mfma_f32_16x16x32_bf16 v[36:39], a[4:7], a[16:19], v[36:39]
  ds_read_b64_tr_b16 a[12:13], v81 offset:6144
  ds_read_b64_tr_b16 a[14:15], v81 offset:6400
  s_waitcnt lgkmcnt(7)
  v_mfma_f32_16x16x32_bf16 v[20:23], a[0:3], a[20:23], v[20:23]
  ds_read_b128 a[36:39], v73 offset:768
  ds_read_b128 a[40:43], v73 offset:17152
  v_mfma_f32_16x16x32_bf16 v[40:43], a[4:7], a[20:23], v[40:43]
  ds_read_b128 a[44:47], v73 offset:33536
  ds_read_b128 a[48:51], v73 offset:49920
  s_waitcnt lgkmcnt(10)
  v_mfma_f32_16x16x32_bf16 v[24:27], a[0:3], a[24:27], v[24:27]
  ds_read_b128 a[52:55], v77 offset:768
  v_mfma_f32_16x16x32_bf16 v[44:47], a[4:7], a[24:27], v[44:47]
  s_waitcnt lgkmcnt(10)
  v_mfma_f32_16x16x32_bf16 v[28:31], a[0:3], a[28:31], v[28:31]
  v_mfma_f32_16x16x32_bf16 v[48:51], a[4:7], a[28:31], v[48:51]
  s_waitcnt lgkmcnt(9)
  v_mfma_f32_16x16x32_bf16 v[32:35], a[0:3], a[32:35], v[32:35]
  v_mfma_f32_16x16x32_bf16 v[52:55], a[4:7], a[32:35], v[52:55]
  s_waitcnt lgkmcnt(4)
  v_mfma_f32_16x16x32_bf16 v[16:19], a[8:11], a[36:39], v[16:19]
  v_mfma_f32_16x16x32_bf16 v[36:39], a[12:15], a[36:39], v[36:39]
  s_waitcnt lgkmcnt(3)
  v_mfma_f32_16x16x32_bf16 v[20:23], a[8:11], a[40:43], v[20:23]
  v_mfma_f32_16x16x32_bf16 v[40:43], a[12:15], a[40:43], v[40:43]
  s_waitcnt lgkmcnt(2)
  v_mfma_f32_16x16x32_bf16 v[24:27], a[8:11], a[44:47], v[24:27]
  v_mfma_f32_16x16x32_bf16 v[44:47], a[12:15], a[44:47], v[44:47]
  s_waitcnt lgkmcnt(1)
  v_mfma_f32_16x16x32_bf16 v[28:31], a[8:11], a[48:51], v[28:31]
  v_mfma_f32_16x16x32_bf16 v[48:51], a[12:15], a[48:51], v[48:51]
  s_waitcnt lgkmcnt(0)
  v_mfma_f32_16x16x32_bf16 v[32:35], a[8:11], a[52:55], v[32:35]
  v_mfma_f32_16x16x32_bf16 v[52:55], a[12:15], a[52:55], v[52:55]
  s_waitcnt lgkmcnt(0)
  s_barrier
  v_lshrrev_b32 v4, 1, v2
  s_lshl_b32 s34, s70, 2
  v_add_u32 v4, s34, v4
  v_xor_b32 v4, v4, v3
  v_lshlrev_b32 v4, 4, v4
  v_lshl_add_u32 v4, v3, 9, v4
  v_and_b32 v5, 1, v2
  v_lshl_add_u32 v4, v5, 3, v4
  v_add_u32 v72, 90112, v4
  v_xor_b32 v73, 32, v72
  v_mul_f32 v16, s49, v16
  v_mul_f32 v17, s49, v17
  v_mul_f32 v18, s49, v18
  v_mul_f32 v19, s49, v19
  v_cvt_pk_bf16_f32 v16, v16, v17
  v_cvt_pk_bf16_f32 v17, v18, v19
  ds_write_b64 v72, v[16:17]
  v_mul_f32 v36, s49, v36
  v_mul_f32 v37, s49, v37
  v_mul_f32 v38, s49, v38
  v_mul_f32 v39, s49, v39
  v_cvt_pk_bf16_f32 v36, v36, v37
  v_cvt_pk_bf16_f32 v37, v38, v39
  ds_write_b64 v73, v[36:37]
  v_mul_f32 v20, s49, v20
  v_mul_f32 v21, s49, v21
  v_mul_f32 v22, s49, v22
  v_mul_f32 v23, s49, v23
  v_cvt_pk_bf16_f32 v20, v20, v21
  v_cvt_pk_bf16_f32 v21, v22, v23
  ds_write_b64 v72, v[20:21] offset:8192
  v_mul_f32 v40, s49, v40
  v_mul_f32 v41, s49, v41
  v_mul_f32 v42, s49, v42
  v_mul_f32 v43, s49, v43
  v_cvt_pk_bf16_f32 v40, v40, v41
  v_cvt_pk_bf16_f32 v41, v42, v43
  ds_write_b64 v73, v[40:41] offset:8192
  v_mul_f32 v24, s49, v24
  v_mul_f32 v25, s49, v25
  v_mul_f32 v26, s49, v26
  v_mul_f32 v27, s49, v27
  v_cvt_pk_bf16_f32 v24, v24, v25
  v_cvt_pk_bf16_f32 v25, v26, v27
  ds_write_b64 v72, v[24:25] offset:16384
  v_mul_f32 v44, s49, v44
  v_mul_f32 v45, s49, v45
  v_mul_f32 v46, s49, v46
  v_mul_f32 v47, s49, v47
  v_cvt_pk_bf16_f32 v44, v44, v45
  v_cvt_pk_bf16_f32 v45, v46, v47
  ds_write_b64 v73, v[44:45] offset:16384
  v_mul_f32 v28, s49, v28
  v_mul_f32 v29, s49, v29
  v_mul_f32 v30, s49, v30
  v_mul_f32 v31, s49, v31
  v_cvt_pk_bf16_f32 v28, v28, v29
  v_cvt_pk_bf16_f32 v29, v30, v31
  ds_write_b64 v72, v[28:29] offset:24576
  v_mul_f32 v48, s49, v48
  v_mul_f32 v49, s49, v49
  v_mul_f32 v50, s49, v50
  v_mul_f32 v51, s49, v51
  v_cvt_pk_bf16_f32 v48, v48, v49
  v_cvt_pk_bf16_f32 v49, v50, v51
  ds_write_b64 v73, v[48:49] offset:24576
  v_mul_f32 v32, s49, v32
  v_mul_f32 v33, s49, v33
  v_mul_f32 v34, s49, v34
  v_mul_f32 v35, s49, v35
  v_cvt_pk_bf16_f32 v32, v32, v33
  v_cvt_pk_bf16_f32 v33, v34, v35
  ds_write_b64 v72, v[32:33] offset:32768
  v_mul_f32 v52, s49, v52
  v_mul_f32 v53, s49, v53
  v_mul_f32 v54, s49, v54
  v_mul_f32 v55, s49, v55
  v_cvt_pk_bf16_f32 v52, v52, v53
  v_cvt_pk_bf16_f32 v53, v54, v55
  ds_write_b64 v73, v[52:53] offset:32768
  s_waitcnt lgkmcnt(0)
  s_barrier
  s_lshl_b32 s32, s28, 14
  s_add_u32 s32, s32, 90112
  v_lshrrev_b32 v5, 1, v3
  v_xor_b32 v4, v2, v5
  v_lshlrev_b32 v4, 4, v4
  v_lshl_add_u32 v4, v3, 7, v4
  s_add_u32 s99, s29, s28
  s_add_u32 s34, s99, 0
  s_and_b32 s34, s34, 1
  s_lshl_b32 s34, s34, 6
  v_xor_b32 v9, s34, v4
  s_add_u32 s34, s99, 1
  s_and_b32 s34, s34, 1
  s_lshl_b32 s34, s34, 6
  v_xor_b32 v10, s34, v4
  v_lshrrev_b32 v4, 2, v3
  v_and_b32 v5, 3, v3
  v_lshl_add_u32 v6, v2, 2, v4
  v_and_b32 v7, 6, v6
  v_lshlrev_b32 v6, 7, v6
  v_lshl_add_u32 v6, v7, 4, v6
  v_lshl_add_u32 v6, v5, 3, v6
  v_add_u32 v13, s32, v6
  v_xor_b32 v14, 32, v13
  v_xor_b32 v15, 64, v13
  v_xor_b32 v16, 96, v13
  v_lshrrev_b32 v4, 3, v1
  v_and_b32 v5, 6, v4
  v_and_b32 v6, 7, v1
  v_xor_b32 v5, v5, v6
  v_lshlrev_b32 v5, 4, v5
  v_lshl_add_u32 v4, v4, 9, v5
  s_lshl_b32 s34, s28, 7
  v_add_u32 v8, s34, v4
  v_lshlrev_b32 v17, 4, v3
  v_accvgpr_write_b32 a0, 0
  v_accvgpr_write_b32 a1, 0
  v_accvgpr_write_b32 a2, 0
  v_accvgpr_write_b32 a3, 0
  v_accvgpr_write_b32 a4, 0
  v_accvgpr_write_b32 a5, 0
  v_accvgpr_write_b32 a6, 0
  v_accvgpr_write_b32 a7, 0
  v_accvgpr_write_b32 a8, 0
  v_accvgpr_write_b32 a9, 0
  v_accvgpr_write_b32 a10, 0
  v_accvgpr_write_b32 a11, 0
  v_accvgpr_write_b32 a12, 0
  v_accvgpr_write_b32 a13, 0
  v_accvgpr_write_b32 a14, 0
  v_accvgpr_write_b32 a15, 0
  v_accvgpr_write_b32 a16, 0
  v_accvgpr_write_b32 a17, 0
  v_accvgpr_write_b32 a18, 0
  v_accvgpr_write_b32 a19, 0
  v_accvgpr_write_b32 a20, 0
  v_accvgpr_write_b32 a21, 0
  v_accvgpr_write_b32 a22, 0
  v_accvgpr_write_b32 a23, 0
  v_accvgpr_write_b32 a24, 0
  v_accvgpr_write_b32 a25, 0
  v_accvgpr_write_b32 a26, 0
  v_accvgpr_write_b32 a27, 0
  v_accvgpr_write_b32 a28, 0
  v_accvgpr_write_b32 a29, 0
  v_accvgpr_write_b32 a30, 0
  v_accvgpr_write_b32 a31, 0
  v_accvgpr_write_b32 a32, 0
  v_accvgpr_write_b32 a33, 0
  v_accvgpr_write_b32 a34, 0
  v_accvgpr_write_b32 a35, 0
  v_accvgpr_write_b32 a36, 0
  v_accvgpr_write_b32 a37, 0
  v_accvgpr_write_b32 a38, 0
  v_accvgpr_write_b32 a39, 0
  v_accvgpr_write_b32 a40, 0
  v_accvgpr_write_b32 a41, 0
  v_accvgpr_write_b32 a42, 0
  v_accvgpr_write_b32 a43, 0
  v_accvgpr_write_b32 a44, 0
  v_accvgpr_write_b32 a45, 0
  v_accvgpr_write_b32 a46, 0
  v_accvgpr_write_b32 a47, 0
  v_accvgpr_write_b32 a48, 0
  v_accvgpr_write_b32 a49, 0
  v_accvgpr_write_b32 a50, 0
  v_accvgpr_write_b32 a51, 0
  v_accvgpr_write_b32 a52, 0
  v_accvgpr_write_b32 a53, 0
  v_accvgpr_write_b32 a54, 0
  v_accvgpr_write_b32 a55, 0
  v_accvgpr_write_b32 a56, 0
  v_accvgpr_write_b32 a57, 0
  v_accvgpr_write_b32 a58, 0
  v_accvgpr_write_b32 a59, 0
  v_accvgpr_write_b32 a60, 0
  v_accvgpr_write_b32 a61, 0
  v_accvgpr_write_b32 a62, 0
  v_accvgpr_write_b32 a63, 0
  v_accvgpr_write_b32 a64, 0
  v_accvgpr_write_b32 a65, 0
  v_accvgpr_write_b32 a66, 0
  v_accvgpr_write_b32 a67, 0
  v_accvgpr_write_b32 a68, 0
  v_accvgpr_write_b32 a69, 0
  v_accvgpr_write_b32 a70, 0
  v_accvgpr_write_b32 a71, 0
  v_accvgpr_write_b32 a72, 0
  v_accvgpr_write_b32 a73, 0
  v_accvgpr_write_b32 a74, 0
  v_accvgpr_write_b32 a75, 0
  v_accvgpr_write_b32 a76, 0
  v_accvgpr_write_b32 a77, 0
  v_accvgpr_write_b32 a78, 0
  v_accvgpr_write_b32 a79, 0
  v_accvgpr_write_b32 a80, 0
  v_accvgpr_write_b32 a81, 0
  v_accvgpr_write_b32 a82, 0
  v_accvgpr_write_b32 a83, 0
  v_accvgpr_write_b32 a84, 0
  v_accvgpr_write_b32 a85, 0
  v_accvgpr_write_b32 a86, 0
  v_accvgpr_write_b32 a87, 0
  v_accvgpr_write_b32 a88, 0
  v_accvgpr_write_b32 a89, 0
  v_accvgpr_write_b32 a90, 0
  v_accvgpr_write_b32 a91, 0
  v_accvgpr_write_b32 a92, 0
  v_accvgpr_write_b32 a93, 0
  v_accvgpr_write_b32 a94, 0
  v_accvgpr_write_b32 a95, 0
  v_accvgpr_write_b32 a96, 0
  v_accvgpr_write_b32 a97, 0
  v_accvgpr_write_b32 a98, 0
  v_accvgpr_write_b32 a99, 0
  v_mov_b32 v4, 0x3f003f00
  v_accvgpr_write_b32 a100, v4
  v_accvgpr_write_b32 a101, v4
  v_accvgpr_write_b32 a102, v4
  v_accvgpr_write_b32 a103, v4
  s_add_u32 s34, s99, 0
  s_and_b32 s34, s34, 1
  s_lshl_b32 s74, s34, 15
  s_add_u32 s34, s99, 1
  s_and_b32 s34, s34, 1
  s_lshl_b32 s75, s34, 15
  s_mov_b32 s45, 0
  s_lshr_b32 s98, s28, 1
  s_setprio 1
  s_waitcnt lgkmcnt(0)
  s_barrier
  s_add_u32 s69, s45, s74
  s_add_u32 m0, s32, 0
  s_add_u32 s44, s69, 0
  buffer_load_dwordx4 v8, s[16:19], s44 offen lds
  s_add_u32 m0, s32, 1024
  s_add_u32 s44, s69, 4096
  buffer_load_dwordx4 v8, s[16:19], s44 offen lds
  s_add_u32 m0, s32, 2048
  s_add_u32 s44, s69, 16384
  buffer_load_dwordx4 v8, s[16:19], s44 offen lds
  s_add_u32 m0, s32, 3072
  s_add_u32 s44, s69, 20480
  buffer_load_dwordx4 v8, s[16:19], s44 offen lds
  s_add_u32 s69, s45, s75
  s_add_u32 m0, s32, 4096
  s_add_u32 s44, s69, 0
  buffer_load_dwordx4 v8, s[16:19], s44 offen lds
  s_add_u32 m0, s32, 5120
  s_add_u32 s44, s69, 4096
  buffer_load_dwordx4 v8, s[16:19], s44 offen lds
  s_add_u32 m0, s32, 6144
  s_add_u32 s44, s69, 16384
  buffer_load_dwordx4 v8, s[16:19], s44 offen lds
  s_add_u32 m0, s32, 7168
  s_add_u32 s44, s69, 20480
  buffer_load_dwordx4 v8, s[16:19], s44 offen lds
  s_add_u32 s69, s45, s74
  s_add_u32 m0, s32, 8192
  s_add_u32 s44, s69, 8192
  buffer_load_dwordx4 v8, s[16:19], s44 offen lds
  s_add_u32 m0, s32, 9216
  s_add_u32 s44, s69, 12288
  buffer_load_dwordx4 v8, s[16:19], s44 offen lds
  s_add_u32 m0, s32, 10240
  s_add_u32 s44, s69, 24576
  buffer_load_dwordx4 v8, s[16:19], s44 offen lds
  s_add_u32 m0, s32, 11264
  s_add_u32 s44, s69, 28672
  buffer_load_dwordx4 v8, s[16:19], s44 offen lds
  s_add_u32 s69, s45, s75
  s_add_u32 m0, s32, 12288
  s_add_u32 s44, s69, 8192
  buffer_load_dwordx4 v8, s[16:19], s44 offen lds
  s_add_u32 m0, s32, 13312
  s_add_u32 s44, s69, 12288
  buffer_load_dwordx4 v8, s[16:19], s44 offen lds
  s_add_u32 m0, s32, 14336
  s_add_u32 s44, s69, 24576
  buffer_load_dwordx4 v8, s[16:19], s44 offen lds
  s_add_u32 m0, s32, 15360
  s_add_u32 s44, s69, 28672
  buffer_load_dwordx4 v8, s[16:19], s44 offen lds
  s_add_u32 s45, s45, 65536
  v_mov_b32 v4, 1.0
  v_accvgpr_write_b32 a104, v4
  v_accvgpr_write_b32 a105, v4
  v_accvgpr_write_b32 a106, v4
  v_accvgpr_write_b32 a107, v4
  v_accvgpr_write_b32 a108, v4
  s_waitcnt lgkmcnt(0)
  s_barrier
  ds_read_b128 v[76:79], v17 offset:20480
  ds_read_b128 v[80:83], v17 offset:20736
  ds_read_b128 v[84:87], v17 offset:20992
  s_waitcnt lgkmcnt(2)
  v_max3_f32 v76, v76, v77, v78
  s_waitcnt lgkmcnt(1)
  v_max3_f32 v80, v80, v81, v82
  s_waitcnt lgkmcnt(0)
  v_max3_f32 v84, v84, v85, v86
  v_max_f32 v76, v76, v79
  v_max_f32 v80, v80, v83
  v_max_f32 v84, v84, v87
  v_mov_b32 v88, v76
  v_mov_b32 v89, v80
  v_mov_b32 v90, v84
  ds_read_b128 v[76:79], v17 offset:21248
  ds_read_b128 v[80:83], v17 offset:21504
  s_waitcnt lgkmcnt(1)
  v_max3_f32 v76, v76, v77, v78
  s_waitcnt lgkmcnt(0)
  v_max3_f32 v80, v80, v81, v82
  v_max_f32 v76, v76, v79
  v_max_f32 v80, v80, v83
  v_mov_b32 v91, v76
  v_mov_b32 v92, v80
  s_waitcnt vmcnt(12)
  ds_read_b64_tr_b16 v[20:21], v13
  ds_read_b64_tr_b16 v[22:23], v13 offset:2048
  ds_read_b64_tr_b16 v[24:25], v14
  ds_read_b64_tr_b16 v[26:27], v14 offset:2048
  ds_read_b64_tr_b16 v[28:29], v15
  ds_read_b64_tr_b16 v[30:31], v15 offset:2048
  ds_read_b64_tr_b16 v[32:33], v16
  ds_read_b64_tr_b16 v[34:35], v16 offset:2048
  s_waitcnt lgkmcnt(0)
  s_barrier
  s_cmp_lg_u32 s47, 0
  s_cbranch_scc1 RO_q0
BO_q0:
  ds_read_b128 v[52:55], v9
  ds_read_b128 v[56:59], v9 offset:2048
  ds_read_b128 v[60:63], v9 offset:4096
  ds_read_b128 v[64:67], v9 offset:6144
  ds_read_b128 v[68:71], v9 offset:8192
  ds_read_b128 v[72:75], v10
  s_waitcnt lgkmcnt(5)
  v_mfma_f32_16x16x32_bf16 a[0:3], v[20:23], v[52:55], a[0:3]
  s_waitcnt vmcnt(8)
  ds_read_b64_tr_b16 v[36:37], v13 offset:4096
  ds_read_b64_tr_b16 v[38:39], v13 offset:6144
  ds_read_b64_tr_b16 v[40:41], v14 offset:4096
  v_mfma_f32_16x16x32_bf16 a[20:23], v[24:27], v[52:55], a[20:23]
  ds_read_b64_tr_b16 v[42:43], v14 offset:6144
  ds_read_b64_tr_b16 v[44:45], v15 offset:4096
  ds_read_b64_tr_b16 v[46:47], v15 offset:6144
  v_mfma_f32_16x16x32_bf16 a[40:43], v[28:31], v[52:55], a[40:43]
  ds_read_b64_tr_b16 v[48:49], v16 offset:4096
  ds_read_b64_tr_b16 v[50:51], v16 offset:6144
  v_mfma_f32_16x16x32_bf16 a[60:63], v[32:35], v[52:55], a[60:63]
  ds_read_b128 v[76:79], v17 offset:21760
  ds_read_b128 v[80:83], v17 offset:22016
  ds_read_b128 v[84:87], v17 offset:22272
  v_mfma_f32_16x16x32_bf16 a[80:83], a[100:103], v[52:55], a[80:83]
  s_add_u32 s69, s45, s74
  s_add_u32 m0, s32, 0
  s_add_u32 s44, s69, 0
  buffer_load_dwordx4 v8, s[16:19], s44 offen lds
  s_waitcnt lgkmcnt(15)
  v_mfma_f32_16x16x32_bf16 a[4:7], v[20:23], v[56:59], a[4:7]
  s_waitcnt lgkmcnt(2)
  v_max3_f32 v76, v76, v77, v78
  s_waitcnt lgkmcnt(1)
  v_max3_f32 v80, v80, v81, v82
  s_waitcnt lgkmcnt(0)
  v_max3_f32 v84, v84, v85, v86
  v_mfma_f32_16x16x32_bf16 a[24:27], v[24:27], v[56:59], a[24:27]
  v_max_f32 v76, v76, v79
  v_max_f32 v80, v80, v83
  v_max_f32 v84, v84, v87
  v_mfma_f32_16x16x32_bf16 a[44:47], v[28:31], v[56:59], a[44:47]
  v_sub_f32 v77, v76, v88
  v_sub_f32 v81, v80, v89
  v_sub_f32 v85, v84, v90
  v_mfma_f32_16x16x32_bf16 a[64:67], v[32:35], v[56:59], a[64:67]
  s_add_u32 m0, s32, 1024
  s_add_u32 s44, s69, 4096
  buffer_load_dwordx4 v8, s[16:19], s44 offen lds
  v_mfma_f32_16x16x32_bf16 a[84:87], a[100:103], v[56:59], a[84:87]
  v_max3_f32 v4, v77, v81, v85
  v_cmp_lt_f32 vcc, s48, v4
  s_cbranch_vccnz RP_q00
BP_q00:
  v_mfma_f32_16x16x32_bf16 a[8:11], v[20:23], v[60:63], a[8:11]
  ds_read_b128 v[52:55], v10 offset:2048
  ds_read_b128 v[76:79], v17 offset:22528
  ds_read_b128 v[80:83], v17 offset:22784
  v_mfma_f32_16x16x32_bf16 a[28:31], v[24:27], v[60:63], a[28:31]
  s_waitcnt lgkmcnt(1)
  v_max3_f32 v76, v76, v77, v78
  s_waitcnt lgkmcnt(0)
  v_max3_f32 v80, v80, v81, v82
  ds_read_b128 v[56:59], v10 offset:4096
  v_mfma_f32_16x16x32_bf16 a[48:51], v[28:31], v[60:63], a[48:51]
  s_add_u32 m0, s32, 2048
  s_add_u32 s44, s69, 16384
  buffer_load_dwordx4 v8, s[16:19], s44 offen lds
  v_mfma_f32_16x16x32_bf16 a[68:71], v[32:35], v[60:63], a[68:71]
  v_max_f32 v76, v76, v79
  v_max_f32 v80, v80, v83
  v_sub_f32 v77, v76, v91
  v_mfma_f32_16x16x32_bf16 a[88:91], a[100:103], v[60:63], a[88:91]
  v_sub_f32 v81, v80, v92
  v_max_f32 v4, v77, v81
  v_cmp_lt_f32 vcc, s48, v4
  v_mfma_f32_16x16x32_bf16 a[12:15], v[20:23], v[64:67], a[12:15]
  ds_read_b128 v[60:63], v10 offset:6144
  s_cbranch_vccnz RP_q01
BP_q01:
  v_mfma_f32_16x16x32_bf16 a[32:35], v[24:27], v[64:67], a[32:35]
  s_add_u32 m0, s32, 3072
  s_add_u32 s44, s69, 20480
  buffer_load_dwordx4 v8, s[16:19], s44 offen lds
  v_mfma_f32_16x16x32_bf16 a[52:55], v[28:31], v[64:67], a[52:55]
  v_mfma_f32_16x16x32_bf16 a[72:75], v[32:35], v[64:67], a[72:75]
  v_mfma_f32_16x16x32_bf16 a[92:95], a[100:103], v[64:67], a[92:95]
  v_mfma_f32_16x16x32_bf16 a[16:19], v[20:23], v[68:71], a[16:19]
  ds_read_b128 v[64:67], v10 offset:8192
  v_mfma_f32_16x16x32_bf16 a[36:39], v[24:27], v[68:71], a[36:39]
  v_mfma_f32_16x16x32_bf16 a[56:59], v[28:31], v[68:71], a[56:59]
  v_mfma_f32_16x16x32_bf16 a[76:79], v[32:35], v[68:71], a[76:79]
  v_mfma_f32_16x16x32_bf16 a[96:99], a[100:103], v[68:71], a[96:99]
  v_mfma_f32_16x16x32_bf16 a[0:3], v[36:39], v[72:75], a[0:3]
  v_mfma_f32_16x16x32_bf16 a[20:23], v[40:43], v[72:75], a[20:23]
  s_waitcnt vmcnt(8)
  ds_read_b64_tr_b16 v[20:21], v13 offset:8192
  ds_read_b64_tr_b16 v[22:23], v13 offset:10240
  ds_read_b64_tr_b16 v[24:25], v14 offset:8192
  v_mfma_f32_16x16x32_bf16 a[40:43], v[44:47], v[72:75], a[40:43]
  ds_read_b64_tr_b16 v[26:27], v14 offset:10240
  ds_read_b64_tr_b16 v[28:29], v15 offset:8192
  ds_read_b64_tr_b16 v[30:31], v15 offset:10240
  v_mfma_f32_16x16x32_bf16 a[60:63], v[48:51], v[72:75], a[60:63]
  ds_read_b64_tr_b16 v[32:33], v16 offset:8192
  ds_read_b64_tr_b16 v[34:35], v16 offset:10240
  v_mfma_f32_16x16x32_bf16 a[4:7], v[36:39], v[52:55], a[4:7]
  s_add_u32 s69, s45, s75
  s_add_u32 m0, s32, 4096
  s_add_u32 s44, s69, 0
  buffer_load_dwordx4 v8, s[16:19], s44 offen lds
  v_mfma_f32_16x16x32_bf16 a[24:27], v[40:43], v[52:55], a[24:27]
  v_mfma_f32_16x16x32_bf16 a[44:47], v[44:47], v[52:55], a[44:47]
  v_mfma_f32_16x16x32_bf16 a[64:67], v[48:51], v[52:55], a[64:67]
  s_waitcnt lgkmcnt(10)
  v_mfma_f32_16x16x32_bf16 a[8:11], v[36:39], v[56:59], a[8:11]
  s_add_u32 m0, s32, 5120
  s_add_u32 s44, s69, 4096
  buffer_load_dwordx4 v8, s[16:19], s44 offen lds
  v_mfma_f32_16x16x32_bf16 a[28:31], v[40:43], v[56:59], a[28:31]
  v_mfma_f32_16x16x32_bf16 a[48:51], v[44:47], v[56:59], a[48:51]
  v_mfma_f32_16x16x32_bf16 a[68:71], v[48:51], v[56:59], a[68:71]
  s_waitcnt lgkmcnt(9)
  v_mfma_f32_16x16x32_bf16 a[12:15], v[36:39], v[60:63], a[12:15]
  s_add_u32 m0, s32, 6144
  s_add_u32 s44, s69, 16384
  buffer_load_dwordx4 v8, s[16:19], s44 offen lds
  v_mfma_f32_16x16x32_bf16 a[32:35], v[40:43], v[60:63], a[32:35]
  v_mfma_f32_16x16x32_bf16 a[52:55], v[44:47], v[60:63], a[52:55]
  v_mfma_f32_16x16x32_bf16 a[72:75], v[48:51], v[60:63], a[72:75]
  s_waitcnt lgkmcnt(8)
  v_mfma_f32_16x16x32_bf16 a[16:19], v[36:39], v[64:67], a[16:19]
  s_add_u32 m0, s32, 7168
  s_add_u32 s44, s69, 20480
  buffer_load_dwordx4 v8, s[16:19], s44 offen lds
  v_mfma_f32_16x16x32_bf16 a[36:39], v[40:43], v[64:67], a[36:39]
  v_mfma_f32_16x16x32_bf16 a[56:59], v[44:47], v[64:67], a[56:59]
  v_mfma_f32_16x16x32_bf16 a[76:79], v[48:51], v[64:67], a[76:79]
  s_waitcnt lgkmcnt(0)
  s_barrier
  s_cmp_lg_u32 s47, 0
  s_cbranch_scc1 RO_q1
BO_q1:
  ds_read_b128 v[52:55], v9 offset:10240
  ds_read_b128 v[56:59], v9 offset:12288
  ds_read_b128 v[60:63], v9 offset:14336
  ds_read_b128 v[64:67], v9 offset:16384
  ds_read_b128 v[68:71], v9 offset:18432
  ds_read_b128 v[72:75], v10 offset:10240
  s_waitcnt lgkmcnt(5)
  v_mfma_f32_16x16x32_bf16 a[0:3], v[20:23], v[52:55], a[0:3]
  s_waitcnt vmcnt(8)
  ds_read_b64_tr_b16 v[36:37], v13 offset:12288
  ds_read_b64_tr_b16 v[38:39], v13 offset:14336
  ds_read_b64_tr_b16 v[40:41], v14 offset:12288
  v_mfma_f32_16x16x32_bf16 a[20:23], v[24:27], v[52:55], a[20:23]
  ds_read_b64_tr_b16 v[42:43], v14 offset:14336
  ds_read_b64_tr_b16 v[44:45], v15 offset:12288
  ds_read_b64_tr_b16 v[46:47], v15 offset:14336
  v_mfma_f32_16x16x32_bf16 a[40:43], v[28:31], v[52:55], a[40:43]
  ds_read_b64_tr_b16 v[48:49], v16 offset:12288
  ds_read_b64_tr_b16 v[50:51], v16 offset:14336
  v_mfma_f32_16x16x32_bf16 a[60:63], v[32:35], v[52:55], a[60:63]
  ds_read_b128 v[76:79], v17 offset:20480
  ds_read_b128 v[80:83], v17 offset:20736
  ds_read_b128 v[84:87], v17 offset:20992
  v_mfma_f32_16x16x32_bf16 a[80:83], a[100:103], v[52:55], a[80:83]
  s_add_u32 s69, s45, s74
  s_add_u32 m0, s32, 8192
  s_add_u32 s44, s69, 8192
  buffer_load_dwordx4 v8, s[16:19], s44 offen lds
  s_waitcnt lgkmcnt(15)
  v_mfma_f32_16x16x32_bf16 a[4:7], v[20:23], v[56:59], a[4:7]
  s_waitcnt lgkmcnt(2)
  v_max3_f32 v76, v76, v77, v78
  s_waitcnt lgkmcnt(1)
  v_max3_f32 v80, v80, v81, v82
  s_waitcnt lgkmcnt(0)
  v_max3_f32 v84, v84, v85, v86
  v_mfma_f32_16x16x32_bf16 a[24:27], v[24:27], v[56:59], a[24:27]
  v_max_f32 v76, v76, v79
  v_max_f32 v80, v80, v83
  v_max_f32 v84, v84, v87
  v_mfma_f32_16x16x32_bf16 a[44:47], v[28:31], v[56:59], a[44:47]
  v_sub_f32 v77, v76, v88
  v_sub_f32 v81, v80, v89
  v_sub_f32 v85, v84, v90
  v_mfma_f32_16x16x32_bf16 a[64:67], v[32:35], v[56:59], a[64:67]
  s_add_u32 m0, s32, 9216
  s_add_u32 s44, s69, 12288
  buffer_load_dwordx4 v8, s[16:19], s44 offen lds
  v_mfma_f32_16x16x32_bf16 a[84:87], a[100:103], v[56:59], a[84:87]
  v_max3_f32 v4, v77, v81, v85
  v_cmp_lt_f32 vcc, s48, v4
  s_cbranch_vccnz RP_q10
BP_q10:
  v_mfma_f32_16x16x32_bf16 a[8:11], v[20:23], v[60:63], a[8:11]
  ds_read_b128 v[52:55], v10 offset:12288
  ds_read_b128 v[76:79], v17 offset:21248
  ds_read_b128 v[80:83], v17 offset:21504
  v_mfma_f32_16x16x32_bf16 a[28:31], v[24:27], v[60:63], a[28:31]
  s_waitcnt lgkmcnt(1)
  v_max3_f32 v76, v76, v77, v78
  s_waitcnt lgkmcnt(0)
  v_max3_f32 v80, v80, v81, v82
  ds_read_b128 v[56:59], v10 offset:14336
  v_mfma_f32_16x16x32_bf16 a[48:51], v[28:31], v[60:63], a[48:51]
  s_add_u32 m0, s32, 10240
  s_add_u32 s44, s69, 24576
  buffer_load_dwordx4 v8, s[16:19], s44 offen lds
  v_mfma_f32_16x16x32_bf16 a[68:71], v[32:35], v[60:63], a[68:71]
  v_max_f32 v76, v76, v79
  v_max_f32 v80, v80, v83
  v_sub_f32 v77, v76, v91
  v_mfma_f32_16x16x32_bf16 a[88:91], a[100:103], v[60:63], a[88:91]
  v_sub_f32 v81, v80, v92
  v_max_f32 v4, v77, v81
  v_cmp_lt_f32 vcc, s48, v4
  v_mfma_f32_16x16x32_bf16 a[12:15], v[20:23], v[64:67], a[12:15]
  ds_read_b128 v[60:63], v10 offset:16384
  s_cbranch_vccnz RP_q11
BP_q11:
  v_mfma_f32_16x16x32_bf16 a[32:35], v[24:27], v[64:67], a[32:35]
  s_add_u32 m0, s32, 11264
  s_add_u32 s44, s69, 28672
  buffer_load_dwordx4 v8, s[16:19], s44 offen lds
  v_mfma_f32_16x16x32_bf16 a[52:55], v[28:31], v[64:67], a[52:55]
  v_mfma_f32_16x16x32_bf16 a[72:75], v[32:35], v[64:67], a[72:75]
  v_mfma_f32_16x16x32_bf16 a[92:95], a[100:103], v[64:67], a[92:95]
  v_mfma_f32_16x16x32_bf16 a[16:19], v[20:23], v[68:71], a[16:19]
  ds_read_b128 v[64:67], v10 offset:18432
  v_mfma_f32_16x16x32_bf16 a[36:39], v[24:27], v[68:71], a[36:39]
  v_mfma_f32_16x16x32_bf16 a[56:59], v[28:31], v[68:71], a[56:59]
  v_mfma_f32_16x16x32_bf16 a[76:79], v[32:35], v[68:71], a[76:79]
  v_mfma_f32_16x16x32_bf16 a[96:99], a[100:103], v[68:71], a[96:99]
  v_mfma_f32_16x16x32_bf16 a[0:3], v[36:39], v[72:75], a[0:3]
  v_mfma_f32_16x16x32_bf16 a[20:23], v[40:43], v[72:75], a[20:23]
  s_waitcnt vmcnt(8)
  ds_read_b64_tr_b16 v[20:21], v13
  ds_read_b64_tr_b16 v[22:23], v13 offset:2048
  ds_read_b64_tr_b16 v[24:25], v14
  v_mfma_f32_16x16x32_bf16 a[40:43], v[44:47], v[72:75], a[40:43]
  ds_read_b64_tr_b16 v[26:27], v14 offset:2048
  ds_read_b64_tr_b16 v[28:29], v15
  ds_read_b64_tr_b16 v[30:31], v15 offset:2048
  v_mfma_f32_16x16x32_bf16 a[60:63], v[48:51], v[72:75], a[60:63]
  ds_read_b64_tr_b16 v[32:33], v16
  ds_read_b64_tr_b16 v[34:35], v16 offset:2048
  v_mfma_f32_16x16x32_bf16 a[4:7], v[36:39], v[52:55], a[4:7]
  s_add_u32 s69, s45, s75
  s_add_u32 m0, s32, 12288
  s_add_u32 s44, s69, 8192
  buffer_load_dwordx4 v8, s[16:19], s44 offen lds
  v_mfma_f32_16x16x32_bf16 a[24:27], v[40:43], v[52:55], a[24:27]
  v_mfma_f32_16x16x32_bf16 a[44:47], v[44:47], v[52:55], a[44:47]
  v_mfma_f32_16x16x32_bf16 a[64:67], v[48:51], v[52:55], a[64:67]
  s_waitcnt lgkmcnt(10)
  v_mfma_f32_16x16x32_bf16 a[8:11], v[36:39], v[56:59], a[8:11]
  s_add_u32 m0, s32, 13312
  s_add_u32 s44, s69, 12288
  buffer_load_dwordx4 v8, s[16:19], s44 offen lds
  v_mfma_f32_16x16x32_bf16 a[28:31], v[40:43], v[56:59], a[28:31]
  v_mfma_f32_16x16x32_bf16 a[48:51], v[44:47], v[56:59], a[48:51]
  v_mfma_f32_16x16x32_bf16 a[68:71], v[48:51], v[56:59], a[68:71]
  s_waitcnt lgkmcnt(9)
  v_mfma_f32_16x16x32_bf16 a[12:15], v[36:39], v[60:63], a[12:15]
  s_add_u32 m0, s32, 14336
  s_add_u32 s44, s69, 24576
  buffer_load_dwordx4 v8, s[16:19], s44 offen lds
  v_mfma_f32_16x16x32_bf16 a[32:35], v[40:43], v[60:63], a[32:35]
  v_mfma_f32_16x16x32_bf16 a[52:55], v[44:47], v[60:63], a[52:55]
  v_mfma_f32_16x16x32_bf16 a[72:75], v[48:51], v[60:63], a[72:75]
  s_waitcnt lgkmcnt(8)
  v_mfma_f32_16x16x32_bf16 a[16:19], v[36:39], v[64:67], a[16:19]
  s_add_u32 m0, s32, 15360
  s_add_u32 s44, s69, 28672
  buffer_load_dwordx4 v8, s[16:19], s44 offen lds
  s_add_u32 s45, s45, 65536
  v_mfma_f32_16x16x32_bf16 a[36:39], v[40:43], v[64:67], a[36:39]
  v_mfma_f32_16x16x32_bf16 a[56:59], v[44:47], v[64:67], a[56:59]
  v_mfma_f32_16x16x32_bf16 a[76:79], v[48:51], v[64:67], a[76:79]
  s_waitcnt lgkmcnt(0)
  s_barrier
LP_MAIN:
  s_cmp_lg_u32 s47, 0
  s_cbranch_scc1 RO_qA
BO_qA:
  ds_read_b128 v[52:55], v9
  ds_read_b128 v[56:59], v9 offset:2048
  ds_read_b128 v[60:63], v9 offset:4096
  ds_read_b128 v[64:67], v9 offset:6144
  ds_read_b128 v[68:71], v9 offset:8192
  ds_read_b128 v[72:75], v10
  s_waitcnt lgkmcnt(5)
  v_mfma_f32_16x16x32_bf16 a[0:3], v[20:23], v[52:55], a[0:3]
  s_waitcnt vmcnt(8)
  ds_read_b64_tr_b16 v[36:37], v13 offset:4096
  ds_read_b64_tr_b16 v[38:39], v13 offset:6144
  ds_read_b64_tr_b16 v[40:41], v14 offset:4096
  v_mfma_f32_16x16x32_bf16 a[20:23], v[24:27], v[52:55], a[20:23]
  ds_read_b64_tr_b16 v[42:43], v14 offset:6144
  ds_read_b64_tr_b16 v[44:45], v15 offset:4096
  ds_read_b64_tr_b16 v[46:47], v15 offset:6144
  v_mfma_f32_16x16x32_bf16 a[40:43], v[28:31], v[52:55], a[40:43]
  ds_read_b64_tr_b16 v[48:49], v16 offset:4096
  ds_read_b64_tr_b16 v[50:51], v16 offset:6144
  v_mfma_f32_16x16x32_bf16 a[60:63], v[32:35], v[52:55], a[60:63]
  ds_read_b128 v[76:79], v17 offset:21760
  ds_read_b128 v[80:83], v17 offset:22016
  ds_read_b128 v[84:87], v17 offset:22272
  v_mfma_f32_16x16x32_bf16 a[80:83], a[100:103], v[52:55], a[80:83]
  s_add_u32 s69, s45, s74
  s_add_u32 m0, s32, 0
  s_add_u32 s44, s69, 0
  buffer_load_dwordx4 v8, s[16:19], s44 offen lds
  s_waitcnt lgkmcnt(15)
  v_mfma_f32_16x16x32_bf16 a[4:7], v[20:23], v[56:59], a[4:7]
  s_waitcnt lgkmcnt(2)
  v_max3_f32 v76, v76, v77, v78
  s_waitcnt lgkmcnt(1)
  v_max3_f32 v80, v80, v81, v82
  s_waitcnt lgkmcnt(0)
  v_max3_f32 v84, v84, v85, v86
  v_mfma_f32_16x16x32_bf16 a[24:27], v[24:27], v[56:59], a[24:27]
  v_max_f32 v76, v76, v79
  v_max_f32 v80, v80, v83
  v_max_f32 v84, v84, v87
  v_mfma_f32_16x16x32_bf16 a[44:47], v[28:31], v[56:59], a[44:47]
  v_sub_f32 v77, v76, v88
  v_sub_f32 v81, v80, v89
  v_sub_f32 v85, v84, v90
  v_mfma_f32_16x16x32_bf16 a[64:67], v[32:35], v[56:59], a[64:67]
  s_add_u32 m0, s32, 1024
  s_add_u32 s44, s69, 4096
  buffer_load_dwordx4 v8, s[16:19], s44 offen lds
  v_mfma_f32_16x16x32_bf16 a[84:87], a[100:103], v[56:59], a[84:87]
  v_max3_f32 v4, v77, v81, v85
  v_cmp_lt_f32 vcc, s48, v4
  s_cbranch_vccnz RP_qA0
BP_qA0:
  v_mfma_f32_16x16x32_bf16 a[8:11], v[20:23], v[60:63], a[8:11]
  ds_read_b128 v[52:55], v10 offset:2048
  ds_read_b128 v[76:79], v17 offset:22528
  ds_read_b128 v[80:83], v17 offset:22784
  v_mfma_f32_16x16x32_bf16 a[28:31], v[24:27], v[60:63], a[28:31]
  s_waitcnt lgkmcnt(1)
  v_max3_f32 v76, v76, v77, v78
  s_waitcnt lgkmcnt(0)
  v_max3_f32 v80, v80, v81, v82
  ds_read_b128 v[56:59], v10 offset:4096
  v_mfma_f32_16x16x32_bf16 a[48:51], v[28:31], v[60:63], a[48:51]
  s_add_u32 m0, s32, 2048
  s_add_u32 s44, s69, 16384
  buffer_load_dwordx4 v8, s[16:19], s44 offen lds
  v_mfma_f32_16x16x32_bf16 a[68:71], v[32:35], v[60:63], a[68:71]
  v_max_f32 v76, v76, v79
  v_max_f32 v80, v80, v83
  v_sub_f32 v77, v76, v91
  v_mfma_f32_16x16x32_bf16 a[88:91], a[100:103], v[60:63], a[88:91]
  v_sub_f32 v81, v80, v92
  v_max_f32 v4, v77, v81
  v_cmp_lt_f32 vcc, s48, v4
  v_mfma_f32_16x16x32_bf16 a[12:15], v[20:23], v[64:67], a[12:15]
  ds_read_b128 v[60:63], v10 offset:6144
  s_cbranch_vccnz RP_qA1
BP_qA1:
  v_mfma_f32_16x16x32_bf16 a[32:35], v[24:27], v[64:67], a[32:35]
  s_add_u32 m0, s32, 3072
  s_add_u32 s44, s69, 20480
  buffer_load_dwordx4 v8, s[16:19], s44 offen lds
  v_mfma_f32_16x16x32_bf16 a[52:55], v[28:31], v[64:67], a[52:55]
  v_mfma_f32_16x16x32_bf16 a[72:75], v[32:35], v[64:67], a[72:75]
  v_mfma_f32_16x16x32_bf16 a[92:95], a[100:103], v[64:67], a[92:95]
  v_mfma_f32_16x16x32_bf16 a[16:19], v[20:23], v[68:71], a[16:19]
  ds_read_b128 v[64:67], v10 offset:8192
  v_mfma_f32_16x16x32_bf16 a[36:39], v[24:27], v[68:71], a[36:39]
  v_mfma_f32_16x16x32_bf16 a[56:59], v[28:31], v[68:71], a[56:59]
  v_mfma_f32_16x16x32_bf16 a[76:79], v[32:35], v[68:71], a[76:79]
  v_mfma_f32_16x16x32_bf16 a[96:99], a[100:103], v[68:71], a[96:99]
  v_mfma_f32_16x16x32_bf16 a[0:3], v[36:39], v[72:75], a[0:3]
  v_mfma_f32_16x16x32_bf16 a[20:23], v[40:43], v[72:75], a[20:23]
  s_waitcnt vmcnt(8)
  ds_read_b64_tr_b16 v[20:21], v13 offset:8192
  ds_read_b64_tr_b16 v[22:23], v13 offset:10240
  ds_read_b64_tr_b16 v[24:25], v14 offset:8192
  v_mfma_f32_16x16x32_bf16 a[40:43], v[44:47], v[72:75], a[40:43]
  ds_read_b64_tr_b16 v[26:27], v14 offset:10240
  ds_read_b64_tr_b16 v[28:29], v15 offset:8192
  ds_read_b64_tr_b16 v[30:31], v15 offset:10240
  v_mfma_f32_16x16x32_bf16 a[60:63], v[48:51], v[72:75], a[60:63]
  ds_read_b64_tr_b16 v[32:33], v16 offset:8192
  ds_read_b64_tr_b16 v[34:35], v16 offset:10240
  v_mfma_f32_16x16x32_bf16 a[4:7], v[36:39], v[52:55], a[4:7]
  s_add_u32 s69, s45, s75
  s_add_u32 m0, s32, 4096
  s_add_u32 s44, s69, 0
  buffer_load_dwordx4 v8, s[16:19], s44 offen lds
  v_mfma_f32_16x16x32_bf16 a[24:27], v[40:43], v[52:55], a[24:27]
  v_mfma_f32_16x16x32_bf16 a[44:47], v[44:47], v[52:55], a[44:47]
  v_mfma_f32_16x16x32_bf16 a[64:67], v[48:51], v[52:55], a[64:67]
  s_waitcnt lgkmcnt(10)
  v_mfma_f32_16x16x32_bf16 a[8:11], v[36:39], v[56:59], a[8:11]
  s_add_u32 m0, s32, 5120
  s_add_u32 s44, s69, 4096
  buffer_load_dwordx4 v8, s[16:19], s44 offen lds
  v_mfma_f32_16x16x32_bf16 a[28:31], v[40:43], v[56:59], a[28:31]
  v_mfma_f32_16x16x32_bf16 a[48:51], v[44:47], v[56:59], a[48:51]
  v_mfma_f32_16x16x32_bf16 a[68:71], v[48:51], v[56:59], a[68:71]
  s_waitcnt lgkmcnt(9)
  v_mfma_f32_16x16x32_bf16 a[12:15], v[36:39], v[60:63], a[12:15]
  s_add_u32 m0, s32, 6144
  s_add_u32 s44, s69, 16384
  buffer_load_dwordx4 v8, s[16:19], s44 offen lds
  v_mfma_f32_16x16x32_bf16 a[32:35], v[40:43], v[60:63], a[32:35]
  v_mfma_f32_16x16x32_bf16 a[52:55], v[44:47], v[60:63], a[52:55]
  v_mfma_f32_16x16x32_bf16 a[72:75], v[48:51], v[60:63], a[72:75]
  s_waitcnt lgkmcnt(8)
  v_mfma_f32_16x16x32_bf16 a[16:19], v[36:39], v[64:67], a[16:19]
  s_add_u32 m0, s32, 7168
  s_add_u32 s44, s69, 20480
  buffer_load_dwordx4 v8, s[16:19], s44 offen lds
  v_mfma_f32_16x16x32_bf16 a[36:39], v[40:43], v[64:67], a[36:39]
  v_mfma_f32_16x16x32_bf16 a[56:59], v[44:47], v[64:67], a[56:59]
  v_mfma_f32_16x16x32_bf16 a[76:79], v[48:51], v[64:67], a[76:79]
  s_waitcnt lgkmcnt(0)
  s_waitcnt lgkmcnt(0)
  s_barrier
  s_cmp_lg_u32 s47, 0
  s_cbranch_scc1 RO_qB
BO_qB:
  ds_read_b128 v[52:55], v9 offset:10240
  ds_read_b128 v[56:59], v9 offset:12288
  ds_read_b128 v[60:63], v9 offset:14336
  ds_read_b128 v[64:67], v9 offset:16384
  ds_read_b128 v[68:71], v9 offset:18432
  ds_read_b128 v[72:75], v10 offset:10240
  s_waitcnt lgkmcnt(5)
  v_mfma_f32_16x16x32_bf16 a[0:3], v[20:23], v[52:55], a[0:3]
  s_waitcnt vmcnt(8)
  ds_read_b64_tr_b16 v[36:37], v13 offset:12288
  ds_read_b64_tr_b16 v[38:39], v13 offset:14336
  ds_read_b64_tr_b16 v[40:41], v14 offset:12288
  v_mfma_f32_16x16x32_bf16 a[20:23], v[24:27], v[52:55], a[20:23]
  ds_read_b64_tr_b16 v[42:43], v14 offset:14336
  ds_read_b64_tr_b16 v[44:45], v15 offset:12288
  ds_read_b64_tr_b16 v[46:47], v15 offset:14336
  v_mfma_f32_16x16x32_bf16 a[40:43], v[28:31], v[52:55], a[40:43]
  ds_read_b64_tr_b16 v[48:49], v16 offset:12288
  ds_read_b64_tr_b16 v[50:51], v16 offset:14336
  v_mfma_f32_16x16x32_bf16 a[60:63], v[32:35], v[52:55], a[60:63]
  ds_read_b128 v[76:79], v17 offset:20480
  ds_read_b128 v[80:83], v17 offset:20736
  ds_read_b128 v[84:87], v17 offset:20992
  v_mfma_f32_16x16x32_bf16 a[80:83], a[100:103], v[52:55], a[80:83]
  s_add_u32 s69, s45, s74
  s_add_u32 m0, s32, 8192
  s_add_u32 s44, s69, 8192
  buffer_load_dwordx4 v8, s[16:19], s44 offen lds
  s_waitcnt lgkmcnt(15)
  v_mfma_f32_16x16x32_bf16 a[4:7], v[20:23], v[56:59], a[4:7]
  s_waitcnt lgkmcnt(2)
  v_max3_f32 v76, v76, v77, v78
  s_waitcnt lgkmcnt(1)
  v_max3_f32 v80, v80, v81, v82
  s_waitcnt lgkmcnt(0)
  v_max3_f32 v84, v84, v85, v86
  v_mfma_f32_16x16x32_bf16 a[24:27], v[24:27], v[56:59], a[24:27]
  v_max_f32 v76, v76, v79
  v_max_f32 v80, v80, v83
  v_max_f32 v84, v84, v87
  v_mfma_f32_16x16x32_bf16 a[44:47], v[28:31], v[56:59], a[44:47]
  v_sub_f32 v77, v76, v88
  v_sub_f32 v81, v80, v89
  v_sub_f32 v85, v84, v90
  v_mfma_f32_16x16x32_bf16 a[64:67], v[32:35], v[56:59], a[64:67]
  s_add_u32 m0, s32, 9216
  s_add_u32 s44, s69, 12288
  buffer_load_dwordx4 v8, s[16:19], s44 offen lds
  v_mfma_f32_16x16x32_bf16 a[84:87], a[100:103], v[56:59], a[84:87]
  v_max3_f32 v4, v77, v81, v85
  v_cmp_lt_f32 vcc, s48, v4
  s_cbranch_vccnz RP_qB0
BP_qB0:
  v_mfma_f32_16x16x32_bf16 a[8:11], v[20:23], v[60:63], a[8:11]
  ds_read_b128 v[52:55], v10 offset:12288
  ds_read_b128 v[76:79], v17 offset:21248
  ds_read_b128 v[80:83], v17 offset:21504
  v_mfma_f32_16x16x32_bf16 a[28:31], v[24:27], v[60:63], a[28:31]
  s_waitcnt lgkmcnt(1)
  v_max3_f32 v76, v76, v77, v78
  s_waitcnt lgkmcnt(0)
  v_max3_f32 v80, v80, v81, v82
  ds_read_b128 v[56:59], v10 offset:14336
  v_mfma_f32_16x16x32_bf16 a[48:51], v[28:31], v[60:63], a[48:51]
  s_add_u32 m0, s32, 10240
  s_add_u32 s44, s69, 24576
  buffer_load_dwordx4 v8, s[16:19], s44 offen lds
  v_mfma_f32_16x16x32_bf16 a[68:71], v[32:35], v[60:63], a[68:71]
  v_max_f32 v76, v76, v79
  v_max_f32 v80, v80, v83
  v_sub_f32 v77, v76, v91
  v_mfma_f32_16x16x32_bf16 a[88:91], a[100:103], v[60:63], a[88:91]
  v_sub_f32 v81, v80, v92
  v_max_f32 v4, v77, v81
  v_cmp_lt_f32 vcc, s48, v4
  v_mfma_f32_16x16x32_bf16 a[12:15], v[20:23], v[64:67], a[12:15]
  ds_read_b128 v[60:63], v10 offset:16384
  s_cbranch_vccnz RP_qB1
BP_qB1:
  v_mfma_f32_16x16x32_bf16 a[32:35], v[24:27], v[64:67], a[32:35]
  s_add_u32 m0, s32, 11264
  s_add_u32 s44, s69, 28672
  buffer_load_dwordx4 v8, s[16:19], s44 offen lds
  v_mfma_f32_16x16x32_bf16 a[52:55], v[28:31], v[64:67], a[52:55]
  v_mfma_f32_16x16x32_bf16 a[72:75], v[32:35], v[64:67], a[72:75]
  v_mfma_f32_16x16x32_bf16 a[92:95], a[100:103], v[64:67], a[92:95]
  v_mfma_f32_16x16x32_bf16 a[16:19], v[20:23], v[68:71], a[16:19]
  ds_read_b128 v[64:67], v10 offset:18432
  v_mfma_f32_16x16x32_bf16 a[36:39], v[24:27], v[68:71], a[36:39]
  v_mfma_f32_16x16x32_bf16 a[56:59], v[28:31], v[68:71], a[56:59]
  v_mfma_f32_16x16x32_bf16 a[76:79], v[32:35], v[68:71], a[76:79]
  v_mfma_f32_16x16x32_bf16 a[96:99], a[100:103], v[68:71], a[96:99]
  v_mfma_f32_16x16x32_bf16 a[0:3], v[36:39], v[72:75], a[0:3]
  v_mfma_f32_16x16x32_bf16 a[20:23], v[40:43], v[72:75], a[20:23]
  s_waitcnt vmcnt(8)
  ds_read_b64_tr_b16 v[20:21], v13
  ds_read_b64_tr_b16 v[22:23], v13 offset:2048
  ds_read_b64_tr_b16 v[24:25], v14
  v_mfma_f32_16x16x32_bf16 a[40:43], v[44:47], v[72:75], a[40:43]
  ds_read_b64_tr_b16 v[26:27], v14 offset:2048
  ds_read_b64_tr_b16 v[28:29], v15
  ds_read_b64_tr_b16 v[30:31], v15 offset:2048
  v_mfma_f32_16x16x32_bf16 a[60:63], v[48:51], v[72:75], a[60:63]
  ds_read_b64_tr_b16 v[32:33], v16
  ds_read_b64_tr_b16 v[34:35], v16 offset:2048
  v_mfma_f32_16x16x32_bf16 a[4:7], v[36:39], v[52:55], a[4:7]
  s_add_u32 s69, s45, s75
  s_add_u32 m0, s32, 12288
  s_add_u32 s44, s69, 8192
  buffer_load_dwordx4 v8, s[16:19], s44 offen lds
  v_mfma_f32_16x16x32_bf16 a[24:27], v[40:43], v[52:55], a[24:27]
  v_mfma_f32_16x16x32_bf16 a[44:47], v[44:47], v[52:55], a[44:47]
  v_mfma_f32_16x16x32_bf16 a[64:67], v[48:51], v[52:55], a[64:67]
  s_waitcnt lgkmcnt(10)
  v_mfma_f32_16x16x32_bf16 a[8:11], v[36:39], v[56:59], a[8:11]
  s_add_u32 m0, s32, 13312
  s_add_u32 s44, s69, 12288
  buffer_load_dwordx4 v8, s[16:19], s44 offen lds
  v_mfma_f32_16x16x32_bf16 a[28:31], v[40:43], v[56:59], a[28:31]
  v_mfma_f32_16x16x32_bf16 a[48:51], v[44:47], v[56:59], a[48:51]
  v_mfma_f32_16x16x32_bf16 a[68:71], v[48:51], v[56:59], a[68:71]
  s_waitcnt lgkmcnt(9)
  v_mfma_f32_16x16x32_bf16 a[12:15], v[36:39], v[60:63], a[12:15]
  s_add_u32 m0, s32, 14336
  s_add_u32 s44, s69, 24576
  buffer_load_dwordx4 v8, s[16:19], s44 offen lds
  v_mfma_f32_16x16x32_bf16 a[32:35], v[40:43], v[60:63], a[32:35]
  v_mfma_f32_16x16x32_bf16 a[52:55], v[44:47], v[60:63], a[52:55]
  v_mfma_f32_16x16x32_bf16 a[72:75], v[48:51], v[60:63], a[72:75]
  s_waitcnt lgkmcnt(8)
  v_mfma_f32_16x16x32_bf16 a[16:19], v[36:39], v[64:67], a[16:19]
  s_add_u32 m0, s32, 15360
  s_add_u32 s44, s69, 28672
  buffer_load_dwordx4 v8, s[16:19], s44 offen lds
  s_add_u32 s45, s45, 65536
  v_mfma_f32_16x16x32_bf16 a[36:39], v[40:43], v[64:67], a[36:39]
  v_mfma_f32_16x16x32_bf16 a[56:59], v[44:47], v[64:67], a[56:59]
  v_mfma_f32_16x16x32_bf16 a[76:79], v[48:51], v[64:67], a[76:79]
  s_waitcnt lgkmcnt(0)
  s_barrier
  s_add_u32 s46, s46, 1
  s_cmp_lt_u32 s46, 6
  s_cbranch_scc1 LP_MAIN
  s_cmp_lg_u32 s47, 0
  s_cbranch_scc1 RO_q14
BO_q14:
  ds_read_b128 v[52:55], v9
  ds_read_b128 v[56:59], v9 offset:2048
  ds_read_b128 v[60:63], v9 offset:4096
  ds_read_b128 v[64:67], v9 offset:6144
  ds_read_b128 v[68:71], v9 offset:8192
  ds_read_b128 v[72:75], v10
  s_waitcnt lgkmcnt(5)
  v_mfma_f32_16x16x32_bf16 a[0:3], v[20:23], v[52:55], a[0:3]
  s_waitcnt vmcnt(8)
  ds_read_b64_tr_b16 v[36:37], v13 offset:4096
  ds_read_b64_tr_b16 v[38:39], v13 offset:6144
  ds_read_b64_tr_b16 v[40:41], v14 offset:4096
  v_mfma_f32_16x16x32_bf16 a[20:23], v[24:27], v[52:55], a[20:23]
  ds_read_b64_tr_b16 v[42:43], v14 offset:6144
  ds_read_b64_tr_b16 v[44:45], v15 offset:4096
  ds_read_b64_tr_b16 v[46:47], v15 offset:6144
  v_mfma_f32_16x16x32_bf16 a[40:43], v[28:31], v[52:55], a[40:43]
  ds_read_b64_tr_b16 v[48:49], v16 offset:4096
  ds_read_b64_tr_b16 v[50:51], v16 offset:6144
  v_mfma_f32_16x16x32_bf16 a[60:63], v[32:35], v[52:55], a[60:63]
  ds_read_b128 v[76:79], v17 offset:21760
  ds_read_b128 v[80:83], v17 offset:22016
  ds_read_b128 v[84:87], v17 offset:22272
  v_mfma_f32_16x16x32_bf16 a[80:83], a[100:103], v[52:55], a[80:83]
  s_waitcnt lgkmcnt(2)
  v_max3_f32 v76, v76, v77, v78
  s_waitcnt lgkmcnt(1)
  v_max3_f32 v80, v80, v81, v82
  s_waitcnt lgkmcnt(0)
  v_max3_f32 v84, v84, v85, v86
  v_mfma_f32_16x16x32_bf16 a[4:7], v[20:23], v[56:59], a[4:7]
  v_max_f32 v76, v76, v79
  v_max_f32 v80, v80, v83
  v_max_f32 v84, v84, v87
  v_mfma_f32_16x16x32_bf16 a[24:27], v[24:27], v[56:59], a[24:27]
  v_sub_f32 v77, v76, v88
  v_sub_f32 v81, v80, v89
  v_sub_f32 v85, v84, v90
  v_mfma_f32_16x16x32_bf16 a[44:47], v[28:31], v[56:59], a[44:47]
  v_max3_f32 v4, v77, v81, v85
  v_cmp_lt_f32 vcc, s48, v4
  s_cbranch_vccnz RP_q140
BP_q140:
  v_mfma_f32_16x16x32_bf16 a[64:67], v[32:35], v[56:59], a[64:67]
  ds_read_b128 v[52:55], v10 offset:2048
  ds_read_b128 v[76:79], v17 offset:22528
  ds_read_b128 v[80:83], v17 offset:22784
  v_mfma_f32_16x16x32_bf16 a[84:87], a[100:103], v[56:59], a[84:87]
  s_waitcnt lgkmcnt(1)
  v_max3_f32 v76, v76, v77, v78
  s_waitcnt lgkmcnt(0)
  v_max3_f32 v80, v80, v81, v82
  v_max_f32 v76, v76, v79
  v_mfma_f32_16x16x32_bf16 a[8:11], v[20:23], v[60:63], a[8:11]
  ds_read_b128 v[56:59], v10 offset:4096
  v_max_f32 v80, v80, v83
  v_sub_f32 v77, v76, v91
  v_mfma_f32_16x16x32_bf16 a[28:31], v[24:27], v[60:63], a[28:31]
  v_sub_f32 v81, v80, v92
  v_max_f32 v4, v77, v81
  v_cmp_lt_f32 vcc, s48, v4
  v_mfma_f32_16x16x32_bf16 a[48:51], v[28:31], v[60:63], a[48:51]
  s_cbranch_vccnz RP_q141
BP_q141:
  v_mfma_f32_16x16x32_bf16 a[68:71], v[32:35], v[60:63], a[68:71]
  v_mfma_f32_16x16x32_bf16 a[88:91], a[100:103], v[60:63], a[88:91]
  v_mfma_f32_16x16x32_bf16 a[12:15], v[20:23], v[64:67], a[12:15]
  ds_read_b128 v[60:63], v10 offset:6144
  v_mfma_f32_16x16x32_bf16 a[32:35], v[24:27], v[64:67], a[32:35]
  v_mfma_f32_16x16x32_bf16 a[52:55], v[28:31], v[64:67], a[52:55]
  v_mfma_f32_16x16x32_bf16 a[72:75], v[32:35], v[64:67], a[72:75]
  v_mfma_f32_16x16x32_bf16 a[92:95], a[100:103], v[64:67], a[92:95]
  v_mfma_f32_16x16x32_bf16 a[16:19], v[20:23], v[68:71], a[16:19]
  ds_read_b128 v[64:67], v10 offset:8192
  v_mfma_f32_16x16x32_bf16 a[36:39], v[24:27], v[68:71], a[36:39]
  v_mfma_f32_16x16x32_bf16 a[56:59], v[28:31], v[68:71], a[56:59]
  v_mfma_f32_16x16x32_bf16 a[76:79], v[32:35], v[68:71], a[76:79]
  v_mfma_f32_16x16x32_bf16 a[96:99], a[100:103], v[68:71], a[96:99]
  v_mfma_f32_16x16x32_bf16 a[0:3], v[36:39], v[72:75], a[0:3]
  v_mfma_f32_16x16x32_bf16 a[20:23], v[40:43], v[72:75], a[20:23]
  s_waitcnt vmcnt(4)
  ds_read_b64_tr_b16 v[20:21], v13 offset:8192
  ds_read_b64_tr_b16 v[22:23], v13 offset:10240
  ds_read_b64_tr_b16 v[24:25], v14 offset:8192
  v_mfma_f32_16x16x32_bf16 a[40:43], v[44:47], v[72:75], a[40:43]
  ds_read_b64_tr_b16 v[26:27], v14 offset:10240
  ds_read_b64_tr_b16 v[28:29], v15 offset:8192
  ds_read_b64_tr_b16 v[30:31], v15 offset:10240
  v_mfma_f32_16x16x32_bf16 a[60:63], v[48:51], v[72:75], a[60:63]
  ds_read_b64_tr_b16 v[32:33], v16 offset:8192
  ds_read_b64_tr_b16 v[34:35], v16 offset:10240
  v_mfma_f32_16x16x32_bf16 a[4:7], v[36:39], v[52:55], a[4:7]
  v_mfma_f32_16x16x32_bf16 a[24:27], v[40:43], v[52:55], a[24:27]
  v_mfma_f32_16x16x32_bf16 a[44:47], v[44:47], v[52:55], a[44:47]
  v_mfma_f32_16x16x32_bf16 a[64:67], v[48:51], v[52:55], a[64:67]
  s_waitcnt lgkmcnt(10)
  v_mfma_f32_16x16x32_bf16 a[8:11], v[36:39], v[56:59], a[8:11]
  v_mfma_f32_16x16x32_bf16 a[28:31], v[40:43], v[56:59], a[28:31]
  v_mfma_f32_16x16x32_bf16 a[48:51], v[44:47], v[56:59], a[48:51]
  v_mfma_f32_16x16x32_bf16 a[68:71], v[48:51], v[56:59], a[68:71]
  s_waitcnt lgkmcnt(9)
  v_mfma_f32_16x16x32_bf16 a[12:15], v[36:39], v[60:63], a[12:15]
  v_mfma_f32_16x16x32_bf16 a[32:35], v[40:43], v[60:63], a[32:35]
  v_mfma_f32_16x16x32_bf16 a[52:55], v[44:47], v[60:63], a[52:55]
  v_mfma_f32_16x16x32_bf16 a[72:75], v[48:51], v[60:63], a[72:75]
  s_waitcnt lgkmcnt(8)
  v_mfma_f32_16x16x32_bf16 a[16:19], v[36:39], v[64:67], a[16:19]
  v_mfma_f32_16x16x32_bf16 a[36:39], v[40:43], v[64:67], a[36:39]
  v_mfma_f32_16x16x32_bf16 a[56:59], v[44:47], v[64:67], a[56:59]
  v_mfma_f32_16x16x32_bf16 a[76:79], v[48:51], v[64:67], a[76:79]
  s_waitcnt lgkmcnt(0)
  s_barrier
  s_cmp_lg_u32 s47, 0
  s_cbranch_scc1 RO_q15
BO_q15:
  ds_read_b128 v[52:55], v9 offset:10240
  ds_read_b128 v[56:59], v9 offset:12288
  ds_read_b128 v[60:63], v9 offset:14336
  ds_read_b128 v[64:67], v9 offset:16384
  ds_read_b128 v[68:71], v9 offset:18432
  ds_read_b128 v[72:75], v10 offset:10240
  s_waitcnt lgkmcnt(5)
  v_mfma_f32_16x16x32_bf16 a[0:3], v[20:23], v[52:55], a[0:3]
  s_waitcnt vmcnt(0)
  ds_read_b64_tr_b16 v[36:37], v13 offset:12288
  ds_read_b64_tr_b16 v[38:39], v13 offset:14336
  ds_read_b64_tr_b16 v[40:41], v14 offset:12288
  v_mfma_f32_16x16x32_bf16 a[20:23], v[24:27], v[52:55], a[20:23]
  ds_read_b64_tr_b16 v[42:43], v14 offset:14336
  ds_read_b64_tr_b16 v[44:45], v15 offset:12288
  ds_read_b64_tr_b16 v[46:47], v15 offset:14336
  v_mfma_f32_16x16x32_bf16 a[40:43], v[28:31], v[52:55], a[40:43]
  ds_read_b64_tr_b16 v[48:49], v16 offset:12288
  ds_read_b64_tr_b16 v[50:51], v16 offset:14336
  v_mfma_f32_16x16x32_bf16 a[60:63], v[32:35], v[52:55], a[60:63]
  v_mfma_f32_16x16x32_bf16 a[80:83], a[100:103], v[52:55], a[80:83]
  s_waitcnt lgkmcnt(12)
  v_mfma_f32_16x16x32_bf16 a[4:7], v[20:23], v[56:59], a[4:7]
  ds_read_b128 v[52:55], v10 offset:12288
  v_mfma_f32_16x16x32_bf16 a[24:27], v[24:27], v[56:59], a[24:27]
  v_mfma_f32_16x16x32_bf16 a[44:47], v[28:31], v[56:59], a[44:47]
  v_mfma_f32_16x16x32_bf16 a[64:67], v[32:35], v[56:59], a[64:67]
  v_mfma_f32_16x16x32_bf16 a[84:87], a[100:103], v[56:59], a[84:87]
  s_waitcnt lgkmcnt(12)
  v_mfma_f32_16x16x32_bf16 a[8:11], v[20:23], v[60:63], a[8:11]
  ds_read_b128 v[56:59], v10 offset:14336
  v_mfma_f32_16x16x32_bf16 a[28:31], v[24:27], v[60:63], a[28:31]
  v_mfma_f32_16x16x32_bf16 a[48:51], v[28:31], v[60:63], a[48:51]
  v_mfma_f32_16x16x32_bf16 a[68:71], v[32:35], v[60:63], a[68:71]
  v_mfma_f32_16x16x32_bf16 a[88:91], a[100:103], v[60:63], a[88:91]
  s_waitcnt lgkmcnt(12)
  v_mfma_f32_16x16x32_bf16 a[12:15], v[20:23], v[64:67], a[12:15]
  ds_read_b128 v[60:63], v10 offset:16384
  v_mfma_f32_16x16x32_bf16 a[32:35], v[24:27], v[64:67], a[32:35]
  v_mfma_f32_16x16x32_bf16 a[52:55], v[28:31], v[64:67], a[52:55]
  v_mfma_f32_16x16x32_bf16 a[72:75], v[32:35], v[64:67], a[72:75]
  v_mfma_f32_16x16x32_bf16 a[92:95], a[100:103], v[64:67], a[92:95]
  s_waitcnt lgkmcnt(12)
  v_mfma_f32_16x16x32_bf16 a[16:19], v[20:23], v[68:71], a[16:19]
  ds_read_b128 v[64:67], v10 offset:18432
  v_mfma_f32_16x16x32_bf16 a[36:39], v[24:27], v[68:71], a[36:39]
  v_mfma_f32_16x16x32_bf16 a[56:59], v[28:31], v[68:71], a[56:59]
  v_mfma_f32_16x16x32_bf16 a[76:79], v[32:35], v[68:71], a[76:79]
  v_mfma_f32_16x16x32_bf16 a[96:99], a[100:103], v[68:71], a[96:99]
  s_waitcnt lgkmcnt(10)
  v_mfma_f32_16x16x32_bf16 a[0:3], v[36:39], v[72:75], a[0:3]
  s_waitcnt lgkmcnt(8)
  v_mfma_f32_16x16x32_bf16 a[20:23], v[40:43], v[72:75], a[20:23]
  s_waitcnt lgkmcnt(6)
  v_mfma_f32_16x16x32_bf16 a[40:43], v[44:47], v[72:75], a[40:43]
  s_waitcnt lgkmcnt(4)
  v_mfma_f32_16x16x32_bf16 a[60:63], v[48:51], v[72:75], a[60:63]
  s_waitcnt lgkmcnt(3)
  v_mfma_f32_16x16x32_bf16 a[4:7], v[36:39], v[52:55], a[4:7]
  v_mfma_f32_16x16x32_bf16 a[24:27], v[40:43], v[52:55], a[24:27]
  v_mfma_f32_16x16x32_bf16 a[44:47], v[44:47], v[52:55], a[44:47]
  v_mfma_f32_16x16x32_bf16 a[64:67], v[48:51], v[52:55], a[64:67]
  s_waitcnt lgkmcnt(2)
  v_mfma_f32_16x16x32_bf16 a[8:11], v[36:39], v[56:59], a[8:11]
  v_mfma_f32_16x16x32_bf16 a[28:31], v[40:43], v[56:59], a[28:31]
  v_mfma_f32_16x16x32_bf16 a[48:51], v[44:47], v[56:59], a[48:51]
  v_mfma_f32_16x16x32_bf16 a[68:71], v[48:51], v[56:59], a[68:71]
  s_waitcnt lgkmcnt(1)
  v_mfma_f32_16x16x32_bf16 a[12:15], v[36:39], v[60:63], a[12:15]
  v_mfma_f32_16x16x32_bf16 a[32:35], v[40:43], v[60:63], a[32:35]
  v_mfma_f32_16x16x32_bf16 a[52:55], v[44:47], v[60:63], a[52:55]
  v_mfma_f32_16x16x32_bf16 a[72:75], v[48:51], v[60:63], a[72:75]
  s_waitcnt lgkmcnt(0)
  v_mfma_f32_16x16x32_bf16 a[16:19], v[36:39], v[64:67], a[16:19]
  v_mfma_f32_16x16x32_bf16 a[36:39], v[40:43], v[64:67], a[36:39]
  v_mfma_f32_16x16x32_bf16 a[56:59], v[44:47], v[64:67], a[56:59]
  v_mfma_f32_16x16x32_bf16 a[76:79], v[48:51], v[64:67], a[76:79]
  s_setprio 0
  v_lshlrev_b32 v5, 4, v1
  s_lshl_b32 s34, s28, 2
  v_add_u32 v19, s34, v5
  v_accvgpr_read_b32 v64, a80
  v_accvgpr_read_b32 v65, a84
  v_accvgpr_read_b32 v66, a88
  v_accvgpr_read_b32 v67, a92
  v_accvgpr_read_b32 v68, a96
  v_cmp_eq_u32 vcc, 1, v2
  s_nop 1
  v_cndmask_b32 v64, v64, v65, vcc
  v_cmp_eq_u32 vcc, 2, v2
  s_nop 1
  v_cndmask_b32 v64, v64, v66, vcc
  v_cmp_eq_u32 vcc, 3, v2
  s_nop 1
  v_cndmask_b32 v64, v64, v67, vcc
  v_and_b32 v4, 0xff, v19
  v_add_u32 v19, 161792, v19
  v_add_u32 v4, 161792, v4
  ds_write_b32 v19, v64
  ds_write_b32 v4, v68 offset:1024
  s_waitcnt vmcnt(0) lgkmcnt(0)
  s_waitcnt lgkmcnt(0)
  s_barrier
  s_lshl_b32 s97, s28, 14
  s_add_u32 s97, s97, 106496
  v_lshrrev_b32 v4, 3, v1
  v_and_b32 v5, 6, v4
  v_and_b32 v6, 7, v1
  v_xor_b32 v5, v5, v6
  v_lshlrev_b32 v5, 4, v5
  v_mul_u32_u24 v4, 896, v4
  v_add_u32 v4, v4, v5
  s_lshl_b32 s34, s70, 7
  v_add_u32 v95, s34, v4
  s_cmp_eq_u32 s70, 7
  s_cbranch_scc1 L_P7A
  s_add_u32 m0, s97, 0
  s_mov_b32 s35, 0
  buffer_load_dwordx4 v95, s[20:23], s35 offen lds
  s_add_u32 m0, s97, 1024
  s_mov_b32 s35, 7168
  buffer_load_dwordx4 v95, s[20:23], s35 offen lds
  s_add_u32 m0, s97, 2048
  s_mov_b32 s35, 14336
  buffer_load_dwordx4 v95, s[20:23], s35 offen lds
  s_add_u32 m0, s97, 3072
  s_mov_b32 s35, 21504
  buffer_load_dwordx4 v95, s[20:23], s35 offen lds
  s_add_u32 m0, s97, 4096
  s_mov_b32 s35, 28672
  buffer_load_dwordx4 v95, s[20:23], s35 offen lds
  s_add_u32 m0, s97, 5120
  s_mov_b32 s35, 35840
  buffer_load_dwordx4 v95, s[20:23], s35 offen lds
  s_add_u32 m0, s97, 6144
  s_mov_b32 s35, 43008
  buffer_load_dwordx4 v95, s[20:23], s35 offen lds
  s_add_u32 m0, s97, 7168
  s_mov_b32 s35, 50176
  buffer_load_dwordx4 v95, s[20:23], s35 offen lds
  s_add_u32 m0, s97, 8192
  s_mov_b32 s35, 57344
  buffer_load_dwordx4 v95, s[20:23], s35 offen lds
  s_add_u32 m0, s97, 9216
  s_mov_b32 s35, 64512
  buffer_load_dwordx4 v95, s[20:23], s35 offen lds
  s_add_u32 m0, s97, 10240
  s_mov_b32 s35, 71680
  buffer_load_dwordx4 v95, s[20:23], s35 offen lds
  s_add_u32 m0, s97, 11264
  s_mov_b32 s35, 78848
  buffer_load_dwordx4 v95, s[20:23], s35 offen lds
  s_add_u32 m0, s97, 12288
  s_mov_b32 s35, 86016
  buffer_load_dwordx4 v95, s[20:23], s35 offen lds
  s_add_u32 m0, s97, 13312
  s_mov_b32 s35, 93184
  buffer_load_dwordx4 v95, s[20:23], s35 offen lds
  s_add_u32 m0, s97, 14336
  s_mov_b32 s35, 100352
  buffer_load_dwordx4 v95, s[20:23], s35 offen lds
  s_add_u32 m0, s97, 15360
  s_mov_b32 s35, 107520
  buffer_load_dwordx4 v95, s[20:23], s35 offen lds
L_P7A:
  v_add_u32 v7, 161792, v17
  ds_read_b128 v[48:51], v7
  ds_read_b128 v[52:55], v7 offset:256
  ds_read_b128 v[56:59], v7 offset:512
  ds_read_b128 v[60:63], v7 offset:768
  ds_read_b128 v[64:67], v7 offset:1024
  s_waitcnt lgkmcnt(4)
  v_add_f32 v48, v48, v49
  s_waitcnt lgkmcnt(3)
  v_add_f32 v52, v52, v53
  s_waitcnt lgkmcnt(2)
  v_add_f32 v56, v56, v57
  s_waitcnt lgkmcnt(1)
  v_add_f32 v60, v60, v61
  s_waitcnt lgkmcnt(0)
  v_add_f32 v64, v64, v65
  v_add_f32 v50, v50, v51
  v_add_f32 v54, v54, v55
  v_add_f32 v58, v58, v59
  v_add_f32 v62, v62, v63
  v_add_f32 v66, v66, v67
  v_add_f32 v48, v48, v50
  v_add_f32 v52, v52, v54
  v_add_f32 v56, v56, v58
  v_add_f32 v60, v60, v62
  v_add_f32 v64, v64, v66
  v_rcp_f32 v84, v48
  v_rcp_f32 v85, v52
  v_rcp_f32 v86, v56
  v_rcp_f32 v87, v60
  v_rcp_f32 v88, v64
  v_lshrrev_b32 v4, 1, v2
  s_lshl_b32 s34, s28, 3
  v_add_u32 v4, s34, v4
  v_xor_b32 v4, v4, v3
  v_lshlrev_b32 v4, 4, v4
  v_lshl_add_u32 v4, v3, 9, v4
  v_and_b32 v5, 1, v2
  v_lshl_add_u32 v72, v5, 3, v4
  v_xor_b32 v73, 32, v72
  v_xor_b32 v74, 64, v72
  v_xor_b32 v75, 96, v72
  v_add_u32 v76, 90112, v72
  v_add_u32 v77, 90112, v73
  v_add_u32 v78, 90112, v74
  v_add_u32 v79, 90112, v75
  v_accvgpr_read_b32 v16, a0
  v_accvgpr_read_b32 v17, a1
  v_accvgpr_read_b32 v18, a2
  v_accvgpr_read_b32 v19, a3
  v_accvgpr_read_b32 v20, a20
  v_accvgpr_read_b32 v21, a21
  v_accvgpr_read_b32 v22, a22
  v_accvgpr_read_b32 v23, a23
  v_accvgpr_read_b32 v24, a40
  v_accvgpr_read_b32 v25, a41
  v_accvgpr_read_b32 v26, a42
  v_accvgpr_read_b32 v27, a43
  v_accvgpr_read_b32 v28, a60
  v_accvgpr_read_b32 v29, a61
  v_accvgpr_read_b32 v30, a62
  v_accvgpr_read_b32 v31, a63
  v_accvgpr_read_b32 v32, a4
  v_accvgpr_read_b32 v33, a5
  v_accvgpr_read_b32 v34, a6
  v_accvgpr_read_b32 v35, a7
  v_accvgpr_read_b32 v36, a24
  v_accvgpr_read_b32 v37, a25
  v_accvgpr_read_b32 v38, a26
  v_accvgpr_read_b32 v39, a27
  v_accvgpr_read_b32 v40, a44
  v_accvgpr_read_b32 v41, a45
  v_accvgpr_read_b32 v42, a46
  v_accvgpr_read_b32 v43, a47
  v_accvgpr_read_b32 v44, a64
  v_accvgpr_read_b32 v45, a65
  v_accvgpr_read_b32 v46, a66
  v_accvgpr_read_b32 v47, a67
  v_accvgpr_read_b32 v48, a8
  v_accvgpr_read_b32 v49, a9
  v_accvgpr_read_b32 v50, a10
  v_accvgpr_read_b32 v51, a11
  v_accvgpr_read_b32 v52, a28
  v_accvgpr_read_b32 v53, a29
  v_accvgpr_read_b32 v54, a30
  v_accvgpr_read_b32 v55, a31
  v_mul_f32 v16, v16, v84
  v_mul_f32 v17, v17, v84
  v_mul_f32 v18, v18, v84
  v_mul_f32 v19, v19, v84
  v_mul_f32 v20, v20, v84
  v_mul_f32 v21, v21, v84
  v_mul_f32 v22, v22, v84
  v_mul_f32 v23, v23, v84
  v_mul_f32 v24, v24, v84
  v_mul_f32 v25, v25, v84
  v_mul_f32 v26, v26, v84
  v_mul_f32 v27, v27, v84
  v_mul_f32 v28, v28, v84
  v_mul_f32 v29, v29, v84
  v_mul_f32 v30, v30, v84
  v_mul_f32 v31, v31, v84
  v_mul_f32 v32, v32, v85
  v_mul_f32 v33, v33, v85
  v_mul_f32 v34, v34, v85
  v_mul_f32 v35, v35, v85
  v_mul_f32 v36, v36, v85
  v_mul_f32 v37, v37, v85
  v_mul_f32 v38, v38, v85
  v_mul_f32 v39, v39, v85
  v_mul_f32 v40, v40, v85
  v_mul_f32 v41, v41, v85
  v_mul_f32 v42, v42, v85
  v_mul_f32 v43, v43, v85
  v_mul_f32 v44, v44, v85
  v_mul_f32 v45, v45, v85
  v_mul_f32 v46, v46, v85
  v_mul_f32 v47, v47, v85
  v_mul_f32 v48, v48, v86
  v_mul_f32 v49, v49, v86
  v_mul_f32 v50, v50, v86
  v_mul_f32 v51, v51, v86
  v_mul_f32 v52, v52, v86
  v_mul_f32 v53, v53, v86
  v_mul_f32 v54, v54, v86
  v_mul_f32 v55, v55, v86
  v_cvt_pk_bf16_f32 v16, v16, v17
  v_cvt_pk_bf16_f32 v17, v18, v19
  v_cvt_pk_bf16_f32 v20, v20, v21
  v_cvt_pk_bf16_f32 v21, v22, v23
  v_cvt_pk_bf16_f32 v24, v24, v25
  v_cvt_pk_bf16_f32 v25, v26, v27
  v_cvt_pk_bf16_f32 v28, v28, v29
  v_cvt_pk_bf16_f32 v29, v30, v31
  v_cvt_pk_bf16_f32 v32, v32, v33
  v_cvt_pk_bf16_f32 v33, v34, v35
  v_cvt_pk_bf16_f32 v36, v36, v37
  v_cvt_pk_bf16_f32 v37, v38, v39
  v_cvt_pk_bf16_f32 v40, v40, v41
  v_cvt_pk_bf16_f32 v41, v42, v43
  v_cvt_pk_bf16_f32 v44, v44, v45
  v_cvt_pk_bf16_f32 v45, v46, v47
  v_cvt_pk_bf16_f32 v48, v48, v49
  v_cvt_pk_bf16_f32 v49, v50, v51
  v_cvt_pk_bf16_f32 v52, v52, v53
  v_cvt_pk_bf16_f32 v53, v54, v55
  ds_write_b64 v72, v[16:17]
  ds_write_b64 v73, v[20:21]
  ds_write_b64 v74, v[24:25]
  ds_write_b64 v75, v[28:29]
  ds_write_b64 v72, v[32:33] offset:8192
  ds_write_b64 v73, v[36:37] offset:8192
  ds_write_b64 v74, v[40:41] offset:8192
  ds_write_b64 v75, v[44:45] offset:8192
  ds_write_b64 v72, v[48:49] offset:16384
  ds_write_b64 v73, v[52:53] offset:16384
  v_accvgpr_read_b32 v16, a48
  v_accvgpr_read_b32 v17, a49
  v_accvgpr_read_b32 v18, a50
  v_accvgpr_read_b32 v19, a51
  v_accvgpr_read_b32 v20, a68
  v_accvgpr_read_b32 v21, a69
  v_accvgpr_read_b32 v22, a70
  v_accvgpr_read_b32 v23, a71
  v_accvgpr_read_b32 v24, a12
  v_accvgpr_read_b32 v25, a13
  v_accvgpr_read_b32 v26, a14
  v_accvgpr_read_b32 v27, a15
  v_accvgpr_read_b32 v28, a32
  v_accvgpr_read_b32 v29, a33
  v_accvgpr_read_b32 v30, a34
  v_accvgpr_read_b32 v31, a35
  v_accvgpr_read_b32 v32, a52
  v_accvgpr_read_b32 v33, a53
  v_accvgpr_read_b32 v34, a54
  v_accvgpr_read_b32 v35, a55
  v_accvgpr_read_b32 v36, a72
  v_accvgpr_read_b32 v37, a73
  v_accvgpr_read_b32 v38, a74
  v_accvgpr_read_b32 v39, a75
  v_accvgpr_read_b32 v40, a16
  v_accvgpr_read_b32 v41, a17
  v_accvgpr_read_b32 v42, a18
  v_accvgpr_read_b32 v43, a19
  v_accvgpr_read_b32 v44, a36
  v_accvgpr_read_b32 v45, a37
  v_accvgpr_read_b32 v46, a38
  v_accvgpr_read_b32 v47, a39
  v_accvgpr_read_b32 v48, a56
  v_accvgpr_read_b32 v49, a57
  v_accvgpr_read_b32 v50, a58
  v_accvgpr_read_b32 v51, a59
  v_accvgpr_read_b32 v52, a76
  v_accvgpr_read_b32 v53, a77
  v_accvgpr_read_b32 v54, a78
  v_accvgpr_read_b32 v55, a79
  v_mul_f32 v16, v16, v86
  v_mul_f32 v17, v17, v86
  v_mul_f32 v18, v18, v86
  v_mul_f32 v19, v19, v86
  v_mul_f32 v20, v20, v86
  v_mul_f32 v21, v21, v86
  v_mul_f32 v22, v22, v86
  v_mul_f32 v23, v23, v86
  v_mul_f32 v24, v24, v87
  v_mul_f32 v25, v25, v87
  v_mul_f32 v26, v26, v87
  v_mul_f32 v27, v27, v87
  v_mul_f32 v28, v28, v87
  v_mul_f32 v29, v29, v87
  v_mul_f32 v30, v30, v87
  v_mul_f32 v31, v31, v87
  v_mul_f32 v32, v32, v87
  v_mul_f32 v33, v33, v87
  v_mul_f32 v34, v34, v87
  v_mul_f32 v35, v35, v87
  v_mul_f32 v36, v36, v87
  v_mul_f32 v37, v37, v87
  v_mul_f32 v38, v38, v87
  v_mul_f32 v39, v39, v87
  v_mul_f32 v40, v40, v88
  v_mul_f32 v41, v41, v88
  v_mul_f32 v42, v42, v88
  v_mul_f32 v43, v43, v88
  v_mul_f32 v44, v44, v88
  v_mul_f32 v45, v45, v88
  v_mul_f32 v46, v46, v88
  v_mul_f32 v47, v47, v88
  v_mul_f32 v48, v48, v88
  v_mul_f32 v49, v49, v88
  v_mul_f32 v50, v50, v88
  v_mul_f32 v51, v51, v88
  v_mul_f32 v52, v52, v88
  v_mul_f32 v53, v53, v88
  v_mul_f32 v54, v54, v88
  v_mul_f32 v55, v55, v88
  v_cvt_pk_bf16_f32 v16, v16, v17
  v_cvt_pk_bf16_f32 v17, v18, v19
  v_cvt_pk_bf16_f32 v20, v20, v21
  v_cvt_pk_bf16_f32 v21, v22, v23
  v_cvt_pk_bf16_f32 v24, v24, v25
  v_cvt_pk_bf16_f32 v25, v26, v27
  v_cvt_pk_bf16_f32 v28, v28, v29
  v_cvt_pk_bf16_f32 v29, v30, v31
  v_cvt_pk_bf16_f32 v32, v32, v33
  v_cvt_pk_bf16_f32 v33, v34, v35
  v_cvt_pk_bf16_f32 v36, v36, v37
  v_cvt_pk_bf16_f32 v37, v38, v39
  v_cvt_pk_bf16_f32 v40, v40, v41
  v_cvt_pk_bf16_f32 v41, v42, v43
  v_cvt_pk_bf16_f32 v44, v44, v45
  v_cvt_pk_bf16_f32 v45, v46, v47
  v_cvt_pk_bf16_f32 v48, v48, v49
  v_cvt_pk_bf16_f32 v49, v50, v51
  v_cvt_pk_bf16_f32 v52, v52, v53
  v_cvt_pk_bf16_f32 v53, v54, v55
  ds_write_b64 v74, v[16:17] offset:16384
  ds_write_b64 v75, v[20:21] offset:16384
  ds_write_b64 v76, v[24:25]
  ds_write_b64 v77, v[28:29]
  ds_write_b64 v78, v[32:33]
  ds_write_b64 v79, v[36:37]
  ds_write_b64 v76, v[40:41] offset:8192
  ds_write_b64 v77, v[44:45] offset:8192
  ds_write_b64 v78, v[48:49] offset:8192
  ds_write_b64 v79, v[52:53] offset:8192
  s_waitcnt lgkmcnt(0)
  s_barrier
  s_cmp_eq_u32 s70, 7
  s_cbranch_scc1 L_P7B
  v_xor_b32 v4, v2, v3
  v_lshlrev_b32 v4, 4, v4
  v_lshl_add_u32 v9, v3, 9, v4
  v_xor_b32 v11, 192, v9
  v_xor_b32 v10, 128, v9
  v_xor_b32 v76, 64, v9
  v_xor_b32 v8, 0, v9
  v_mov_b32 v9, v76
  v_add_u32 v12, 90112, v8
  v_add_u32 v13, 90112, v9
  v_add_u32 v14, 90112, v10
  v_add_u32 v15, 90112, v11
  v_lshrrev_b32 v4, 2, v3
  v_and_b32 v5, 3, v3
  v_lshlrev_b32 v6, 10, v2
  v_lshl_add_u32 v6, v4, 7, v6
  v_and_b32 v7, 2, v4
  v_lshl_add_u32 v6, v7, 4, v6
  v_lshl_add_u32 v6, v5, 3, v6
  v_add_u32 v72, s97, v6
  v_xor_b32 v73, 32, v72
  v_xor_b32 v74, 64, v72
  v_xor_b32 v75, 96, v72
  ds_read_b128 a[80:83], v8
  ds_read_b128 a[84:87], v8 offset:8192
  ds_read_b128 a[88:91], v8 offset:16384
  ds_read_b128 a[92:95], v12
  ds_read_b128 a[96:99], v12 offset:8192
  s_waitcnt vmcnt(12)
  ds_read_b64_tr_b16 v[16:17], v72
  ds_read_b64_tr_b16 v[18:19], v74 offset:512
  ds_read_b64_tr_b16 v[20:21], v73
  ds_read_b64_tr_b16 v[22:23], v75 offset:512
  ds_read_b64_tr_b16 v[24:25], v74
  ds_read_b64_tr_b16 v[26:27], v72 offset:512
  ds_read_b64_tr_b16 v[28:29], v75
  ds_read_b64_tr_b16 v[30:31], v73 offset:512
  s_waitcnt lgkmcnt(6)
  v_mfma_f32_16x16x32_bf16 a[0:3], v[16:19], a[80:83], 0
  ds_read_b128 a[100:103], v9
  ds_read_b128 a[104:107], v9 offset:8192
  s_waitcnt lgkmcnt(6)
  v_mfma_f32_16x16x32_bf16 a[20:23], v[20:23], a[80:83], 0
  ds_read_b128 a[108:111], v9 offset:16384
  ds_read_b128 a[112:115], v13
  s_waitcnt lgkmcnt(6)
  v_mfma_f32_16x16x32_bf16 a[40:43], v[24:27], a[80:83], 0
  ds_read_b128 a[116:119], v13 offset:8192
  s_waitcnt vmcnt(8)
  ds_read_b64_tr_b16 v[32:33], v72 offset:4096
  s_waitcnt lgkmcnt(6)
  v_mfma_f32_16x16x32_bf16 a[60:63], v[28:31], a[80:83], 0
  ds_read_b64_tr_b16 v[34:35], v74 offset:4608
  ds_read_b64_tr_b16 v[36:37], v73 offset:4096
  v_mfma_f32_16x16x32_bf16 a[4:7], v[16:19], a[84:87], 0
  s_add_u32 m0, s97, 0
  s_mov_b32 s35, 114688
  buffer_load_dwordx4 v95, s[20:23], s35 offen lds
  v_mfma_f32_16x16x32_bf16 a[24:27], v[20:23], a[84:87], 0
  ds_read_b64_tr_b16 v[38:39], v75 offset:4608
  ds_read_b64_tr_b16 v[40:41], v74 offset:4096
  v_mfma_f32_16x16x32_bf16 a[44:47], v[24:27], a[84:87], 0
  ds_read_b64_tr_b16 v[42:43], v72 offset:4608
  ds_read_b64_tr_b16 v[44:45], v75 offset:4096
  v_mfma_f32_16x16x32_bf16 a[64:67], v[28:31], a[84:87], 0
  ds_read_b64_tr_b16 v[46:47], v73 offset:4608
  v_mfma_f32_16x16x32_bf16 a[8:11], v[16:19], a[88:91], 0
  s_add_u32 m0, s97, 1024
  s_mov_b32 s35, 121856
  buffer_load_dwordx4 v95, s[20:23], s35 offen lds
  v_mfma_f32_16x16x32_bf16 a[28:31], v[20:23], a[88:91], 0
  v_mfma_f32_16x16x32_bf16 a[48:51], v[24:27], a[88:91], 0
  v_mfma_f32_16x16x32_bf16 a[68:71], v[28:31], a[88:91], 0
  v_mfma_f32_16x16x32_bf16 a[12:15], v[16:19], a[92:95], 0
  s_add_u32 m0, s97, 2048
  s_mov_b32 s35, 129024
  buffer_load_dwordx4 v95, s[20:23], s35 offen lds
  v_mfma_f32_16x16x32_bf16 a[32:35], v[20:23], a[92:95], 0
  v_mfma_f32_16x16x32_bf16 a[52:55], v[24:27], a[92:95], 0
  v_mfma_f32_16x16x32_bf16 a[72:75], v[28:31], a[92:95], 0
  v_mfma_f32_16x16x32_bf16 a[16:19], v[16:19], a[96:99], 0
  s_add_u32 m0, s97, 3072
  s_mov_b32 s35, 136192
  buffer_load_dwordx4 v95, s[20:23], s35 offen lds
  v_mfma_f32_16x16x32_bf16 a[36:39], v[20:23], a[96:99], 0
  v_mfma_f32_16x16x32_bf16 a[56:59], v[24:27], a[96:99], 0
  v_mfma_f32_16x16x32_bf16 a[76:79], v[28:31], a[96:99], 0
  s_waitcnt lgkmcnt(6)
  v_mfma_f32_16x16x32_bf16 a[0:3], v[32:35], a[100:103], a[0:3]
  ds_read_b128 a[80:83], v10
  ds_read_b128 a[84:87], v10 offset:8192
  s_waitcnt lgkmcnt(6)
  v_mfma_f32_16x16x32_bf16 a[20:23], v[36:39], a[100:103], a[20:23]
  ds_read_b128 a[88:91], v10 offset:16384
  ds_read_b128 a[92:95], v14
  s_waitcnt lgkmcnt(6)
  v_mfma_f32_16x16x32_bf16 a[40:43], v[40:43], a[100:103], a[40:43]
  ds_read_b128 a[96:99], v14 offset:8192
  s_waitcnt vmcnt(8)
  ds_read_b64_tr_b16 v[16:17], v72 offset:8192
  s_waitcnt lgkmcnt(6)
  v_mfma_f32_16x16x32_bf16 a[60:63], v[44:47], a[100:103], a[60:63]
  ds_read_b64_tr_b16 v[18:19], v74 offset:8704
  ds_read_b64_tr_b16 v[20:21], v73 offset:8192
  v_mfma_f32_16x16x32_bf16 a[4:7], v[32:35], a[104:107], a[4:7]
  s_add_u32 m0, s97, 4096
  s_mov_b32 s35, 143360
  buffer_load_dwordx4 v95, s[20:23], s35 offen lds
  v_mfma_f32_16x16x32_bf16 a[24:27], v[36:39], a[104:107], a[24:27]
  ds_read_b64_tr_b16 v[22:23], v75 offset:8704
  ds_read_b64_tr_b16 v[24:25], v74 offset:8192
  v_mfma_f32_16x16x32_bf16 a[44:47], v[40:43], a[104:107], a[44:47]
  ds_read_b64_tr_b16 v[26:27], v72 offset:8704
  ds_read_b64_tr_b16 v[28:29], v75 offset:8192
  v_mfma_f32_16x16x32_bf16 a[64:67], v[44:47], a[104:107], a[64:67]
  ds_read_b64_tr_b16 v[30:31], v73 offset:8704
  v_mfma_f32_16x16x32_bf16 a[8:11], v[32:35], a[108:111], a[8:11]
  s_add_u32 m0, s97, 5120
  s_mov_b32 s35, 150528
  buffer_load_dwordx4 v95, s[20:23], s35 offen lds
  v_mfma_f32_16x16x32_bf16 a[28:31], v[36:39], a[108:111], a[28:31]
  v_mfma_f32_16x16x32_bf16 a[48:51], v[40:43], a[108:111], a[48:51]
  v_mfma_f32_16x16x32_bf16 a[68:71], v[44:47], a[108:111], a[68:71]
  v_mfma_f32_16x16x32_bf16 a[12:15], v[32:35], a[112:115], a[12:15]
  s_add_u32 m0, s97, 6144
  s_mov_b32 s35, 157696
  buffer_load_dwordx4 v95, s[20:23], s35 offen lds
  v_mfma_f32_16x16x32_bf16 a[32:35], v[36:39], a[112:115], a[32:35]
  v_mfma_f32_16x16x32_bf16 a[52:55], v[40:43], a[112:115], a[52:55]
  v_mfma_f32_16x16x32_bf16 a[72:75], v[44:47], a[112:115], a[72:75]
  v_mfma_f32_16x16x32_bf16 a[16:19], v[32:35], a[116:119], a[16:19]
  s_add_u32 m0, s97, 7168
  s_mov_b32 s35, 164864
  buffer_load_dwordx4 v95, s[20:23], s35 offen lds
  v_mfma_f32_16x16x32_bf16 a[36:39], v[36:39], a[116:119], a[36:39]
  v_mfma_f32_16x16x32_bf16 a[56:59], v[40:43], a[116:119], a[56:59]
  v_mfma_f32_16x16x32_bf16 a[76:79], v[44:47], a[116:119], a[76:79]
  s_waitcnt lgkmcnt(6)
  v_mfma_f32_16x16x32_bf16 a[0:3], v[16:19], a[80:83], a[0:3]
  ds_read_b128 a[100:103], v11
  ds_read_b128 a[104:107], v11 offset:8192
  s_waitcnt lgkmcnt(6)
  v_mfma_f32_16x16x32_bf16 a[20:23], v[20:23], a[80:83], a[20:23]
  ds_read_b128 a[108:111], v11 offset:16384
  ds_read_b128 a[112:115], v15
  s_waitcnt lgkmcnt(6)
  v_mfma_f32_16x16x32_bf16 a[40:43], v[24:27], a[80:83], a[40:43]
  ds_read_b128 a[116:119], v15 offset:8192
  s_waitcnt vmcnt(8)
  ds_read_b64_tr_b16 v[32:33], v72 offset:12288
  s_waitcnt lgkmcnt(6)
  v_mfma_f32_16x16x32_bf16 a[60:63], v[28:31], a[80:83], a[60:63]
  ds_read_b64_tr_b16 v[34:35], v74 offset:12800
  ds_read_b64_tr_b16 v[36:37], v73 offset:12288
  v_mfma_f32_16x16x32_bf16 a[4:7], v[16:19], a[84:87], a[4:7]
  s_add_u32 m0, s97, 8192
  s_mov_b32 s35, 172032
  buffer_load_dwordx4 v95, s[20:23], s35 offen lds
  v_mfma_f32_16x16x32_bf16 a[24:27], v[20:23], a[84:87], a[24:27]
  ds_read_b64_tr_b16 v[38:39], v75 offset:12800
  ds_read_b64_tr_b16 v[40:41], v74 offset:12288
  v_mfma_f32_16x16x32_bf16 a[44:47], v[24:27], a[84:87], a[44:47]
  ds_read_b64_tr_b16 v[42:43], v72 offset:12800
  ds_read_b64_tr_b16 v[44:45], v75 offset:12288
  v_mfma_f32_16x16x32_bf16 a[64:67], v[28:31], a[84:87], a[64:67]
  ds_read_b64_tr_b16 v[46:47], v73 offset:12800
  v_mfma_f32_16x16x32_bf16 a[8:11], v[16:19], a[88:91], a[8:11]
  s_add_u32 m0, s97, 9216
  s_mov_b32 s35, 179200
  buffer_load_dwordx4 v95, s[20:23], s35 offen lds
  v_mfma_f32_16x16x32_bf16 a[28:31], v[20:23], a[88:91], a[28:31]
  v_mfma_f32_16x16x32_bf16 a[48:51], v[24:27], a[88:91], a[48:51]
  v_mfma_f32_16x16x32_bf16 a[68:71], v[28:31], a[88:91], a[68:71]
  v_mfma_f32_16x16x32_bf16 a[12:15], v[16:19], a[92:95], a[12:15]
  s_add_u32 m0, s97, 10240
  s_mov_b32 s35, 186368
  buffer_load_dwordx4 v95, s[20:23], s35 offen lds
  v_mfma_f32_16x16x32_bf16 a[32:35], v[20:23], a[92:95], a[32:35]
  v_mfma_f32_16x16x32_bf16 a[52:55], v[24:27], a[92:95], a[52:55]
  v_mfma_f32_16x16x32_bf16 a[72:75], v[28:31], a[92:95], a[72:75]
  v_mfma_f32_16x16x32_bf16 a[16:19], v[16:19], a[96:99], a[16:19]
  s_add_u32 m0, s97, 11264
  s_mov_b32 s35, 193536
  buffer_load_dwordx4 v95, s[20:23], s35 offen lds
  v_mfma_f32_16x16x32_bf16 a[36:39], v[20:23], a[96:99], a[36:39]
  v_mfma_f32_16x16x32_bf16 a[56:59], v[24:27], a[96:99], a[56:59]
  v_mfma_f32_16x16x32_bf16 a[76:79], v[28:31], a[96:99], a[76:79]
  s_waitcnt lgkmcnt(6)
  v_mfma_f32_16x16x32_bf16 a[0:3], v[32:35], a[100:103], a[0:3]
  ds_read_b128 a[80:83], v8 offset:256
  ds_read_b128 a[84:87], v8 offset:8448
  s_waitcnt lgkmcnt(6)
  v_mfma_f32_16x16x32_bf16 a[20:23], v[36:39], a[100:103], a[20:23]
  ds_read_b128 a[88:91], v8 offset:16640
  ds_read_b128 a[92:95], v12 offset:256
  s_waitcnt lgkmcnt(6)
  v_mfma_f32_16x16x32_bf16 a[40:43], v[40:43], a[100:103], a[40:43]
  ds_read_b128 a[96:99], v12 offset:8448
  s_waitcnt vmcnt(8)
  ds_read_b64_tr_b16 v[16:17], v72
  s_waitcnt lgkmcnt(6)
  v_mfma_f32_16x16x32_bf16 a[60:63], v[44:47], a[100:103], a[60:63]
  ds_read_b64_tr_b16 v[18:19], v74 offset:512
  ds_read_b64_tr_b16 v[20:21], v73
  v_mfma_f32_16x16x32_bf16 a[4:7], v[32:35], a[104:107], a[4:7]
  s_add_u32 m0, s97, 12288
  s_mov_b32 s35, 200704
  buffer_load_dwordx4 v95, s[20:23], s35 offen lds
  v_mfma_f32_16x16x32_bf16 a[24:27], v[36:39], a[104:107], a[24:27]
  ds_read_b64_tr_b16 v[22:23], v75 offset:512
  ds_read_b64_tr_b16 v[24:25], v74
  v_mfma_f32_16x16x32_bf16 a[44:47], v[40:43], a[104:107], a[44:47]
  ds_read_b64_tr_b16 v[26:27], v72 offset:512
  ds_read_b64_tr_b16 v[28:29], v75
  v_mfma_f32_16x16x32_bf16 a[64:67], v[44:47], a[104:107], a[64:67]
  ds_read_b64_tr_b16 v[30:31], v73 offset:512
  v_mfma_f32_16x16x32_bf16 a[8:11], v[32:35], a[108:111], a[8:11]
  s_add_u32 m0, s97, 13312
  s_mov_b32 s35, 207872
  buffer_load_dwordx4 v95, s[20:23], s35 offen lds
  v_mfma_f32_16x16x32_bf16 a[28:31], v[36:39], a[108:111], a[28:31]
  v_mfma_f32_16x16x32_bf16 a[48:51], v[40:43], a[108:111], a[48:51]
  v_mfma_f32_16x16x32_bf16 a[68:71], v[44:47], a[108:111], a[68:71]
  v_mfma_f32_16x16x32_bf16 a[12:15], v[32:35], a[112:115], a[12:15]
  s_add_u32 m0, s97, 14336
  s_mov_b32 s35, 215040
  buffer_load_dwordx4 v95, s[20:23], s35 offen lds
  v_mfma_f32_16x16x32_bf16 a[32:35], v[36:39], a[112:115], a[32:35]
  v_mfma_f32_16x16x32_bf16 a[52:55], v[40:43], a[112:115], a[52:55]
  v_mfma_f32_16x16x32_bf16 a[72:75], v[44:47], a[112:115], a[72:75]
  v_mfma_f32_16x16x32_bf16 a[16:19], v[32:35], a[116:119], a[16:19]
  s_add_u32 m0, s97, 15360
  s_mov_b32 s35, 222208
  buffer_load_dwordx4 v95, s[20:23], s35 offen lds
  v_mfma_f32_16x16x32_bf16 a[36:39], v[36:39], a[116:119], a[36:39]
  v_mfma_f32_16x16x32_bf16 a[56:59], v[40:43], a[116:119], a[56:59]
  v_mfma_f32_16x16x32_bf16 a[76:79], v[44:47], a[116:119], a[76:79]
  s_waitcnt lgkmcnt(6)
  v_mfma_f32_16x16x32_bf16 a[0:3], v[16:19], a[80:83], a[0:3]
  ds_read_b128 a[100:103], v9 offset:256
  ds_read_b128 a[104:107], v9 offset:8448
  s_waitcnt lgkmcnt(6)
  v_mfma_f32_16x16x32_bf16 a[20:23], v[20:23], a[80:83], a[20:23]
  ds_read_b128 a[108:111], v9 offset:16640
  ds_read_b128 a[112:115], v13 offset:256
  s_waitcnt lgkmcnt(6)
  v_mfma_f32_16x16x32_bf16 a[40:43], v[24:27], a[80:83], a[40:43]
  ds_read_b128 a[116:119], v13 offset:8448
  s_waitcnt vmcnt(8)
  ds_read_b64_tr_b16 v[32:33], v72 offset:4096
  s_waitcnt lgkmcnt(6)
  v_mfma_f32_16x16x32_bf16 a[60:63], v[28:31], a[80:83], a[60:63]
  ds_read_b64_tr_b16 v[34:35], v74 offset:4608
  ds_read_b64_tr_b16 v[36:37], v73 offset:4096
  v_mfma_f32_16x16x32_bf16 a[4:7], v[16:19], a[84:87], a[4:7]
  ds_read_b64_tr_b16 v[38:39], v75 offset:4608
  ds_read_b64_tr_b16 v[40:41], v74 offset:4096
  v_mfma_f32_16x16x32_bf16 a[24:27], v[20:23], a[84:87], a[24:27]
  ds_read_b64_tr_b16 v[42:43], v72 offset:4608
  ds_read_b64_tr_b16 v[44:45], v75 offset:4096
  v_mfma_f32_16x16x32_bf16 a[44:47], v[24:27], a[84:87], a[44:47]
  ds_read_b64_tr_b16 v[46:47], v73 offset:4608
  v_mfma_f32_16x16x32_bf16 a[64:67], v[28:31], a[84:87], a[64:67]
  v_mfma_f32_16x16x32_bf16 a[8:11], v[16:19], a[88:91], a[8:11]
  v_mfma_f32_16x16x32_bf16 a[28:31], v[20:23], a[88:91], a[28:31]
  v_mfma_f32_16x16x32_bf16 a[48:51], v[24:27], a[88:91], a[48:51]
  v_mfma_f32_16x16x32_bf16 a[68:71], v[28:31], a[88:91], a[68:71]
  v_mfma_f32_16x16x32_bf16 a[12:15], v[16:19], a[92:95], a[12:15]
  v_mfma_f32_16x16x32_bf16 a[32:35], v[20:23], a[92:95], a[32:35]
  v_mfma_f32_16x16x32_bf16 a[52:55], v[24:27], a[92:95], a[52:55]
  v_mfma_f32_16x16x32_bf16 a[72:75], v[28:31], a[92:95], a[72:75]
  v_mfma_f32_16x16x32_bf16 a[16:19], v[16:19], a[96:99], a[16:19]
  v_mfma_f32_16x16x32_bf16 a[36:39], v[20:23], a[96:99], a[36:39]
  v_mfma_f32_16x16x32_bf16 a[56:59], v[24:27], a[96:99], a[56:59]
  v_mfma_f32_16x16x32_bf16 a[76:79], v[28:31], a[96:99], a[76:79]
  s_waitcnt lgkmcnt(6)
  v_mfma_f32_16x16x32_bf16 a[0:3], v[32:35], a[100:103], a[0:3]
  ds_read_b128 a[80:83], v10 offset:256
  ds_read_b128 a[84:87], v10 offset:8448
  s_waitcnt lgkmcnt(6)
  v_mfma_f32_16x16x32_bf16 a[20:23], v[36:39], a[100:103], a[20:23]
  ds_read_b128 a[88:91], v10 offset:16640
  ds_read_b128 a[92:95], v14 offset:256
  s_waitcnt lgkmcnt(6)
  v_mfma_f32_16x16x32_bf16 a[40:43], v[40:43], a[100:103], a[40:43]
  ds_read_b128 a[96:99], v14 offset:8448
  s_waitcnt vmcnt(4)
  ds_read_b64_tr_b16 v[16:17], v72 offset:8192
  s_waitcnt lgkmcnt(6)
  v_mfma_f32_16x16x32_bf16 a[60:63], v[44:47], a[100:103], a[60:63]
  ds_read_b64_tr_b16 v[18:19], v74 offset:8704
  ds_read_b64_tr_b16 v[20:21], v73 offset:8192
  v_mfma_f32_16x16x32_bf16 a[4:7], v[32:35], a[104:107], a[4:7]
  ds_read_b64_tr_b16 v[22:23], v75 offset:8704
  ds_read_b64_tr_b16 v[24:25], v74 offset:8192
  v_mfma_f32_16x16x32_bf16 a[24:27], v[36:39], a[104:107], a[24:27]
  ds_read_b64_tr_b16 v[26:27], v72 offset:8704
  ds_read_b64_tr_b16 v[28:29], v75 offset:8192
  v_mfma_f32_16x16x32_bf16 a[44:47], v[40:43], a[104:107], a[44:47]
  ds_read_b64_tr_b16 v[30:31], v73 offset:8704
  v_mfma_f32_16x16x32_bf16 a[64:67], v[44:47], a[104:107], a[64:67]
  v_mfma_f32_16x16x32_bf16 a[8:11], v[32:35], a[108:111], a[8:11]
  v_mfma_f32_16x16x32_bf16 a[28:31], v[36:39], a[108:111], a[28:31]
  v_mfma_f32_16x16x32_bf16 a[48:51], v[40:43], a[108:111], a[48:51]
  v_mfma_f32_16x16x32_bf16 a[68:71], v[44:47], a[108:111], a[68:71]
  v_mfma_f32_16x16x32_bf16 a[12:15], v[32:35], a[112:115], a[12:15]
  v_mfma_f32_16x16x32_bf16 a[32:35], v[36:39], a[112:115], a[32:35]
  v_mfma_f32_16x16x32_bf16 a[52:55], v[40:43], a[112:115], a[52:55]
  v_mfma_f32_16x16x32_bf16 a[72:75], v[44:47], a[112:115], a[72:75]
  v_mfma_f32_16x16x32_bf16 a[16:19], v[32:35], a[116:119], a[16:19]
  v_mfma_f32_16x16x32_bf16 a[36:39], v[36:39], a[116:119], a[36:39]
  v_mfma_f32_16x16x32_bf16 a[56:59], v[40:43], a[116:119], a[56:59]
  v_mfma_f32_16x16x32_bf16 a[76:79], v[44:47], a[116:119], a[76:79]
  s_waitcnt lgkmcnt(6)
  v_mfma_f32_16x16x32_bf16 a[0:3], v[16:19], a[80:83], a[0:3]
  ds_read_b128 a[100:103], v11 offset:256
  ds_read_b128 a[104:107], v11 offset:8448
  s_waitcnt lgkmcnt(6)
  v_mfma_f32_16x16x32_bf16 a[20:23], v[20:23], a[80:83], a[20:23]
  ds_read_b128 a[108:111], v11 offset:16640
  ds_read_b128 a[112:115], v15 offset:256
  s_waitcnt lgkmcnt(6)
  v_mfma_f32_16x16x32_bf16 a[40:43], v[24:27], a[80:83], a[40:43]
  ds_read_b128 a[116:119], v15 offset:8448
  s_waitcnt vmcnt(0)
  ds_read_b64_tr_b16 v[32:33], v72 offset:12288
  s_waitcnt lgkmcnt(6)
  v_mfma_f32_16x16x32_bf16 a[60:63], v[28:31], a[80:83], a[60:63]
  ds_read_b64_tr_b16 v[34:35], v74 offset:12800
  ds_read_b64_tr_b16 v[36:37], v73 offset:12288
  v_mfma_f32_16x16x32_bf16 a[4:7], v[16:19], a[84:87], a[4:7]
  ds_read_b64_tr_b16 v[38:39], v75 offset:12800
  ds_read_b64_tr_b16 v[40:41], v74 offset:12288
  v_mfma_f32_16x16x32_bf16 a[24:27], v[20:23], a[84:87], a[24:27]
  ds_read_b64_tr_b16 v[42:43], v72 offset:12800
  ds_read_b64_tr_b16 v[44:45], v75 offset:12288
  v_mfma_f32_16x16x32_bf16 a[44:47], v[24:27], a[84:87], a[44:47]
  ds_read_b64_tr_b16 v[46:47], v73 offset:12800
  v_mfma_f32_16x16x32_bf16 a[64:67], v[28:31], a[84:87], a[64:67]
  v_mfma_f32_16x16x32_bf16 a[8:11], v[16:19], a[88:91], a[8:11]
  v_mfma_f32_16x16x32_bf16 a[28:31], v[20:23], a[88:91], a[28:31]
  v_mfma_f32_16x16x32_bf16 a[48:51], v[24:27], a[88:91], a[48:51]
  v_mfma_f32_16x16x32_bf16 a[68:71], v[28:31], a[88:91], a[68:71]
  v_mfma_f32_16x16x32_bf16 a[12:15], v[16:19], a[92:95], a[12:15]
  v_mfma_f32_16x16x32_bf16 a[32:35], v[20:23], a[92:95], a[32:35]
  v_mfma_f32_16x16x32_bf16 a[52:55], v[24:27], a[92:95], a[52:55]
  v_mfma_f32_16x16x32_bf16 a[72:75], v[28:31], a[92:95], a[72:75]
  v_mfma_f32_16x16x32_bf16 a[16:19], v[16:19], a[96:99], a[16:19]
  v_mfma_f32_16x16x32_bf16 a[36:39], v[20:23], a[96:99], a[36:39]
  v_mfma_f32_16x16x32_bf16 a[56:59], v[24:27], a[96:99], a[56:59]
  v_mfma_f32_16x16x32_bf16 a[76:79], v[28:31], a[96:99], a[76:79]
  s_waitcnt lgkmcnt(6)
  v_mfma_f32_16x16x32_bf16 a[0:3], v[32:35], a[100:103], a[0:3]
  s_waitcnt lgkmcnt(4)
  v_mfma_f32_16x16x32_bf16 a[20:23], v[36:39], a[100:103], a[20:23]
  s_waitcnt lgkmcnt(2)
  v_mfma_f32_16x16x32_bf16 a[40:43], v[40:43], a[100:103], a[40:43]
  s_waitcnt lgkmcnt(0)
  v_mfma_f32_16x16x32_bf16 a[60:63], v[44:47], a[100:103], a[60:63]
  v_mfma_f32_16x16x32_bf16 a[4:7], v[32:35], a[104:107], a[4:7]
  v_mfma_f32_16x16x32_bf16 a[24:27], v[36:39], a[104:107], a[24:27]
  v_mfma_f32_16x16x32_bf16 a[44:47], v[40:43], a[104:107], a[44:47]
  v_mfma_f32_16x16x32_bf16 a[64:67], v[44:47], a[104:107], a[64:67]
  v_mfma_f32_16x16x32_bf16 a[8:11], v[32:35], a[108:111], a[8:11]
  v_mfma_f32_16x16x32_bf16 a[28:31], v[36:39], a[108:111], a[28:31]
  v_mfma_f32_16x16x32_bf16 a[48:51], v[40:43], a[108:111], a[48:51]
  v_mfma_f32_16x16x32_bf16 a[68:71], v[44:47], a[108:111], a[68:71]
  v_mfma_f32_16x16x32_bf16 a[12:15], v[32:35], a[112:115], a[12:15]
  v_mfma_f32_16x16x32_bf16 a[32:35], v[36:39], a[112:115], a[32:35]
  v_mfma_f32_16x16x32_bf16 a[52:55], v[40:43], a[112:115], a[52:55]
  v_mfma_f32_16x16x32_bf16 a[72:75], v[44:47], a[112:115], a[72:75]
  v_mfma_f32_16x16x32_bf16 a[16:19], v[32:35], a[116:119], a[16:19]
  v_mfma_f32_16x16x32_bf16 a[36:39], v[36:39], a[116:119], a[36:39]
  v_mfma_f32_16x16x32_bf16 a[56:59], v[40:43], a[116:119], a[56:59]
  v_mfma_f32_16x16x32_bf16 a[76:79], v[44:47], a[116:119], a[76:79]
  s_waitcnt vmcnt(0) lgkmcnt(0)
  v_mul_u32_u24 v4, 144, v3
  v_lshl_add_u32 v4, v2, 3, v4
  v_add_u32 v8, s97, v4
  v_lshrrev_b32 v4, 3, v1
  v_and_b32 v5, 7, v1
  v_mul_u32_u24 v6, 144, v4
  v_lshl_add_u32 v6, v5, 4, v6
  v_add_u32 v9, s97, v6
  v_mul_u32_u24 v6, 896, v4
  v_lshl_add_u32 v10, v5, 4, v6
  s_lshl_b32 s34, s70, 7
  v_accvgpr_read_b32 v16, a0
  v_accvgpr_read_b32 v17, a1
  v_accvgpr_read_b32 v18, a2
  v_accvgpr_read_b32 v19, a3
  v_accvgpr_read_b32 v20, a20
  v_accvgpr_read_b32 v21, a21
  v_accvgpr_read_b32 v22, a22
  v_accvgpr_read_b32 v23, a23
  v_accvgpr_read_b32 v24, a40
  v_accvgpr_read_b32 v25, a41
  v_accvgpr_read_b32 v26, a42
  v_accvgpr_read_b32 v27, a43
  v_accvgpr_read_b32 v28, a60
  v_accvgpr_read_b32 v29, a61
  v_accvgpr_read_b32 v30, a62
  v_accvgpr_read_b32 v31, a63
  v_accvgpr_read_b32 v32, a4
  v_accvgpr_read_b32 v33, a5
  v_accvgpr_read_b32 v34, a6
  v_accvgpr_read_b32 v35, a7
  v_accvgpr_read_b32 v36, a24
  v_accvgpr_read_b32 v37, a25
  v_accvgpr_read_b32 v38, a26
  v_accvgpr_read_b32 v39, a27
  v_accvgpr_read_b32 v40, a44
  v_accvgpr_read_b32 v41, a45
  v_accvgpr_read_b32 v42, a46
  v_accvgpr_read_b32 v43, a47
  v_accvgpr_read_b32 v44, a64
  v_accvgpr_read_b32 v45, a65
  v_accvgpr_read_b32 v46, a66
  v_accvgpr_read_b32 v47, a67
  v_accvgpr_read_b32 v48, a8
  v_accvgpr_read_b32 v49, a9
  v_accvgpr_read_b32 v50, a10
  v_accvgpr_read_b32 v51, a11
  v_accvgpr_read_b32 v52, a28
  v_accvgpr_read_b32 v53, a29
  v_accvgpr_read_b32 v54, a30
  v_accvgpr_read_b32 v55, a31
  v_accvgpr_read_b32 v56, a48
  v_accvgpr_read_b32 v57, a49
  v_accvgpr_read_b32 v58, a50
  v_accvgpr_read_b32 v59, a51
  v_accvgpr_read_b32 v60, a68
  v_accvgpr_read_b32 v61, a69
  v_accvgpr_read_b32 v62, a70
  v_accvgpr_read_b32 v63, a71
  v_accvgpr_read_b32 v64, a12
  v_accvgpr_read_b32 v65, a13
  v_accvgpr_read_b32 v66, a14
  v_accvgpr_read_b32 v67, a15
  v_accvgpr_read_b32 v68, a32
  v_accvgpr_read_b32 v69, a33
  v_accvgpr_read_b32 v70, a34
  v_accvgpr_read_b32 v71, a35
  v_accvgpr_read_b32 v72, a52
  v_accvgpr_read_b32 v73, a53
  v_accvgpr_read_b32 v74, a54
  v_accvgpr_read_b32 v75, a55
  v_accvgpr_read_b32 v76, a72
  v_accvgpr_read_b32 v77, a73
  v_accvgpr_read_b32 v78, a74
  v_accvgpr_read_b32 v79, a75
  v_accvgpr_read_b32 v80, a16
  v_accvgpr_read_b32 v81, a17
  v_accvgpr_read_b32 v82, a18
  v_accvgpr_read_b32 v83, a19
  v_accvgpr_read_b32 v84, a36
  v_accvgpr_read_b32 v85, a37
  v_accvgpr_read_b32 v86, a38
  v_accvgpr_read_b32 v87, a39
  v_accvgpr_read_b32 v88, a56
  v_accvgpr_read_b32 v89, a57
  v_accvgpr_read_b32 v90, a58
  v_accvgpr_read_b32 v91, a59
  v_accvgpr_read_b32 v92, a76
  v_accvgpr_read_b32 v93, a77
  v_accvgpr_read_b32 v94, a78
  v_accvgpr_read_b32 v95, a79
  v_cvt_pk_bf16_f32 v16, v16, v17
  v_cvt_pk_bf16_f32 v17, v18, v19
  v_cvt_pk_bf16_f32 v20, v20, v21
  v_cvt_pk_bf16_f32 v21, v22, v23
  v_cvt_pk_bf16_f32 v24, v24, v25
  v_cvt_pk_bf16_f32 v25, v26, v27
  v_cvt_pk_bf16_f32 v28, v28, v29
  v_cvt_pk_bf16_f32 v29, v30, v31
  v_cvt_pk_bf16_f32 v32, v32, v33
  v_cvt_pk_bf16_f32 v33, v34, v35
  v_cvt_pk_bf16_f32 v36, v36, v37
  v_cvt_pk_bf16_f32 v37, v38, v39
  v_cvt_pk_bf16_f32 v40, v40, v41
  v_cvt_pk_bf16_f32 v41, v42, v43
  v_cvt_pk_bf16_f32 v44, v44, v45
  v_cvt_pk_bf16_f32 v45, v46, v47
  v_cvt_pk_bf16_f32 v48, v48, v49
  v_cvt_pk_bf16_f32 v49, v50, v51
  v_cvt_pk_bf16_f32 v52, v52, v53
  v_cvt_pk_bf16_f32 v53, v54, v55
  v_cvt_pk_bf16_f32 v56, v56, v57
  v_cvt_pk_bf16_f32 v57, v58, v59
  v_cvt_pk_bf16_f32 v60, v60, v61
  v_cvt_pk_bf16_f32 v61, v62, v63
  v_cvt_pk_bf16_f32 v64, v64, v65
  v_cvt_pk_bf16_f32 v65, v66, v67
  v_cvt_pk_bf16_f32 v68, v68, v69
  v_cvt_pk_bf16_f32 v69, v70, v71
  v_cvt_pk_bf16_f32 v72, v72, v73
  v_cvt_pk_bf16_f32 v73, v74, v75
  v_cvt_pk_bf16_f32 v76, v76, v77
  v_cvt_pk_bf16_f32 v77, v78, v79
  v_cvt_pk_bf16_f32 v80, v80, v81
  v_cvt_pk_bf16_f32 v81, v82, v83
  v_cvt_pk_bf16_f32 v84, v84, v85
  v_cvt_pk_bf16_f32 v85, v86, v87
  v_cvt_pk_bf16_f32 v88, v88, v89
  v_cvt_pk_bf16_f32 v89, v90, v91
  v_cvt_pk_bf16_f32 v92, v92, v93
  v_cvt_pk_bf16_f32 v93, v94, v95
  ds_write_b64 v8, v[16:17]
  ds_write_b64 v8, v[20:21] offset:32
  ds_write_b64 v8, v[24:25] offset:64
  ds_write_b64 v8, v[28:29] offset:96
  ds_write_b64 v8, v[32:33] offset:2304
  ds_write_b64 v8, v[36:37] offset:2336
  ds_write_b64 v8, v[40:41] offset:2368
  ds_write_b64 v8, v[44:45] offset:2400
  ds_write_b64 v8, v[48:49] offset:4608
  ds_write_b64 v8, v[52:53] offset:4640
  ds_write_b64 v8, v[56:57] offset:4672
  ds_write_b64 v8, v[60:61] offset:4704
  ds_write_b64 v8, v[64:65] offset:6912
  ds_write_b64 v8, v[68:69] offset:6944
  ds_write_b64 v8, v[72:73] offset:6976
  ds_write_b64 v8, v[76:77] offset:7008
  ds_write_b64 v8, v[80:81] offset:9216
  ds_write_b64 v8, v[84:85] offset:9248
  ds_write_b64 v8, v[88:89] offset:9280
  ds_write_b64 v8, v[92:93] offset:9312
  ds_read_b128 v[16:19], v9
  ds_read_b128 v[20:23], v9 offset:1152
  ds_read_b128 v[24:27], v9 offset:2304
  ds_read_b128 v[28:31], v9 offset:3456
  ds_read_b128 v[32:35], v9 offset:4608
  ds_read_b128 v[36:39], v9 offset:5760
  ds_read_b128 v[40:43], v9 offset:6912
  ds_read_b128 v[44:47], v9 offset:8064
  ds_read_b128 v[48:51], v9 offset:9216
  ds_read_b128 v[52:55], v9 offset:10368
  s_add_u32 s35, s34, 0
  s_waitcnt lgkmcnt(9)
  buffer_store_dwordx4 v[16:19], v10, s[24:27], s35 offen
  s_add_u32 s35, s34, 7168
  s_waitcnt lgkmcnt(8)
  buffer_store_dwordx4 v[20:23], v10, s[24:27], s35 offen
  s_add_u32 s35, s34, 14336
  s_waitcnt lgkmcnt(7)
  buffer_store_dwordx4 v[24:27], v10, s[24:27], s35 offen
  s_add_u32 s35, s34, 21504
  s_waitcnt lgkmcnt(6)
  buffer_store_dwordx4 v[28:31], v10, s[24:27], s35 offen
  s_add_u32 s35, s34, 28672
  s_waitcnt lgkmcnt(5)
  buffer_store_dwordx4 v[32:35], v10, s[24:27], s35 offen
  s_add_u32 s35, s34, 35840
  s_waitcnt lgkmcnt(4)
  buffer_store_dwordx4 v[36:39], v10, s[24:27], s35 offen
  s_add_u32 s35, s34, 43008
  s_waitcnt lgkmcnt(3)
  buffer_store_dwordx4 v[40:43], v10, s[24:27], s35 offen
  s_add_u32 s35, s34, 50176
  s_waitcnt lgkmcnt(2)
  buffer_store_dwordx4 v[44:47], v10, s[24:27], s35 offen
  s_add_u32 s35, s34, 57344
  s_waitcnt lgkmcnt(1)
  buffer_store_dwordx4 v[48:51], v10, s[24:27], s35 offen
  s_add_u32 s35, s34, 64512
  s_waitcnt lgkmcnt(0)
  buffer_store_dwordx4 v[52:55], v10, s[24:27], s35 offen
L_P7B:
  s_waitcnt vmcnt(0) lgkmcnt(0)
  s_endpgm
L_END:
  s_endpgm
RS_h1:
  v_cmp_lt_f32 vcc, s48, v73
  s_nop 1
  v_cndmask_b32 v92, v92, v72, vcc
  v_cmp_lt_f32 vcc, s48, v77
  s_nop 1
  v_cndmask_b32 v93, v93, v76, vcc
  v_cmp_lt_f32 vcc, s48, v81
  s_nop 1
  v_cndmask_b32 v94, v94, v80, vcc
  v_cmp_lt_f32 vcc, s48, v85
  s_nop 1
  v_cndmask_b32 v14, v14, v84, vcc
  v_cmp_lt_f32 vcc, s48, v89
  s_nop 1
  v_cndmask_b32 v15, v15, v88, vcc
  s_nop 1
  s_branch BS_h1
RS_hA:
  v_cmp_lt_f32 vcc, s48, v73
  s_nop 1
  v_cndmask_b32 v92, v92, v72, vcc
  v_cmp_lt_f32 vcc, s48, v77
  s_nop 1
  v_cndmask_b32 v93, v93, v76, vcc
  v_cmp_lt_f32 vcc, s48, v81
  s_nop 1
  v_cndmask_b32 v94, v94, v80, vcc
  v_cmp_lt_f32 vcc, s48, v85
  s_nop 1
  v_cndmask_b32 v14, v14, v84, vcc
  v_cmp_lt_f32 vcc, s48, v89
  s_nop 1
  v_cndmask_b32 v15, v15, v88, vcc
  s_nop 1
  s_branch BS_hA
RS_hB:
  v_cmp_lt_f32 vcc, s48, v73
  s_nop 1
  v_cndmask_b32 v92, v92, v72, vcc
  v_cmp_lt_f32 vcc, s48, v77
  s_nop 1
  v_cndmask_b32 v93, v93, v76, vcc
  v_cmp_lt_f32 vcc, s48, v81
  s_nop 1
  v_cndmask_b32 v94, v94, v80, vcc
  v_cmp_lt_f32 vcc, s48, v85
  s_nop 1
  v_cndmask_b32 v14, v14, v84, vcc
  v_cmp_lt_f32 vcc, s48, v89
  s_nop 1
  v_cndmask_b32 v15, v15, v88, vcc
  s_nop 1
  s_branch BS_hB
RS_h14:
  v_cmp_lt_f32 vcc, s48, v73
  s_nop 1
  v_cndmask_b32 v92, v92, v72, vcc
  v_cmp_lt_f32 vcc, s48, v77
  s_nop 1
  v_cndmask_b32 v93, v93, v76, vcc
  v_cmp_lt_f32 vcc, s48, v81
  s_nop 1
  v_cndmask_b32 v94, v94, v80, vcc
  v_cmp_lt_f32 vcc, s48, v85
  s_nop 1
  v_cndmask_b32 v14, v14, v84, vcc
  v_cmp_lt_f32 vcc, s48, v89
  s_nop 1
  v_cndmask_b32 v15, v15, v88, vcc
  s_nop 1
  s_branch BS_h14
RS_h15:
  v_cmp_lt_f32 vcc, s48, v73
  s_nop 1
  v_cndmask_b32 v92, v92, v72, vcc
  v_cmp_lt_f32 vcc, s48, v77
  s_nop 1
  v_cndmask_b32 v93, v93, v76, vcc
  v_cmp_lt_f32 vcc, s48, v81
  s_nop 1
  v_cndmask_b32 v94, v94, v80, vcc
  v_cmp_lt_f32 vcc, s48, v85
  s_nop 1
  v_cndmask_b32 v14, v14, v84, vcc
  v_cmp_lt_f32 vcc, s48, v89
  s_nop 1
  v_cndmask_b32 v15, v15, v88, vcc
  s_nop 1
  s_branch BS_h15
RO_q0:
  s_nop 15
  v_accvgpr_read_b32 v76, a104
  v_accvgpr_read_b32 v4, a0
  v_accvgpr_read_b32 v5, a1
  v_accvgpr_read_b32 v6, a2
  v_accvgpr_read_b32 v7, a3
  s_nop 0
  v_mul_f32 v4, v4, v76
  v_mul_f32 v5, v5, v76
  v_mul_f32 v6, v6, v76
  v_mul_f32 v7, v7, v76
  s_nop 0
  v_accvgpr_write_b32 a0, v4
  v_accvgpr_write_b32 a1, v5
  v_accvgpr_write_b32 a2, v6
  v_accvgpr_write_b32 a3, v7
  v_accvgpr_read_b32 v4, a20
  v_accvgpr_read_b32 v5, a21
  v_accvgpr_read_b32 v6, a22
  v_accvgpr_read_b32 v7, a23
  s_nop 0
  v_mul_f32 v4, v4, v76
  v_mul_f32 v5, v5, v76
  v_mul_f32 v6, v6, v76
  v_mul_f32 v7, v7, v76
  s_nop 0
  v_accvgpr_write_b32 a20, v4
  v_accvgpr_write_b32 a21, v5
  v_accvgpr_write_b32 a22, v6
  v_accvgpr_write_b32 a23, v7
  v_accvgpr_read_b32 v4, a40
  v_accvgpr_read_b32 v5, a41
  v_accvgpr_read_b32 v6, a42
  v_accvgpr_read_b32 v7, a43
  s_nop 0
  v_mul_f32 v4, v4, v76
  v_mul_f32 v5, v5, v76
  v_mul_f32 v6, v6, v76
  v_mul_f32 v7, v7, v76
  s_nop 0
  v_accvgpr_write_b32 a40, v4
  v_accvgpr_write_b32 a41, v5
  v_accvgpr_write_b32 a42, v6
  v_accvgpr_write_b32 a43, v7
  v_accvgpr_read_b32 v4, a60
  v_accvgpr_read_b32 v5, a61
  v_accvgpr_read_b32 v6, a62
  v_accvgpr_read_b32 v7, a63
  s_nop 0
  v_mul_f32 v4, v4, v76
  v_mul_f32 v5, v5, v76
  v_mul_f32 v6, v6, v76
  v_mul_f32 v7, v7, v76
  s_nop 0
  v_accvgpr_write_b32 a60, v4
  v_accvgpr_write_b32 a61, v5
  v_accvgpr_write_b32 a62, v6
  v_accvgpr_write_b32 a63, v7
  v_accvgpr_read_b32 v4, a80
  v_accvgpr_read_b32 v5, a81
  v_accvgpr_read_b32 v6, a82
  v_accvgpr_read_b32 v7, a83
  s_nop 0
  v_mul_f32 v4, v4, v76
  v_mul_f32 v5, v5, v76
  v_mul_f32 v6, v6, v76
  v_mul_f32 v7, v7, v76
  s_nop 0
  v_accvgpr_write_b32 a80, v4
  v_accvgpr_write_b32 a81, v5
  v_accvgpr_write_b32 a82, v6
  v_accvgpr_write_b32 a83, v7
  v_mov_b32 v76, 1.0
  s_nop 0
  v_accvgpr_write_b32 a104, v76
  v_accvgpr_read_b32 v76, a105
  v_accvgpr_read_b32 v4, a4
  v_accvgpr_read_b32 v5, a5
  v_accvgpr_read_b32 v6, a6
  v_accvgpr_read_b32 v7, a7
  s_nop 0
  v_mul_f32 v4, v4, v76
  v_mul_f32 v5, v5, v76
  v_mul_f32 v6, v6, v76
  v_mul_f32 v7, v7, v76
  s_nop 0
  v_accvgpr_write_b32 a4, v4
  v_accvgpr_write_b32 a5, v5
  v_accvgpr_write_b32 a6, v6
  v_accvgpr_write_b32 a7, v7
  v_accvgpr_read_b32 v4, a24
  v_accvgpr_read_b32 v5, a25
  v_accvgpr_read_b32 v6, a26
  v_accvgpr_read_b32 v7, a27
  s_nop 0
  v_mul_f32 v4, v4, v76
  v_mul_f32 v5, v5, v76
  v_mul_f32 v6, v6, v76
  v_mul_f32 v7, v7, v76
  s_nop 0
  v_accvgpr_write_b32 a24, v4
  v_accvgpr_write_b32 a25, v5
  v_accvgpr_write_b32 a26, v6
  v_accvgpr_write_b32 a27, v7
  v_accvgpr_read_b32 v4, a44
  v_accvgpr_read_b32 v5, a45
  v_accvgpr_read_b32 v6, a46
  v_accvgpr_read_b32 v7, a47
  s_nop 0
  v_mul_f32 v4, v4, v76
  v_mul_f32 v5, v5, v76
  v_mul_f32 v6, v6, v76
  v_mul_f32 v7, v7, v76
  s_nop 0
  v_accvgpr_write_b32 a44, v4
  v_accvgpr_write_b32 a45, v5
  v_accvgpr_write_b32 a46, v6
  v_accvgpr_write_b32 a47, v7
  v_accvgpr_read_b32 v4, a64
  v_accvgpr_read_b32 v5, a65
  v_accvgpr_read_b32 v6, a66
  v_accvgpr_read_b32 v7, a67
  s_nop 0
  v_mul_f32 v4, v4, v76
  v_mul_f32 v5, v5, v76
  v_mul_f32 v6, v6, v76
  v_mul_f32 v7, v7, v76
  s_nop 0
  v_accvgpr_write_b32 a64, v4
  v_accvgpr_write_b32 a65, v5
  v_accvgpr_write_b32 a66, v6
  v_accvgpr_write_b32 a67, v7
  v_accvgpr_read_b32 v4, a84
  v_accvgpr_read_b32 v5, a85
  v_accvgpr_read_b32 v6, a86
  v_accvgpr_read_b32 v7, a87
  s_nop 0
  v_mul_f32 v4, v4, v76
  v_mul_f32 v5, v5, v76
  v_mul_f32 v6, v6, v76
  v_mul_f32 v7, v7, v76
  s_nop 0
  v_accvgpr_write_b32 a84, v4
  v_accvgpr_write_b32 a85, v5
  v_accvgpr_write_b32 a86, v6
  v_accvgpr_write_b32 a87, v7
  v_mov_b32 v76, 1.0
  s_nop 0
  v_accvgpr_write_b32 a105, v76
  v_accvgpr_read_b32 v76, a106
  v_accvgpr_read_b32 v4, a8
  v_accvgpr_read_b32 v5, a9
  v_accvgpr_read_b32 v6, a10
  v_accvgpr_read_b32 v7, a11
  s_nop 0
  v_mul_f32 v4, v4, v76
  v_mul_f32 v5, v5, v76
  v_mul_f32 v6, v6, v76
  v_mul_f32 v7, v7, v76
  s_nop 0
  v_accvgpr_write_b32 a8, v4
  v_accvgpr_write_b32 a9, v5
  v_accvgpr_write_b32 a10, v6
  v_accvgpr_write_b32 a11, v7
  v_accvgpr_read_b32 v4, a28
  v_accvgpr_read_b32 v5, a29
  v_accvgpr_read_b32 v6, a30
  v_accvgpr_read_b32 v7, a31
  s_nop 0
  v_mul_f32 v4, v4, v76
  v_mul_f32 v5, v5, v76
  v_mul_f32 v6, v6, v76
  v_mul_f32 v7, v7, v76
  s_nop 0
  v_accvgpr_write_b32 a28, v4
  v_accvgpr_write_b32 a29, v5
  v_accvgpr_write_b32 a30, v6
  v_accvgpr_write_b32 a31, v7
  v_accvgpr_read_b32 v4, a48
  v_accvgpr_read_b32 v5, a49
  v_accvgpr_read_b32 v6, a50
  v_accvgpr_read_b32 v7, a51
  s_nop 0
  v_mul_f32 v4, v4, v76
  v_mul_f32 v5, v5, v76
  v_mul_f32 v6, v6, v76
  v_mul_f32 v7, v7, v76
  s_nop 0
  v_accvgpr_write_b32 a48, v4
  v_accvgpr_write_b32 a49, v5
  v_accvgpr_write_b32 a50, v6
  v_accvgpr_write_b32 a51, v7
  v_accvgpr_read_b32 v4, a68
  v_accvgpr_read_b32 v5, a69
  v_accvgpr_read_b32 v6, a70
  v_accvgpr_read_b32 v7, a71
  s_nop 0
  v_mul_f32 v4, v4, v76
  v_mul_f32 v5, v5, v76
  v_mul_f32 v6, v6, v76
  v_mul_f32 v7, v7, v76
  s_nop 0
  v_accvgpr_write_b32 a68, v4
  v_accvgpr_write_b32 a69, v5
  v_accvgpr_write_b32 a70, v6
  v_accvgpr_write_b32 a71, v7
  v_accvgpr_read_b32 v4, a88
  v_accvgpr_read_b32 v5, a89
  v_accvgpr_read_b32 v6, a90
  v_accvgpr_read_b32 v7, a91
  s_nop 0
  v_mul_f32 v4, v4, v76
  v_mul_f32 v5, v5, v76
  v_mul_f32 v6, v6, v76
  v_mul_f32 v7, v7, v76
  s_nop 0
  v_accvgpr_write_b32 a88, v4
  v_accvgpr_write_b32 a89, v5
  v_accvgpr_write_b32 a90, v6
  v_accvgpr_write_b32 a91, v7
  v_mov_b32 v76, 1.0
  s_nop 0
  v_accvgpr_write_b32 a106, v76
  v_accvgpr_read_b32 v76, a107
  v_accvgpr_read_b32 v4, a12
  v_accvgpr_read_b32 v5, a13
  v_accvgpr_read_b32 v6, a14
  v_accvgpr_read_b32 v7, a15
  s_nop 0
  v_mul_f32 v4, v4, v76
  v_mul_f32 v5, v5, v76
  v_mul_f32 v6, v6, v76
  v_mul_f32 v7, v7, v76
  s_nop 0
  v_accvgpr_write_b32 a12, v4
  v_accvgpr_write_b32 a13, v5
  v_accvgpr_write_b32 a14, v6
  v_accvgpr_write_b32 a15, v7
  v_accvgpr_read_b32 v4, a32
  v_accvgpr_read_b32 v5, a33
  v_accvgpr_read_b32 v6, a34
  v_accvgpr_read_b32 v7, a35
  s_nop 0
  v_mul_f32 v4, v4, v76
  v_mul_f32 v5, v5, v76
  v_mul_f32 v6, v6, v76
  v_mul_f32 v7, v7, v76
  s_nop 0
  v_accvgpr_write_b32 a32, v4
  v_accvgpr_write_b32 a33, v5
  v_accvgpr_write_b32 a34, v6
  v_accvgpr_write_b32 a35, v7
  v_accvgpr_read_b32 v4, a52
  v_accvgpr_read_b32 v5, a53
  v_accvgpr_read_b32 v6, a54
  v_accvgpr_read_b32 v7, a55
  s_nop 0
  v_mul_f32 v4, v4, v76
  v_mul_f32 v5, v5, v76
  v_mul_f32 v6, v6, v76
  v_mul_f32 v7, v7, v76
  s_nop 0
  v_accvgpr_write_b32 a52, v4
  v_accvgpr_write_b32 a53, v5
  v_accvgpr_write_b32 a54, v6
  v_accvgpr_write_b32 a55, v7
  v_accvgpr_read_b32 v4, a72
  v_accvgpr_read_b32 v5, a73
  v_accvgpr_read_b32 v6, a74
  v_accvgpr_read_b32 v7, a75
  s_nop 0
  v_mul_f32 v4, v4, v76
  v_mul_f32 v5, v5, v76
  v_mul_f32 v6, v6, v76
  v_mul_f32 v7, v7, v76
  s_nop 0
  v_accvgpr_write_b32 a72, v4
  v_accvgpr_write_b32 a73, v5
  v_accvgpr_write_b32 a74, v6
  v_accvgpr_write_b32 a75, v7
  v_accvgpr_read_b32 v4, a92
  v_accvgpr_read_b32 v5, a93
  v_accvgpr_read_b32 v6, a94
  v_accvgpr_read_b32 v7, a95
  s_nop 0
  v_mul_f32 v4, v4, v76
  v_mul_f32 v5, v5, v76
  v_mul_f32 v6, v6, v76
  v_mul_f32 v7, v7, v76
  s_nop 0
  v_accvgpr_write_b32 a92, v4
  v_accvgpr_write_b32 a93, v5
  v_accvgpr_write_b32 a94, v6
  v_accvgpr_write_b32 a95, v7
  v_mov_b32 v76, 1.0
  s_nop 0
  v_accvgpr_write_b32 a107, v76
  v_accvgpr_read_b32 v76, a108
  v_accvgpr_read_b32 v4, a16
  v_accvgpr_read_b32 v5, a17
  v_accvgpr_read_b32 v6, a18
  v_accvgpr_read_b32 v7, a19
  s_nop 0
  v_mul_f32 v4, v4, v76
  v_mul_f32 v5, v5, v76
  v_mul_f32 v6, v6, v76
  v_mul_f32 v7, v7, v76
  s_nop 0
  v_accvgpr_write_b32 a16, v4
  v_accvgpr_write_b32 a17, v5
  v_accvgpr_write_b32 a18, v6
  v_accvgpr_write_b32 a19, v7
  v_accvgpr_read_b32 v4, a36
  v_accvgpr_read_b32 v5, a37
  v_accvgpr_read_b32 v6, a38
  v_accvgpr_read_b32 v7, a39
  s_nop 0
  v_mul_f32 v4, v4, v76
  v_mul_f32 v5, v5, v76
  v_mul_f32 v6, v6, v76
  v_mul_f32 v7, v7, v76
  s_nop 0
  v_accvgpr_write_b32 a36, v4
  v_accvgpr_write_b32 a37, v5
  v_accvgpr_write_b32 a38, v6
  v_accvgpr_write_b32 a39, v7
  v_accvgpr_read_b32 v4, a56
  v_accvgpr_read_b32 v5, a57
  v_accvgpr_read_b32 v6, a58
  v_accvgpr_read_b32 v7, a59
  s_nop 0
  v_mul_f32 v4, v4, v76
  v_mul_f32 v5, v5, v76
  v_mul_f32 v6, v6, v76
  v_mul_f32 v7, v7, v76
  s_nop 0
  v_accvgpr_write_b32 a56, v4
  v_accvgpr_write_b32 a57, v5
  v_accvgpr_write_b32 a58, v6
  v_accvgpr_write_b32 a59, v7
  v_accvgpr_read_b32 v4, a76
  v_accvgpr_read_b32 v5, a77
  v_accvgpr_read_b32 v6, a78
  v_accvgpr_read_b32 v7, a79
  s_nop 0
  v_mul_f32 v4, v4, v76
  v_mul_f32 v5, v5, v76
  v_mul_f32 v6, v6, v76
  v_mul_f32 v7, v7, v76
  s_nop 0
  v_accvgpr_write_b32 a76, v4
  v_accvgpr_write_b32 a77, v5
  v_accvgpr_write_b32 a78, v6
  v_accvgpr_write_b32 a79, v7
  v_accvgpr_read_b32 v4, a96
  v_accvgpr_read_b32 v5, a97
  v_accvgpr_read_b32 v6, a98
  v_accvgpr_read_b32 v7, a99
  s_nop 0
  v_mul_f32 v4, v4, v76
  v_mul_f32 v5, v5, v76
  v_mul_f32 v6, v6, v76
  v_mul_f32 v7, v7, v76
  s_nop 0
  v_accvgpr_write_b32 a96, v4
  v_accvgpr_write_b32 a97, v5
  v_accvgpr_write_b32 a98, v6
  v_accvgpr_write_b32 a99, v7
  v_mov_b32 v76, 1.0
  s_nop 0
  v_accvgpr_write_b32 a108, v76
  s_mov_b32 s47, 0
  s_nop 3
  s_branch BO_q0
RP_q00:
  v_cmp_lt_f32 vcc, s48, v77
  s_nop 1
  v_cndmask_b32 v76, v88, v76, vcc
  v_sub_f32 v77, v88, v76
  v_exp_f32 v77, v77
  v_mov_b32 v88, v76
  v_accvgpr_read_b32 v78, a104
  s_nop 0
  v_mul_f32 v77, v77, v78
  s_nop 0
  v_accvgpr_write_b32 a104, v77
  v_cmp_lt_f32 vcc, s48, v81
  s_nop 1
  v_cndmask_b32 v80, v89, v80, vcc
  v_sub_f32 v81, v89, v80
  v_exp_f32 v81, v81
  v_mov_b32 v89, v80
  v_accvgpr_read_b32 v82, a105
  s_nop 0
  v_mul_f32 v81, v81, v82
  s_nop 0
  v_accvgpr_write_b32 a105, v81
  v_cmp_lt_f32 vcc, s48, v85
  s_nop 1
  v_cndmask_b32 v84, v90, v84, vcc
  v_sub_f32 v85, v90, v84
  v_exp_f32 v85, v85
  v_mov_b32 v90, v84
  v_accvgpr_read_b32 v86, a106
  s_nop 0
  v_mul_f32 v85, v85, v86
  s_nop 0
  v_accvgpr_write_b32 a106, v85
  s_mov_b32 s47, 1
  s_nop 1
  s_branch BP_q00
RP_q01:
  v_cmp_lt_f32 vcc, s48, v77
  s_nop 1
  v_cndmask_b32 v76, v91, v76, vcc
  v_sub_f32 v77, v91, v76
  v_exp_f32 v77, v77
  v_mov_b32 v91, v76
  v_accvgpr_read_b32 v78, a107
  s_nop 0
  v_mul_f32 v77, v77, v78
  s_nop 0
  v_accvgpr_write_b32 a107, v77
  v_cmp_lt_f32 vcc, s48, v81
  s_nop 1
  v_cndmask_b32 v80, v92, v80, vcc
  v_sub_f32 v81, v92, v80
  v_exp_f32 v81, v81
  v_mov_b32 v92, v80
  v_accvgpr_read_b32 v82, a108
  s_nop 0
  v_mul_f32 v81, v81, v82
  s_nop 0
  v_accvgpr_write_b32 a108, v81
  s_mov_b32 s47, 1
  s_nop 1
  s_branch BP_q01
RO_q1:
  s_nop 15
  v_accvgpr_read_b32 v76, a104
  v_accvgpr_read_b32 v4, a0
  v_accvgpr_read_b32 v5, a1
  v_accvgpr_read_b32 v6, a2
  v_accvgpr_read_b32 v7, a3
  s_nop 0
  v_mul_f32 v4, v4, v76
  v_mul_f32 v5, v5, v76
  v_mul_f32 v6, v6, v76
  v_mul_f32 v7, v7, v76
  s_nop 0
  v_accvgpr_write_b32 a0, v4
  v_accvgpr_write_b32 a1, v5
  v_accvgpr_write_b32 a2, v6
  v_accvgpr_write_b32 a3, v7
  v_accvgpr_read_b32 v4, a20
  v_accvgpr_read_b32 v5, a21
  v_accvgpr_read_b32 v6, a22
  v_accvgpr_read_b32 v7, a23
  s_nop 0
  v_mul_f32 v4, v4, v76
  v_mul_f32 v5, v5, v76
  v_mul_f32 v6, v6, v76
  v_mul_f32 v7, v7, v76
  s_nop 0
  v_accvgpr_write_b32 a20, v4
  v_accvgpr_write_b32 a21, v5
  v_accvgpr_write_b32 a22, v6
  v_accvgpr_write_b32 a23, v7
  v_accvgpr_read_b32 v4, a40
  v_accvgpr_read_b32 v5, a41
  v_accvgpr_read_b32 v6, a42
  v_accvgpr_read_b32 v7, a43
  s_nop 0
  v_mul_f32 v4, v4, v76
  v_mul_f32 v5, v5, v76
  v_mul_f32 v6, v6, v76
  v_mul_f32 v7, v7, v76
  s_nop 0
  v_accvgpr_write_b32 a40, v4
  v_accvgpr_write_b32 a41, v5
  v_accvgpr_write_b32 a42, v6
  v_accvgpr_write_b32 a43, v7
  v_accvgpr_read_b32 v4, a60
  v_accvgpr_read_b32 v5, a61
  v_accvgpr_read_b32 v6, a62
  v_accvgpr_read_b32 v7, a63
  s_nop 0
  v_mul_f32 v4, v4, v76
  v_mul_f32 v5, v5, v76
  v_mul_f32 v6, v6, v76
  v_mul_f32 v7, v7, v76
  s_nop 0
  v_accvgpr_write_b32 a60, v4
  v_accvgpr_write_b32 a61, v5
  v_accvgpr_write_b32 a62, v6
  v_accvgpr_write_b32 a63, v7
  v_accvgpr_read_b32 v4, a80
  v_accvgpr_read_b32 v5, a81
  v_accvgpr_read_b32 v6, a82
  v_accvgpr_read_b32 v7, a83
  s_nop 0
  v_mul_f32 v4, v4, v76
  v_mul_f32 v5, v5, v76
  v_mul_f32 v6, v6, v76
  v_mul_f32 v7, v7, v76
  s_nop 0
  v_accvgpr_write_b32 a80, v4
  v_accvgpr_write_b32 a81, v5
  v_accvgpr_write_b32 a82, v6
  v_accvgpr_write_b32 a83, v7
  v_mov_b32 v76, 1.0
  s_nop 0
  v_accvgpr_write_b32 a104, v76
  v_accvgpr_read_b32 v76, a105
  v_accvgpr_read_b32 v4, a4
  v_accvgpr_read_b32 v5, a5
  v_accvgpr_read_b32 v6, a6
  v_accvgpr_read_b32 v7, a7
  s_nop 0
  v_mul_f32 v4, v4, v76
  v_mul_f32 v5, v5, v76
  v_mul_f32 v6, v6, v76
  v_mul_f32 v7, v7, v76
  s_nop 0
  v_accvgpr_write_b32 a4, v4
  v_accvgpr_write_b32 a5, v5
  v_accvgpr_write_b32 a6, v6
  v_accvgpr_write_b32 a7, v7
  v_accvgpr_read_b32 v4, a24
  v_accvgpr_read_b32 v5, a25
  v_accvgpr_read_b32 v6, a26
  v_accvgpr_read_b32 v7, a27
  s_nop 0
  v_mul_f32 v4, v4, v76
  v_mul_f32 v5, v5, v76
  v_mul_f32 v6, v6, v76
  v_mul_f32 v7, v7, v76
  s_nop 0
  v_accvgpr_write_b32 a24, v4
  v_accvgpr_write_b32 a25, v5
  v_accvgpr_write_b32 a26, v6
  v_accvgpr_write_b32 a27, v7
  v_accvgpr_read_b32 v4, a44
  v_accvgpr_read_b32 v5, a45
  v_accvgpr_read_b32 v6, a46
  v_accvgpr_read_b32 v7, a47
  s_nop 0
  v_mul_f32 v4, v4, v76
  v_mul_f32 v5, v5, v76
  v_mul_f32 v6, v6, v76
  v_mul_f32 v7, v7, v76
  s_nop 0
  v_accvgpr_write_b32 a44, v4
  v_accvgpr_write_b32 a45, v5
  v_accvgpr_write_b32 a46, v6
  v_accvgpr_write_b32 a47, v7
  v_accvgpr_read_b32 v4, a64
  v_accvgpr_read_b32 v5, a65
  v_accvgpr_read_b32 v6, a66
  v_accvgpr_read_b32 v7, a67
  s_nop 0
  v_mul_f32 v4, v4, v76
  v_mul_f32 v5, v5, v76
  v_mul_f32 v6, v6, v76
  v_mul_f32 v7, v7, v76
  s_nop 0
  v_accvgpr_write_b32 a64, v4
  v_accvgpr_write_b32 a65, v5
  v_accvgpr_write_b32 a66, v6
  v_accvgpr_write_b32 a67, v7
  v_accvgpr_read_b32 v4, a84
  v_accvgpr_read_b32 v5, a85
  v_accvgpr_read_b32 v6, a86
  v_accvgpr_read_b32 v7, a87
  s_nop 0
  v_mul_f32 v4, v4, v76
  v_mul_f32 v5, v5, v76
  v_mul_f32 v6, v6, v76
  v_mul_f32 v7, v7, v76
  s_nop 0
  v_accvgpr_write_b32 a84, v4
  v_accvgpr_write_b32 a85, v5
  v_accvgpr_write_b32 a86, v6
  v_accvgpr_write_b32 a87, v7
  v_mov_b32 v76, 1.0
  s_nop 0
  v_accvgpr_write_b32 a105, v76
  v_accvgpr_read_b32 v76, a106
  v_accvgpr_read_b32 v4, a8
  v_accvgpr_read_b32 v5, a9
  v_accvgpr_read_b32 v6, a10
  v_accvgpr_read_b32 v7, a11
  s_nop 0
  v_mul_f32 v4, v4, v76
  v_mul_f32 v5, v5, v76
  v_mul_f32 v6, v6, v76
  v_mul_f32 v7, v7, v76
  s_nop 0
  v_accvgpr_write_b32 a8, v4
  v_accvgpr_write_b32 a9, v5
  v_accvgpr_write_b32 a10, v6
  v_accvgpr_write_b32 a11, v7
  v_accvgpr_read_b32 v4, a28
  v_accvgpr_read_b32 v5, a29
  v_accvgpr_read_b32 v6, a30
  v_accvgpr_read_b32 v7, a31
  s_nop 0
  v_mul_f32 v4, v4, v76
  v_mul_f32 v5, v5, v76
  v_mul_f32 v6, v6, v76
  v_mul_f32 v7, v7, v76
  s_nop 0
  v_accvgpr_write_b32 a28, v4
  v_accvgpr_write_b32 a29, v5
  v_accvgpr_write_b32 a30, v6
  v_accvgpr_write_b32 a31, v7
  v_accvgpr_read_b32 v4, a48
  v_accvgpr_read_b32 v5, a49
  v_accvgpr_read_b32 v6, a50
  v_accvgpr_read_b32 v7, a51
  s_nop 0
  v_mul_f32 v4, v4, v76
  v_mul_f32 v5, v5, v76
  v_mul_f32 v6, v6, v76
  v_mul_f32 v7, v7, v76
  s_nop 0
  v_accvgpr_write_b32 a48, v4
  v_accvgpr_write_b32 a49, v5
  v_accvgpr_write_b32 a50, v6
  v_accvgpr_write_b32 a51, v7
  v_accvgpr_read_b32 v4, a68
  v_accvgpr_read_b32 v5, a69
  v_accvgpr_read_b32 v6, a70
  v_accvgpr_read_b32 v7, a71
  s_nop 0
  v_mul_f32 v4, v4, v76
  v_mul_f32 v5, v5, v76
  v_mul_f32 v6, v6, v76
  v_mul_f32 v7, v7, v76
  s_nop 0
  v_accvgpr_write_b32 a68, v4
  v_accvgpr_write_b32 a69, v5
  v_accvgpr_write_b32 a70, v6
  v_accvgpr_write_b32 a71, v7
  v_accvgpr_read_b32 v4, a88
  v_accvgpr_read_b32 v5, a89
  v_accvgpr_read_b32 v6, a90
  v_accvgpr_read_b32 v7, a91
  s_nop 0
  v_mul_f32 v4, v4, v76
  v_mul_f32 v5, v5, v76
  v_mul_f32 v6, v6, v76
  v_mul_f32 v7, v7, v76
  s_nop 0
  v_accvgpr_write_b32 a88, v4
  v_accvgpr_write_b32 a89, v5
  v_accvgpr_write_b32 a90, v6
  v_accvgpr_write_b32 a91, v7
  v_mov_b32 v76, 1.0
  s_nop 0
  v_accvgpr_write_b32 a106, v76
  v_accvgpr_read_b32 v76, a107
  v_accvgpr_read_b32 v4, a12
  v_accvgpr_read_b32 v5, a13
  v_accvgpr_read_b32 v6, a14
  v_accvgpr_read_b32 v7, a15
  s_nop 0
  v_mul_f32 v4, v4, v76
  v_mul_f32 v5, v5, v76
  v_mul_f32 v6, v6, v76
  v_mul_f32 v7, v7, v76
  s_nop 0
  v_accvgpr_write_b32 a12, v4
  v_accvgpr_write_b32 a13, v5
  v_accvgpr_write_b32 a14, v6
  v_accvgpr_write_b32 a15, v7
  v_accvgpr_read_b32 v4, a32
  v_accvgpr_read_b32 v5, a33
  v_accvgpr_read_b32 v6, a34
  v_accvgpr_read_b32 v7, a35
  s_nop 0
  v_mul_f32 v4, v4, v76
  v_mul_f32 v5, v5, v76
  v_mul_f32 v6, v6, v76
  v_mul_f32 v7, v7, v76
  s_nop 0
  v_accvgpr_write_b32 a32, v4
  v_accvgpr_write_b32 a33, v5
  v_accvgpr_write_b32 a34, v6
  v_accvgpr_write_b32 a35, v7
  v_accvgpr_read_b32 v4, a52
  v_accvgpr_read_b32 v5, a53
  v_accvgpr_read_b32 v6, a54
  v_accvgpr_read_b32 v7, a55
  s_nop 0
  v_mul_f32 v4, v4, v76
  v_mul_f32 v5, v5, v76
  v_mul_f32 v6, v6, v76
  v_mul_f32 v7, v7, v76
  s_nop 0
  v_accvgpr_write_b32 a52, v4
  v_accvgpr_write_b32 a53, v5
  v_accvgpr_write_b32 a54, v6
  v_accvgpr_write_b32 a55, v7
  v_accvgpr_read_b32 v4, a72
  v_accvgpr_read_b32 v5, a73
  v_accvgpr_read_b32 v6, a74
  v_accvgpr_read_b32 v7, a75
  s_nop 0
  v_mul_f32 v4, v4, v76
  v_mul_f32 v5, v5, v76
  v_mul_f32 v6, v6, v76
  v_mul_f32 v7, v7, v76
  s_nop 0
  v_accvgpr_write_b32 a72, v4
  v_accvgpr_write_b32 a73, v5
  v_accvgpr_write_b32 a74, v6
  v_accvgpr_write_b32 a75, v7
  v_accvgpr_read_b32 v4, a92
  v_accvgpr_read_b32 v5, a93
  v_accvgpr_read_b32 v6, a94
  v_accvgpr_read_b32 v7, a95
  s_nop 0
  v_mul_f32 v4, v4, v76
  v_mul_f32 v5, v5, v76
  v_mul_f32 v6, v6, v76
  v_mul_f32 v7, v7, v76
  s_nop 0
  v_accvgpr_write_b32 a92, v4
  v_accvgpr_write_b32 a93, v5
  v_accvgpr_write_b32 a94, v6
  v_accvgpr_write_b32 a95, v7
  v_mov_b32 v76, 1.0
  s_nop 0
  v_accvgpr_write_b32 a107, v76
  v_accvgpr_read_b32 v76, a108
  v_accvgpr_read_b32 v4, a16
  v_accvgpr_read_b32 v5, a17
  v_accvgpr_read_b32 v6, a18
  v_accvgpr_read_b32 v7, a19
  s_nop 0
  v_mul_f32 v4, v4, v76
  v_mul_f32 v5, v5, v76
  v_mul_f32 v6, v6, v76
  v_mul_f32 v7, v7, v76
  s_nop 0
  v_accvgpr_write_b32 a16, v4
  v_accvgpr_write_b32 a17, v5
  v_accvgpr_write_b32 a18, v6
  v_accvgpr_write_b32 a19, v7
  v_accvgpr_read_b32 v4, a36
  v_accvgpr_read_b32 v5, a37
  v_accvgpr_read_b32 v6, a38
  v_accvgpr_read_b32 v7, a39
  s_nop 0
  v_mul_f32 v4, v4, v76
  v_mul_f32 v5, v5, v76
  v_mul_f32 v6, v6, v76
  v_mul_f32 v7, v7, v76
  s_nop 0
  v_accvgpr_write_b32 a36, v4
  v_accvgpr_write_b32 a37, v5
  v_accvgpr_write_b32 a38, v6
  v_accvgpr_write_b32 a39, v7
  v_accvgpr_read_b32 v4, a56
  v_accvgpr_read_b32 v5, a57
  v_accvgpr_read_b32 v6, a58
  v_accvgpr_read_b32 v7, a59
  s_nop 0
  v_mul_f32 v4, v4, v76
  v_mul_f32 v5, v5, v76
  v_mul_f32 v6, v6, v76
  v_mul_f32 v7, v7, v76
  s_nop 0
  v_accvgpr_write_b32 a56, v4
  v_accvgpr_write_b32 a57, v5
  v_accvgpr_write_b32 a58, v6
  v_accvgpr_write_b32 a59, v7
  v_accvgpr_read_b32 v4, a76
  v_accvgpr_read_b32 v5, a77
  v_accvgpr_read_b32 v6, a78
  v_accvgpr_read_b32 v7, a79
  s_nop 0
  v_mul_f32 v4, v4, v76
  v_mul_f32 v5, v5, v76
  v_mul_f32 v6, v6, v76
  v_mul_f32 v7, v7, v76
  s_nop 0
  v_accvgpr_write_b32 a76, v4
  v_accvgpr_write_b32 a77, v5
  v_accvgpr_write_b32 a78, v6
  v_accvgpr_write_b32 a79, v7
  v_accvgpr_read_b32 v4, a96
  v_accvgpr_read_b32 v5, a97
  v_accvgpr_read_b32 v6, a98
  v_accvgpr_read_b32 v7, a99
  s_nop 0
  v_mul_f32 v4, v4, v76
  v_mul_f32 v5, v5, v76
  v_mul_f32 v6, v6, v76
  v_mul_f32 v7, v7, v76
  s_nop 0
  v_accvgpr_write_b32 a96, v4
  v_accvgpr_write_b32 a97, v5
  v_accvgpr_write_b32 a98, v6
  v_accvgpr_write_b32 a99, v7
  v_mov_b32 v76, 1.0
  s_nop 0
  v_accvgpr_write_b32 a108, v76
  s_mov_b32 s47, 0
  s_nop 3
  s_branch BO_q1
RP_q10:
  v_cmp_lt_f32 vcc, s48, v77
  s_nop 1
  v_cndmask_b32 v76, v88, v76, vcc
  v_sub_f32 v77, v88, v76
  v_exp_f32 v77, v77
  v_mov_b32 v88, v76
  v_accvgpr_read_b32 v78, a104
  s_nop 0
  v_mul_f32 v77, v77, v78
  s_nop 0
  v_accvgpr_write_b32 a104, v77
  v_cmp_lt_f32 vcc, s48, v81
  s_nop 1
  v_cndmask_b32 v80, v89, v80, vcc
  v_sub_f32 v81, v89, v80
  v_exp_f32 v81, v81
  v_mov_b32 v89, v80
  v_accvgpr_read_b32 v82, a105
  s_nop 0
  v_mul_f32 v81, v81, v82
  s_nop 0
  v_accvgpr_write_b32 a105, v81
  v_cmp_lt_f32 vcc, s48, v85
  s_nop 1
  v_cndmask_b32 v84, v90, v84, vcc
  v_sub_f32 v85, v90, v84
  v_exp_f32 v85, v85
  v_mov_b32 v90, v84
  v_accvgpr_read_b32 v86, a106
  s_nop 0
  v_mul_f32 v85, v85, v86
  s_nop 0
  v_accvgpr_write_b32 a106, v85
  s_mov_b32 s47, 1
  s_nop 1
  s_branch BP_q10
RP_q11:
  v_cmp_lt_f32 vcc, s48, v77
  s_nop 1
  v_cndmask_b32 v76, v91, v76, vcc
  v_sub_f32 v77, v91, v76
  v_exp_f32 v77, v77
  v_mov_b32 v91, v76
  v_accvgpr_read_b32 v78, a107
  s_nop 0
  v_mul_f32 v77, v77, v78
  s_nop 0
  v_accvgpr_write_b32 a107, v77
  v_cmp_lt_f32 vcc, s48, v81
  s_nop 1
  v_cndmask_b32 v80, v92, v80, vcc
  v_sub_f32 v81, v92, v80
  v_exp_f32 v81, v81
  v_mov_b32 v92, v80
  v_accvgpr_read_b32 v82, a108
  s_nop 0
  v_mul_f32 v81, v81, v82
  s_nop 0
  v_accvgpr_write_b32 a108, v81
  s_mov_b32 s47, 1
  s_nop 1
  s_branch BP_q11
RO_qA:
  s_nop 15
  v_accvgpr_read_b32 v76, a104
  v_accvgpr_read_b32 v4, a0
  v_accvgpr_read_b32 v5, a1
  v_accvgpr_read_b32 v6, a2
  v_accvgpr_read_b32 v7, a3
  s_nop 0
  v_mul_f32 v4, v4, v76
  v_mul_f32 v5, v5, v76
  v_mul_f32 v6, v6, v76
  v_mul_f32 v7, v7, v76
  s_nop 0
  v_accvgpr_write_b32 a0, v4
  v_accvgpr_write_b32 a1, v5
  v_accvgpr_write_b32 a2, v6
  v_accvgpr_write_b32 a3, v7
  v_accvgpr_read_b32 v4, a20
  v_accvgpr_read_b32 v5, a21
  v_accvgpr_read_b32 v6, a22
  v_accvgpr_read_b32 v7, a23
  s_nop 0
  v_mul_f32 v4, v4, v76
  v_mul_f32 v5, v5, v76
  v_mul_f32 v6, v6, v76
  v_mul_f32 v7, v7, v76
  s_nop 0
  v_accvgpr_write_b32 a20, v4
  v_accvgpr_write_b32 a21, v5
  v_accvgpr_write_b32 a22, v6
  v_accvgpr_write_b32 a23, v7
  v_accvgpr_read_b32 v4, a40
  v_accvgpr_read_b32 v5, a41
  v_accvgpr_read_b32 v6, a42
  v_accvgpr_read_b32 v7, a43
  s_nop 0
  v_mul_f32 v4, v4, v76
  v_mul_f32 v5, v5, v76
  v_mul_f32 v6, v6, v76
  v_mul_f32 v7, v7, v76
  s_nop 0
  v_accvgpr_write_b32 a40, v4
  v_accvgpr_write_b32 a41, v5
  v_accvgpr_write_b32 a42, v6
  v_accvgpr_write_b32 a43, v7
  v_accvgpr_read_b32 v4, a60
  v_accvgpr_read_b32 v5, a61
  v_accvgpr_read_b32 v6, a62
  v_accvgpr_read_b32 v7, a63
  s_nop 0
  v_mul_f32 v4, v4, v76
  v_mul_f32 v5, v5, v76
  v_mul_f32 v6, v6, v76
  v_mul_f32 v7, v7, v76
  s_nop 0
  v_accvgpr_write_b32 a60, v4
  v_accvgpr_write_b32 a61, v5
  v_accvgpr_write_b32 a62, v6
  v_accvgpr_write_b32 a63, v7
  v_accvgpr_read_b32 v4, a80
  v_accvgpr_read_b32 v5, a81
  v_accvgpr_read_b32 v6, a82
  v_accvgpr_read_b32 v7, a83
  s_nop 0
  v_mul_f32 v4, v4, v76
  v_mul_f32 v5, v5, v76
  v_mul_f32 v6, v6, v76
  v_mul_f32 v7, v7, v76
  s_nop 0
  v_accvgpr_write_b32 a80, v4
  v_accvgpr_write_b32 a81, v5
  v_accvgpr_write_b32 a82, v6
  v_accvgpr_write_b32 a83, v7
  v_mov_b32 v76, 1.0
  s_nop 0
  v_accvgpr_write_b32 a104, v76
  v_accvgpr_read_b32 v76, a105
  v_accvgpr_read_b32 v4, a4
  v_accvgpr_read_b32 v5, a5
  v_accvgpr_read_b32 v6, a6
  v_accvgpr_read_b32 v7, a7
  s_nop 0
  v_mul_f32 v4, v4, v76
  v_mul_f32 v5, v5, v76
  v_mul_f32 v6, v6, v76
  v_mul_f32 v7, v7, v76
  s_nop 0
  v_accvgpr_write_b32 a4, v4
  v_accvgpr_write_b32 a5, v5
  v_accvgpr_write_b32 a6, v6
  v_accvgpr_write_b32 a7, v7
  v_accvgpr_read_b32 v4, a24
  v_accvgpr_read_b32 v5, a25
  v_accvgpr_read_b32 v6, a26
  v_accvgpr_read_b32 v7, a27
  s_nop 0
  v_mul_f32 v4, v4, v76
  v_mul_f32 v5, v5, v76
  v_mul_f32 v6, v6, v76
  v_mul_f32 v7, v7, v76
  s_nop 0
  v_accvgpr_write_b32 a24, v4
  v_accvgpr_write_b32 a25, v5
  v_accvgpr_write_b32 a26, v6
  v_accvgpr_write_b32 a27, v7
  v_accvgpr_read_b32 v4, a44
  v_accvgpr_read_b32 v5, a45
  v_accvgpr_read_b32 v6, a46
  v_accvgpr_read_b32 v7, a47
  s_nop 0
  v_mul_f32 v4, v4, v76
  v_mul_f32 v5, v5, v76
  v_mul_f32 v6, v6, v76
  v_mul_f32 v7, v7, v76
  s_nop 0
  v_accvgpr_write_b32 a44, v4
  v_accvgpr_write_b32 a45, v5
  v_accvgpr_write_b32 a46, v6
  v_accvgpr_write_b32 a47, v7
  v_accvgpr_read_b32 v4, a64
  v_accvgpr_read_b32 v5, a65
  v_accvgpr_read_b32 v6, a66
  v_accvgpr_read_b32 v7, a67
  s_nop 0
  v_mul_f32 v4, v4, v76
  v_mul_f32 v5, v5, v76
  v_mul_f32 v6, v6, v76
  v_mul_f32 v7, v7, v76
  s_nop 0
  v_accvgpr_write_b32 a64, v4
  v_accvgpr_write_b32 a65, v5
  v_accvgpr_write_b32 a66, v6
  v_accvgpr_write_b32 a67, v7
  v_accvgpr_read_b32 v4, a84
  v_accvgpr_read_b32 v5, a85
  v_accvgpr_read_b32 v6, a86
  v_accvgpr_read_b32 v7, a87
  s_nop 0
  v_mul_f32 v4, v4, v76
  v_mul_f32 v5, v5, v76
  v_mul_f32 v6, v6, v76
  v_mul_f32 v7, v7, v76
  s_nop 0
  v_accvgpr_write_b32 a84, v4
  v_accvgpr_write_b32 a85, v5
  v_accvgpr_write_b32 a86, v6
  v_accvgpr_write_b32 a87, v7
  v_mov_b32 v76, 1.0
  s_nop 0
  v_accvgpr_write_b32 a105, v76
  v_accvgpr_read_b32 v76, a106
  v_accvgpr_read_b32 v4, a8
  v_accvgpr_read_b32 v5, a9
  v_accvgpr_read_b32 v6, a10
  v_accvgpr_read_b32 v7, a11
  s_nop 0
  v_mul_f32 v4, v4, v76
  v_mul_f32 v5, v5, v76
  v_mul_f32 v6, v6, v76
  v_mul_f32 v7, v7, v76
  s_nop 0
  v_accvgpr_write_b32 a8, v4
  v_accvgpr_write_b32 a9, v5
  v_accvgpr_write_b32 a10, v6
  v_accvgpr_write_b32 a11, v7
  v_accvgpr_read_b32 v4, a28
  v_accvgpr_read_b32 v5, a29
  v_accvgpr_read_b32 v6, a30
  v_accvgpr_read_b32 v7, a31
  s_nop 0
  v_mul_f32 v4, v4, v76
  v_mul_f32 v5, v5, v76
  v_mul_f32 v6, v6, v76
  v_mul_f32 v7, v7, v76
  s_nop 0
  v_accvgpr_write_b32 a28, v4
  v_accvgpr_write_b32 a29, v5
  v_accvgpr_write_b32 a30, v6
  v_accvgpr_write_b32 a31, v7
  v_accvgpr_read_b32 v4, a48
  v_accvgpr_read_b32 v5, a49
  v_accvgpr_read_b32 v6, a50
  v_accvgpr_read_b32 v7, a51
  s_nop 0
  v_mul_f32 v4, v4, v76
  v_mul_f32 v5, v5, v76
  v_mul_f32 v6, v6, v76
  v_mul_f32 v7, v7, v76
  s_nop 0
  v_accvgpr_write_b32 a48, v4
  v_accvgpr_write_b32 a49, v5
  v_accvgpr_write_b32 a50, v6
  v_accvgpr_write_b32 a51, v7
  v_accvgpr_read_b32 v4, a68
  v_accvgpr_read_b32 v5, a69
  v_accvgpr_read_b32 v6, a70
  v_accvgpr_read_b32 v7, a71
  s_nop 0
  v_mul_f32 v4, v4, v76
  v_mul_f32 v5, v5, v76
  v_mul_f32 v6, v6, v76
  v_mul_f32 v7, v7, v76
  s_nop 0
  v_accvgpr_write_b32 a68, v4
  v_accvgpr_write_b32 a69, v5
  v_accvgpr_write_b32 a70, v6
  v_accvgpr_write_b32 a71, v7
  v_accvgpr_read_b32 v4, a88
  v_accvgpr_read_b32 v5, a89
  v_accvgpr_read_b32 v6, a90
  v_accvgpr_read_b32 v7, a91
  s_nop 0
  v_mul_f32 v4, v4, v76
  v_mul_f32 v5, v5, v76
  v_mul_f32 v6, v6, v76
  v_mul_f32 v7, v7, v76
  s_nop 0
  v_accvgpr_write_b32 a88, v4
  v_accvgpr_write_b32 a89, v5
  v_accvgpr_write_b32 a90, v6
  v_accvgpr_write_b32 a91, v7
  v_mov_b32 v76, 1.0
  s_nop 0
  v_accvgpr_write_b32 a106, v76
  v_accvgpr_read_b32 v76, a107
  v_accvgpr_read_b32 v4, a12
  v_accvgpr_read_b32 v5, a13
  v_accvgpr_read_b32 v6, a14
  v_accvgpr_read_b32 v7, a15
  s_nop 0
  v_mul_f32 v4, v4, v76
  v_mul_f32 v5, v5, v76
  v_mul_f32 v6, v6, v76
  v_mul_f32 v7, v7, v76
  s_nop 0
  v_accvgpr_write_b32 a12, v4
  v_accvgpr_write_b32 a13, v5
  v_accvgpr_write_b32 a14, v6
  v_accvgpr_write_b32 a15, v7
  v_accvgpr_read_b32 v4, a32
  v_accvgpr_read_b32 v5, a33
  v_accvgpr_read_b32 v6, a34
  v_accvgpr_read_b32 v7, a35
  s_nop 0
  v_mul_f32 v4, v4, v76
  v_mul_f32 v5, v5, v76
  v_mul_f32 v6, v6, v76
  v_mul_f32 v7, v7, v76
  s_nop 0
  v_accvgpr_write_b32 a32, v4
  v_accvgpr_write_b32 a33, v5
  v_accvgpr_write_b32 a34, v6
  v_accvgpr_write_b32 a35, v7
  v_accvgpr_read_b32 v4, a52
  v_accvgpr_read_b32 v5, a53
  v_accvgpr_read_b32 v6, a54
  v_accvgpr_read_b32 v7, a55
  s_nop 0
  v_mul_f32 v4, v4, v76
  v_mul_f32 v5, v5, v76
  v_mul_f32 v6, v6, v76
  v_mul_f32 v7, v7, v76
  s_nop 0
  v_accvgpr_write_b32 a52, v4
  v_accvgpr_write_b32 a53, v5
  v_accvgpr_write_b32 a54, v6
  v_accvgpr_write_b32 a55, v7
  v_accvgpr_read_b32 v4, a72
  v_accvgpr_read_b32 v5, a73
  v_accvgpr_read_b32 v6, a74
  v_accvgpr_read_b32 v7, a75
  s_nop 0
  v_mul_f32 v4, v4, v76
  v_mul_f32 v5, v5, v76
  v_mul_f32 v6, v6, v76
  v_mul_f32 v7, v7, v76
  s_nop 0
  v_accvgpr_write_b32 a72, v4
  v_accvgpr_write_b32 a73, v5
  v_accvgpr_write_b32 a74, v6
  v_accvgpr_write_b32 a75, v7
  v_accvgpr_read_b32 v4, a92
  v_accvgpr_read_b32 v5, a93
  v_accvgpr_read_b32 v6, a94
  v_accvgpr_read_b32 v7, a95
  s_nop 0
  v_mul_f32 v4, v4, v76
  v_mul_f32 v5, v5, v76
  v_mul_f32 v6, v6, v76
  v_mul_f32 v7, v7, v76
  s_nop 0
  v_accvgpr_write_b32 a92, v4
  v_accvgpr_write_b32 a93, v5
  v_accvgpr_write_b32 a94, v6
  v_accvgpr_write_b32 a95, v7
  v_mov_b32 v76, 1.0
  s_nop 0
  v_accvgpr_write_b32 a107, v76
  v_accvgpr_read_b32 v76, a108
  v_accvgpr_read_b32 v4, a16
  v_accvgpr_read_b32 v5, a17
  v_accvgpr_read_b32 v6, a18
  v_accvgpr_read_b32 v7, a19
  s_nop 0
  v_mul_f32 v4, v4, v76
  v_mul_f32 v5, v5, v76
  v_mul_f32 v6, v6, v76
  v_mul_f32 v7, v7, v76
  s_nop 0
  v_accvgpr_write_b32 a16, v4
  v_accvgpr_write_b32 a17, v5
  v_accvgpr_write_b32 a18, v6
  v_accvgpr_write_b32 a19, v7
  v_accvgpr_read_b32 v4, a36
  v_accvgpr_read_b32 v5, a37
  v_accvgpr_read_b32 v6, a38
  v_accvgpr_read_b32 v7, a39
  s_nop 0
  v_mul_f32 v4, v4, v76
  v_mul_f32 v5, v5, v76
  v_mul_f32 v6, v6, v76
  v_mul_f32 v7, v7, v76
  s_nop 0
  v_accvgpr_write_b32 a36, v4
  v_accvgpr_write_b32 a37, v5
  v_accvgpr_write_b32 a38, v6
  v_accvgpr_write_b32 a39, v7
  v_accvgpr_read_b32 v4, a56
  v_accvgpr_read_b32 v5, a57
  v_accvgpr_read_b32 v6, a58
  v_accvgpr_read_b32 v7, a59
  s_nop 0
  v_mul_f32 v4, v4, v76
  v_mul_f32 v5, v5, v76
  v_mul_f32 v6, v6, v76
  v_mul_f32 v7, v7, v76
  s_nop 0
  v_accvgpr_write_b32 a56, v4
  v_accvgpr_write_b32 a57, v5
  v_accvgpr_write_b32 a58, v6
  v_accvgpr_write_b32 a59, v7
  v_accvgpr_read_b32 v4, a76
  v_accvgpr_read_b32 v5, a77
  v_accvgpr_read_b32 v6, a78
  v_accvgpr_read_b32 v7, a79
  s_nop 0
  v_mul_f32 v4, v4, v76
  v_mul_f32 v5, v5, v76
  v_mul_f32 v6, v6, v76
  v_mul_f32 v7, v7, v76
  s_nop 0
  v_accvgpr_write_b32 a76, v4
  v_accvgpr_write_b32 a77, v5
  v_accvgpr_write_b32 a78, v6
  v_accvgpr_write_b32 a79, v7
  v_accvgpr_read_b32 v4, a96
  v_accvgpr_read_b32 v5, a97
  v_accvgpr_read_b32 v6, a98
  v_accvgpr_read_b32 v7, a99
  s_nop 0
  v_mul_f32 v4, v4, v76
  v_mul_f32 v5, v5, v76
  v_mul_f32 v6, v6, v76
  v_mul_f32 v7, v7, v76
  s_nop 0
  v_accvgpr_write_b32 a96, v4
  v_accvgpr_write_b32 a97, v5
  v_accvgpr_write_b32 a98, v6
  v_accvgpr_write_b32 a99, v7
  v_mov_b32 v76, 1.0
  s_nop 0
  v_accvgpr_write_b32 a108, v76
  s_mov_b32 s47, 0
  s_nop 3
  s_branch BO_qA
RP_qA0:
  v_cmp_lt_f32 vcc, s48, v77
  s_nop 1
  v_cndmask_b32 v76, v88, v76, vcc
  v_sub_f32 v77, v88, v76
  v_exp_f32 v77, v77
  v_mov_b32 v88, v76
  v_accvgpr_read_b32 v78, a104
  s_nop 0
  v_mul_f32 v77, v77, v78
  s_nop 0
  v_accvgpr_write_b32 a104, v77
  v_cmp_lt_f32 vcc, s48, v81
  s_nop 1
  v_cndmask_b32 v80, v89, v80, vcc
  v_sub_f32 v81, v89, v80
  v_exp_f32 v81, v81
  v_mov_b32 v89, v80
  v_accvgpr_read_b32 v82, a105
  s_nop 0
  v_mul_f32 v81, v81, v82
  s_nop 0
  v_accvgpr_write_b32 a105, v81
  v_cmp_lt_f32 vcc, s48, v85
  s_nop 1
  v_cndmask_b32 v84, v90, v84, vcc
  v_sub_f32 v85, v90, v84
  v_exp_f32 v85, v85
  v_mov_b32 v90, v84
  v_accvgpr_read_b32 v86, a106
  s_nop 0
  v_mul_f32 v85, v85, v86
  s_nop 0
  v_accvgpr_write_b32 a106, v85
  s_mov_b32 s47, 1
  s_nop 1
  s_branch BP_qA0
RP_qA1:
  v_cmp_lt_f32 vcc, s48, v77
  s_nop 1
  v_cndmask_b32 v76, v91, v76, vcc
  v_sub_f32 v77, v91, v76
  v_exp_f32 v77, v77
  v_mov_b32 v91, v76
  v_accvgpr_read_b32 v78, a107
  s_nop 0
  v_mul_f32 v77, v77, v78
  s_nop 0
  v_accvgpr_write_b32 a107, v77
  v_cmp_lt_f32 vcc, s48, v81
  s_nop 1
  v_cndmask_b32 v80, v92, v80, vcc
  v_sub_f32 v81, v92, v80
  v_exp_f32 v81, v81
  v_mov_b32 v92, v80
  v_accvgpr_read_b32 v82, a108
  s_nop 0
  v_mul_f32 v81, v81, v82
  s_nop 0
  v_accvgpr_write_b32 a108, v81
  s_mov_b32 s47, 1
  s_nop 1
  s_branch BP_qA1
RO_qB:
  s_nop 15
  v_accvgpr_read_b32 v76, a104
  v_accvgpr_read_b32 v4, a0
  v_accvgpr_read_b32 v5, a1
  v_accvgpr_read_b32 v6, a2
  v_accvgpr_read_b32 v7, a3
  s_nop 0
  v_mul_f32 v4, v4, v76
  v_mul_f32 v5, v5, v76
  v_mul_f32 v6, v6, v76
  v_mul_f32 v7, v7, v76
  s_nop 0
  v_accvgpr_write_b32 a0, v4
  v_accvgpr_write_b32 a1, v5
  v_accvgpr_write_b32 a2, v6
  v_accvgpr_write_b32 a3, v7
  v_accvgpr_read_b32 v4, a20
  v_accvgpr_read_b32 v5, a21
  v_accvgpr_read_b32 v6, a22
  v_accvgpr_read_b32 v7, a23
  s_nop 0
  v_mul_f32 v4, v4, v76
  v_mul_f32 v5, v5, v76
  v_mul_f32 v6, v6, v76
  v_mul_f32 v7, v7, v76
  s_nop 0
  v_accvgpr_write_b32 a20, v4
  v_accvgpr_write_b32 a21, v5
  v_accvgpr_write_b32 a22, v6
  v_accvgpr_write_b32 a23, v7
  v_accvgpr_read_b32 v4, a40
  v_accvgpr_read_b32 v5, a41
  v_accvgpr_read_b32 v6, a42
  v_accvgpr_read_b32 v7, a43
  s_nop 0
  v_mul_f32 v4, v4, v76
  v_mul_f32 v5, v5, v76
  v_mul_f32 v6, v6, v76
  v_mul_f32 v7, v7, v76
  s_nop 0
  v_accvgpr_write_b32 a40, v4
  v_accvgpr_write_b32 a41, v5
  v_accvgpr_write_b32 a42, v6
  v_accvgpr_write_b32 a43, v7
  v_accvgpr_read_b32 v4, a60
  v_accvgpr_read_b32 v5, a61
  v_accvgpr_read_b32 v6, a62
  v_accvgpr_read_b32 v7, a63
  s_nop 0
  v_mul_f32 v4, v4, v76
  v_mul_f32 v5, v5, v76
  v_mul_f32 v6, v6, v76
  v_mul_f32 v7, v7, v76
  s_nop 0
  v_accvgpr_write_b32 a60, v4
  v_accvgpr_write_b32 a61, v5
  v_accvgpr_write_b32 a62, v6
  v_accvgpr_write_b32 a63, v7
  v_accvgpr_read_b32 v4, a80
  v_accvgpr_read_b32 v5, a81
  v_accvgpr_read_b32 v6, a82
  v_accvgpr_read_b32 v7, a83
  s_nop 0
  v_mul_f32 v4, v4, v76
  v_mul_f32 v5, v5, v76
  v_mul_f32 v6, v6, v76
  v_mul_f32 v7, v7, v76
  s_nop 0
  v_accvgpr_write_b32 a80, v4
  v_accvgpr_write_b32 a81, v5
  v_accvgpr_write_b32 a82, v6
  v_accvgpr_write_b32 a83, v7
  v_mov_b32 v76, 1.0
  s_nop 0
  v_accvgpr_write_b32 a104, v76
  v_accvgpr_read_b32 v76, a105
  v_accvgpr_read_b32 v4, a4
  v_accvgpr_read_b32 v5, a5
  v_accvgpr_read_b32 v6, a6
  v_accvgpr_read_b32 v7, a7
  s_nop 0
  v_mul_f32 v4, v4, v76
  v_mul_f32 v5, v5, v76
  v_mul_f32 v6, v6, v76
  v_mul_f32 v7, v7, v76
  s_nop 0
  v_accvgpr_write_b32 a4, v4
  v_accvgpr_write_b32 a5, v5
  v_accvgpr_write_b32 a6, v6
  v_accvgpr_write_b32 a7, v7
  v_accvgpr_read_b32 v4, a24
  v_accvgpr_read_b32 v5, a25
  v_accvgpr_read_b32 v6, a26
  v_accvgpr_read_b32 v7, a27
  s_nop 0
  v_mul_f32 v4, v4, v76
  v_mul_f32 v5, v5, v76
  v_mul_f32 v6, v6, v76
  v_mul_f32 v7, v7, v76
  s_nop 0
  v_accvgpr_write_b32 a24, v4
  v_accvgpr_write_b32 a25, v5
  v_accvgpr_write_b32 a26, v6
  v_accvgpr_write_b32 a27, v7
  v_accvgpr_read_b32 v4, a44
  v_accvgpr_read_b32 v5, a45
  v_accvgpr_read_b32 v6, a46
  v_accvgpr_read_b32 v7, a47
  s_nop 0
  v_mul_f32 v4, v4, v76
  v_mul_f32 v5, v5, v76
  v_mul_f32 v6, v6, v76
  v_mul_f32 v7, v7, v76
  s_nop 0
  v_accvgpr_write_b32 a44, v4
  v_accvgpr_write_b32 a45, v5
  v_accvgpr_write_b32 a46, v6
  v_accvgpr_write_b32 a47, v7
  v_accvgpr_read_b32 v4, a64
  v_accvgpr_read_b32 v5, a65
  v_accvgpr_read_b32 v6, a66
  v_accvgpr_read_b32 v7, a67
  s_nop 0
  v_mul_f32 v4, v4, v76
  v_mul_f32 v5, v5, v76
  v_mul_f32 v6, v6, v76
  v_mul_f32 v7, v7, v76
  s_nop 0
  v_accvgpr_write_b32 a64, v4
  v_accvgpr_write_b32 a65, v5
  v_accvgpr_write_b32 a66, v6
  v_accvgpr_write_b32 a67, v7
  v_accvgpr_read_b32 v4, a84
  v_accvgpr_read_b32 v5, a85
  v_accvgpr_read_b32 v6, a86
  v_accvgpr_read_b32 v7, a87
  s_nop 0
  v_mul_f32 v4, v4, v76
  v_mul_f32 v5, v5, v76
  v_mul_f32 v6, v6, v76
  v_mul_f32 v7, v7, v76
  s_nop 0
  v_accvgpr_write_b32 a84, v4
  v_accvgpr_write_b32 a85, v5
  v_accvgpr_write_b32 a86, v6
  v_accvgpr_write_b32 a87, v7
  v_mov_b32 v76, 1.0
  s_nop 0
  v_accvgpr_write_b32 a105, v76
  v_accvgpr_read_b32 v76, a106
  v_accvgpr_read_b32 v4, a8
  v_accvgpr_read_b32 v5, a9
  v_accvgpr_read_b32 v6, a10
  v_accvgpr_read_b32 v7, a11
  s_nop 0
  v_mul_f32 v4, v4, v76
  v_mul_f32 v5, v5, v76
  v_mul_f32 v6, v6, v76
  v_mul_f32 v7, v7, v76
  s_nop 0
  v_accvgpr_write_b32 a8, v4
  v_accvgpr_write_b32 a9, v5
  v_accvgpr_write_b32 a10, v6
  v_accvgpr_write_b32 a11, v7
  v_accvgpr_read_b32 v4, a28
  v_accvgpr_read_b32 v5, a29
  v_accvgpr_read_b32 v6, a30
  v_accvgpr_read_b32 v7, a31
  s_nop 0
  v_mul_f32 v4, v4, v76
  v_mul_f32 v5, v5, v76
  v_mul_f32 v6, v6, v76
  v_mul_f32 v7, v7, v76
  s_nop 0
  v_accvgpr_write_b32 a28, v4
  v_accvgpr_write_b32 a29, v5
  v_accvgpr_write_b32 a30, v6
  v_accvgpr_write_b32 a31, v7
  v_accvgpr_read_b32 v4, a48
  v_accvgpr_read_b32 v5, a49
  v_accvgpr_read_b32 v6, a50
  v_accvgpr_read_b32 v7, a51
  s_nop 0
  v_mul_f32 v4, v4, v76
  v_mul_f32 v5, v5, v76
  v_mul_f32 v6, v6, v76
  v_mul_f32 v7, v7, v76
  s_nop 0
  v_accvgpr_write_b32 a48, v4
  v_accvgpr_write_b32 a49, v5
  v_accvgpr_write_b32 a50, v6
  v_accvgpr_write_b32 a51, v7
  v_accvgpr_read_b32 v4, a68
  v_accvgpr_read_b32 v5, a69
  v_accvgpr_read_b32 v6, a70
  v_accvgpr_read_b32 v7, a71
  s_nop 0
  v_mul_f32 v4, v4, v76
  v_mul_f32 v5, v5, v76
  v_mul_f32 v6, v6, v76
  v_mul_f32 v7, v7, v76
  s_nop 0
  v_accvgpr_write_b32 a68, v4
  v_accvgpr_write_b32 a69, v5
  v_accvgpr_write_b32 a70, v6
  v_accvgpr_write_b32 a71, v7
  v_accvgpr_read_b32 v4, a88
  v_accvgpr_read_b32 v5, a89
  v_accvgpr_read_b32 v6, a90
  v_accvgpr_read_b32 v7, a91
  s_nop 0
  v_mul_f32 v4, v4, v76
  v_mul_f32 v5, v5, v76
  v_mul_f32 v6, v6, v76
  v_mul_f32 v7, v7, v76
  s_nop 0
  v_accvgpr_write_b32 a88, v4
  v_accvgpr_write_b32 a89, v5
  v_accvgpr_write_b32 a90, v6
  v_accvgpr_write_b32 a91, v7
  v_mov_b32 v76, 1.0
  s_nop 0
  v_accvgpr_write_b32 a106, v76
  v_accvgpr_read_b32 v76, a107
  v_accvgpr_read_b32 v4, a12
  v_accvgpr_read_b32 v5, a13
  v_accvgpr_read_b32 v6, a14
  v_accvgpr_read_b32 v7, a15
  s_nop 0
  v_mul_f32 v4, v4, v76
  v_mul_f32 v5, v5, v76
  v_mul_f32 v6, v6, v76
  v_mul_f32 v7, v7, v76
  s_nop 0
  v_accvgpr_write_b32 a12, v4
  v_accvgpr_write_b32 a13, v5
  v_accvgpr_write_b32 a14, v6
  v_accvgpr_write_b32 a15, v7
  v_accvgpr_read_b32 v4, a32
  v_accvgpr_read_b32 v5, a33
  v_accvgpr_read_b32 v6, a34
  v_accvgpr_read_b32 v7, a35
  s_nop 0
  v_mul_f32 v4, v4, v76
  v_mul_f32 v5, v5, v76
  v_mul_f32 v6, v6, v76
  v_mul_f32 v7, v7, v76
  s_nop 0
  v_accvgpr_write_b32 a32, v4
  v_accvgpr_write_b32 a33, v5
  v_accvgpr_write_b32 a34, v6
  v_accvgpr_write_b32 a35, v7
  v_accvgpr_read_b32 v4, a52
  v_accvgpr_read_b32 v5, a53
  v_accvgpr_read_b32 v6, a54
  v_accvgpr_read_b32 v7, a55
  s_nop 0
  v_mul_f32 v4, v4, v76
  v_mul_f32 v5, v5, v76
  v_mul_f32 v6, v6, v76
  v_mul_f32 v7, v7, v76
  s_nop 0
  v_accvgpr_write_b32 a52, v4
  v_accvgpr_write_b32 a53, v5
  v_accvgpr_write_b32 a54, v6
  v_accvgpr_write_b32 a55, v7
  v_accvgpr_read_b32 v4, a72
  v_accvgpr_read_b32 v5, a73
  v_accvgpr_read_b32 v6, a74
  v_accvgpr_read_b32 v7, a75
  s_nop 0
  v_mul_f32 v4, v4, v76
  v_mul_f32 v5, v5, v76
  v_mul_f32 v6, v6, v76
  v_mul_f32 v7, v7, v76
  s_nop 0
  v_accvgpr_write_b32 a72, v4
  v_accvgpr_write_b32 a73, v5
  v_accvgpr_write_b32 a74, v6
  v_accvgpr_write_b32 a75, v7
  v_accvgpr_read_b32 v4, a92
  v_accvgpr_read_b32 v5, a93
  v_accvgpr_read_b32 v6, a94
  v_accvgpr_read_b32 v7, a95
  s_nop 0
  v_mul_f32 v4, v4, v76
  v_mul_f32 v5, v5, v76
  v_mul_f32 v6, v6, v76
  v_mul_f32 v7, v7, v76
  s_nop 0
  v_accvgpr_write_b32 a92, v4
  v_accvgpr_write_b32 a93, v5
  v_accvgpr_write_b32 a94, v6
  v_accvgpr_write_b32 a95, v7
  v_mov_b32 v76, 1.0
  s_nop 0
  v_accvgpr_write_b32 a107, v76
  v_accvgpr_read_b32 v76, a108
  v_accvgpr_read_b32 v4, a16
  v_accvgpr_read_b32 v5, a17
  v_accvgpr_read_b32 v6, a18
  v_accvgpr_read_b32 v7, a19
  s_nop 0
  v_mul_f32 v4, v4, v76
  v_mul_f32 v5, v5, v76
  v_mul_f32 v6, v6, v76
  v_mul_f32 v7, v7, v76
  s_nop 0
  v_accvgpr_write_b32 a16, v4
  v_accvgpr_write_b32 a17, v5
  v_accvgpr_write_b32 a18, v6
  v_accvgpr_write_b32 a19, v7
  v_accvgpr_read_b32 v4, a36
  v_accvgpr_read_b32 v5, a37
  v_accvgpr_read_b32 v6, a38
  v_accvgpr_read_b32 v7, a39
  s_nop 0
  v_mul_f32 v4, v4, v76
  v_mul_f32 v5, v5, v76
  v_mul_f32 v6, v6, v76
  v_mul_f32 v7, v7, v76
  s_nop 0
  v_accvgpr_write_b32 a36, v4
  v_accvgpr_write_b32 a37, v5
  v_accvgpr_write_b32 a38, v6
  v_accvgpr_write_b32 a39, v7
  v_accvgpr_read_b32 v4, a56
  v_accvgpr_read_b32 v5, a57
  v_accvgpr_read_b32 v6, a58
  v_accvgpr_read_b32 v7, a59
  s_nop 0
  v_mul_f32 v4, v4, v76
  v_mul_f32 v5, v5, v76
  v_mul_f32 v6, v6, v76
  v_mul_f32 v7, v7, v76
  s_nop 0
  v_accvgpr_write_b32 a56, v4
  v_accvgpr_write_b32 a57, v5
  v_accvgpr_write_b32 a58, v6
  v_accvgpr_write_b32 a59, v7
  v_accvgpr_read_b32 v4, a76
  v_accvgpr_read_b32 v5, a77
  v_accvgpr_read_b32 v6, a78
  v_accvgpr_read_b32 v7, a79
  s_nop 0
  v_mul_f32 v4, v4, v76
  v_mul_f32 v5, v5, v76
  v_mul_f32 v6, v6, v76
  v_mul_f32 v7, v7, v76
  s_nop 0
  v_accvgpr_write_b32 a76, v4
  v_accvgpr_write_b32 a77, v5
  v_accvgpr_write_b32 a78, v6
  v_accvgpr_write_b32 a79, v7
  v_accvgpr_read_b32 v4, a96
  v_accvgpr_read_b32 v5, a97
  v_accvgpr_read_b32 v6, a98
  v_accvgpr_read_b32 v7, a99
  s_nop 0
  v_mul_f32 v4, v4, v76
  v_mul_f32 v5, v5, v76
  v_mul_f32 v6, v6, v76
  v_mul_f32 v7, v7, v76
  s_nop 0
  v_accvgpr_write_b32 a96, v4
  v_accvgpr_write_b32 a97, v5
  v_accvgpr_write_b32 a98, v6
  v_accvgpr_write_b32 a99, v7
  v_mov_b32 v76, 1.0
  s_nop 0
  v_accvgpr_write_b32 a108, v76
  s_mov_b32 s47, 0
  s_nop 3
  s_branch BO_qB
RP_qB0:
  v_cmp_lt_f32 vcc, s48, v77
  s_nop 1
  v_cndmask_b32 v76, v88, v76, vcc
  v_sub_f32 v77, v88, v76
  v_exp_f32 v77, v77
  v_mov_b32 v88, v76
  v_accvgpr_read_b32 v78, a104
  s_nop 0
  v_mul_f32 v77, v77, v78
  s_nop 0
  v_accvgpr_write_b32 a104, v77
  v_cmp_lt_f32 vcc, s48, v81
  s_nop 1
  v_cndmask_b32 v80, v89, v80, vcc
  v_sub_f32 v81, v89, v80
  v_exp_f32 v81, v81
  v_mov_b32 v89, v80
  v_accvgpr_read_b32 v82, a105
  s_nop 0
  v_mul_f32 v81, v81, v82
  s_nop 0
  v_accvgpr_write_b32 a105, v81
  v_cmp_lt_f32 vcc, s48, v85
  s_nop 1
  v_cndmask_b32 v84, v90, v84, vcc
  v_sub_f32 v85, v90, v84
  v_exp_f32 v85, v85
  v_mov_b32 v90, v84
  v_accvgpr_read_b32 v86, a106
  s_nop 0
  v_mul_f32 v85, v85, v86
  s_nop 0
  v_accvgpr_write_b32 a106, v85
  s_mov_b32 s47, 1
  s_nop 1
  s_branch BP_qB0
RP_qB1:
  v_cmp_lt_f32 vcc, s48, v77
  s_nop 1
  v_cndmask_b32 v76, v91, v76, vcc
  v_sub_f32 v77, v91, v76
  v_exp_f32 v77, v77
  v_mov_b32 v91, v76
  v_accvgpr_read_b32 v78, a107
  s_nop 0
  v_mul_f32 v77, v77, v78
  s_nop 0
  v_accvgpr_write_b32 a107, v77
  v_cmp_lt_f32 vcc, s48, v81
  s_nop 1
  v_cndmask_b32 v80, v92, v80, vcc
  v_sub_f32 v81, v92, v80
  v_exp_f32 v81, v81
  v_mov_b32 v92, v80
  v_accvgpr_read_b32 v82, a108
  s_nop 0
  v_mul_f32 v81, v81, v82
  s_nop 0
  v_accvgpr_write_b32 a108, v81
  s_mov_b32 s47, 1
  s_nop 1
  s_branch BP_qB1
RO_q14:
  s_nop 15
  v_accvgpr_read_b32 v76, a104
  v_accvgpr_read_b32 v4, a0
  v_accvgpr_read_b32 v5, a1
  v_accvgpr_read_b32 v6, a2
  v_accvgpr_read_b32 v7, a3
  s_nop 0
  v_mul_f32 v4, v4, v76
  v_mul_f32 v5, v5, v76
  v_mul_f32 v6, v6, v76
  v_mul_f32 v7, v7, v76
  s_nop 0
  v_accvgpr_write_b32 a0, v4
  v_accvgpr_write_b32 a1, v5
  v_accvgpr_write_b32 a2, v6
  v_accvgpr_write_b32 a3, v7
  v_accvgpr_read_b32 v4, a20
  v_accvgpr_read_b32 v5, a21
  v_accvgpr_read_b32 v6, a22
  v_accvgpr_read_b32 v7, a23
  s_nop 0
  v_mul_f32 v4, v4, v76
  v_mul_f32 v5, v5, v76
  v_mul_f32 v6, v6, v76
  v_mul_f32 v7, v7, v76
  s_nop 0
  v_accvgpr_write_b32 a20, v4
  v_accvgpr_write_b32 a21, v5
  v_accvgpr_write_b32 a22, v6
  v_accvgpr_write_b32 a23, v7
  v_accvgpr_read_b32 v4, a40
  v_accvgpr_read_b32 v5, a41
  v_accvgpr_read_b32 v6, a42
  v_accvgpr_read_b32 v7, a43
  s_nop 0
  v_mul_f32 v4, v4, v76
  v_mul_f32 v5, v5, v76
  v_mul_f32 v6, v6, v76
  v_mul_f32 v7, v7, v76
  s_nop 0
  v_accvgpr_write_b32 a40, v4
  v_accvgpr_write_b32 a41, v5
  v_accvgpr_write_b32 a42, v6
  v_accvgpr_write_b32 a43, v7
  v_accvgpr_read_b32 v4, a60
  v_accvgpr_read_b32 v5, a61
  v_accvgpr_read_b32 v6, a62
  v_accvgpr_read_b32 v7, a63
  s_nop 0
  v_mul_f32 v4, v4, v76
  v_mul_f32 v5, v5, v76
  v_mul_f32 v6, v6, v76
  v_mul_f32 v7, v7, v76
  s_nop 0
  v_accvgpr_write_b32 a60, v4
  v_accvgpr_write_b32 a61, v5
  v_accvgpr_write_b32 a62, v6
  v_accvgpr_write_b32 a63, v7
  v_accvgpr_read_b32 v4, a80
  v_accvgpr_read_b32 v5, a81
  v_accvgpr_read_b32 v6, a82
  v_accvgpr_read_b32 v7, a83
  s_nop 0
  v_mul_f32 v4, v4, v76
  v_mul_f32 v5, v5, v76
  v_mul_f32 v6, v6, v76
  v_mul_f32 v7, v7, v76
  s_nop 0
  v_accvgpr_write_b32 a80, v4
  v_accvgpr_write_b32 a81, v5
  v_accvgpr_write_b32 a82, v6
  v_accvgpr_write_b32 a83, v7
  v_mov_b32 v76, 1.0
  s_nop 0
  v_accvgpr_write_b32 a104, v76
  v_accvgpr_read_b32 v76, a105
  v_accvgpr_read_b32 v4, a4
  v_accvgpr_read_b32 v5, a5
  v_accvgpr_read_b32 v6, a6
  v_accvgpr_read_b32 v7, a7
  s_nop 0
  v_mul_f32 v4, v4, v76
  v_mul_f32 v5, v5, v76
  v_mul_f32 v6, v6, v76
  v_mul_f32 v7, v7, v76
  s_nop 0
  v_accvgpr_write_b32 a4, v4
  v_accvgpr_write_b32 a5, v5
  v_accvgpr_write_b32 a6, v6
  v_accvgpr_write_b32 a7, v7
  v_accvgpr_read_b32 v4, a24
  v_accvgpr_read_b32 v5, a25
  v_accvgpr_read_b32 v6, a26
  v_accvgpr_read_b32 v7, a27
  s_nop 0
  v_mul_f32 v4, v4, v76
  v_mul_f32 v5, v5, v76
  v_mul_f32 v6, v6, v76
  v_mul_f32 v7, v7, v76
  s_nop 0
  v_accvgpr_write_b32 a24, v4
  v_accvgpr_write_b32 a25, v5
  v_accvgpr_write_b32 a26, v6
  v_accvgpr_write_b32 a27, v7
  v_accvgpr_read_b32 v4, a44
  v_accvgpr_read_b32 v5, a45
  v_accvgpr_read_b32 v6, a46
  v_accvgpr_read_b32 v7, a47
  s_nop 0
  v_mul_f32 v4, v4, v76
  v_mul_f32 v5, v5, v76
  v_mul_f32 v6, v6, v76
  v_mul_f32 v7, v7, v76
  s_nop 0
  v_accvgpr_write_b32 a44, v4
  v_accvgpr_write_b32 a45, v5
  v_accvgpr_write_b32 a46, v6
  v_accvgpr_write_b32 a47, v7
  v_accvgpr_read_b32 v4, a64
  v_accvgpr_read_b32 v5, a65
  v_accvgpr_read_b32 v6, a66
  v_accvgpr_read_b32 v7, a67
  s_nop 0
  v_mul_f32 v4, v4, v76
  v_mul_f32 v5, v5, v76
  v_mul_f32 v6, v6, v76
  v_mul_f32 v7, v7, v76
  s_nop 0
  v_accvgpr_write_b32 a64, v4
  v_accvgpr_write_b32 a65, v5
  v_accvgpr_write_b32 a66, v6
  v_accvgpr_write_b32 a67, v7
  v_accvgpr_read_b32 v4, a84
  v_accvgpr_read_b32 v5, a85
  v_accvgpr_read_b32 v6, a86
  v_accvgpr_read_b32 v7, a87
  s_nop 0
  v_mul_f32 v4, v4, v76
  v_mul_f32 v5, v5, v76
  v_mul_f32 v6, v6, v76
  v_mul_f32 v7, v7, v76
  s_nop 0
  v_accvgpr_write_b32 a84, v4
  v_accvgpr_write_b32 a85, v5
  v_accvgpr_write_b32 a86, v6
  v_accvgpr_write_b32 a87, v7
  v_mov_b32 v76, 1.0
  s_nop 0
  v_accvgpr_write_b32 a105, v76
  v_accvgpr_read_b32 v76, a106
  v_accvgpr_read_b32 v4, a8
  v_accvgpr_read_b32 v5, a9
  v_accvgpr_read_b32 v6, a10
  v_accvgpr_read_b32 v7, a11
  s_nop 0
  v_mul_f32 v4, v4, v76
  v_mul_f32 v5, v5, v76
  v_mul_f32 v6, v6, v76
  v_mul_f32 v7, v7, v76
  s_nop 0
  v_accvgpr_write_b32 a8, v4
  v_accvgpr_write_b32 a9, v5
  v_accvgpr_write_b32 a10, v6
  v_accvgpr_write_b32 a11, v7
  v_accvgpr_read_b32 v4, a28
  v_accvgpr_read_b32 v5, a29
  v_accvgpr_read_b32 v6, a30
  v_accvgpr_read_b32 v7, a31
  s_nop 0
  v_mul_f32 v4, v4, v76
  v_mul_f32 v5, v5, v76
  v_mul_f32 v6, v6, v76
  v_mul_f32 v7, v7, v76
  s_nop 0
  v_accvgpr_write_b32 a28, v4
  v_accvgpr_write_b32 a29, v5
  v_accvgpr_write_b32 a30, v6
  v_accvgpr_write_b32 a31, v7
  v_accvgpr_read_b32 v4, a48
  v_accvgpr_read_b32 v5, a49
  v_accvgpr_read_b32 v6, a50
  v_accvgpr_read_b32 v7, a51
  s_nop 0
  v_mul_f32 v4, v4, v76
  v_mul_f32 v5, v5, v76
  v_mul_f32 v6, v6, v76
  v_mul_f32 v7, v7, v76
  s_nop 0
  v_accvgpr_write_b32 a48, v4
  v_accvgpr_write_b32 a49, v5
  v_accvgpr_write_b32 a50, v6
  v_accvgpr_write_b32 a51, v7
  v_accvgpr_read_b32 v4, a68
  v_accvgpr_read_b32 v5, a69
  v_accvgpr_read_b32 v6, a70
  v_accvgpr_read_b32 v7, a71
  s_nop 0
  v_mul_f32 v4, v4, v76
  v_mul_f32 v5, v5, v76
  v_mul_f32 v6, v6, v76
  v_mul_f32 v7, v7, v76
  s_nop 0
  v_accvgpr_write_b32 a68, v4
  v_accvgpr_write_b32 a69, v5
  v_accvgpr_write_b32 a70, v6
  v_accvgpr_write_b32 a71, v7
  v_accvgpr_read_b32 v4, a88
  v_accvgpr_read_b32 v5, a89
  v_accvgpr_read_b32 v6, a90
  v_accvgpr_read_b32 v7, a91
  s_nop 0
  v_mul_f32 v4, v4, v76
  v_mul_f32 v5, v5, v76
  v_mul_f32 v6, v6, v76
  v_mul_f32 v7, v7, v76
  s_nop 0
  v_accvgpr_write_b32 a88, v4
  v_accvgpr_write_b32 a89, v5
  v_accvgpr_write_b32 a90, v6
  v_accvgpr_write_b32 a91, v7
  v_mov_b32 v76, 1.0
  s_nop 0
  v_accvgpr_write_b32 a106, v76
  v_accvgpr_read_b32 v76, a107
  v_accvgpr_read_b32 v4, a12
  v_accvgpr_read_b32 v5, a13
  v_accvgpr_read_b32 v6, a14
  v_accvgpr_read_b32 v7, a15
  s_nop 0
  v_mul_f32 v4, v4, v76
  v_mul_f32 v5, v5, v76
  v_mul_f32 v6, v6, v76
  v_mul_f32 v7, v7, v76
  s_nop 0
  v_accvgpr_write_b32 a12, v4
  v_accvgpr_write_b32 a13, v5
  v_accvgpr_write_b32 a14, v6
  v_accvgpr_write_b32 a15, v7
  v_accvgpr_read_b32 v4, a32
  v_accvgpr_read_b32 v5, a33
  v_accvgpr_read_b32 v6, a34
  v_accvgpr_read_b32 v7, a35
  s_nop 0
  v_mul_f32 v4, v4, v76
  v_mul_f32 v5, v5, v76
  v_mul_f32 v6, v6, v76
  v_mul_f32 v7, v7, v76
  s_nop 0
  v_accvgpr_write_b32 a32, v4
  v_accvgpr_write_b32 a33, v5
  v_accvgpr_write_b32 a34, v6
  v_accvgpr_write_b32 a35, v7
  v_accvgpr_read_b32 v4, a52
  v_accvgpr_read_b32 v5, a53
  v_accvgpr_read_b32 v6, a54
  v_accvgpr_read_b32 v7, a55
  s_nop 0
  v_mul_f32 v4, v4, v76
  v_mul_f32 v5, v5, v76
  v_mul_f32 v6, v6, v76
  v_mul_f32 v7, v7, v76
  s_nop 0
  v_accvgpr_write_b32 a52, v4
  v_accvgpr_write_b32 a53, v5
  v_accvgpr_write_b32 a54, v6
  v_accvgpr_write_b32 a55, v7
  v_accvgpr_read_b32 v4, a72
  v_accvgpr_read_b32 v5, a73
  v_accvgpr_read_b32 v6, a74
  v_accvgpr_read_b32 v7, a75
  s_nop 0
  v_mul_f32 v4, v4, v76
  v_mul_f32 v5, v5, v76
  v_mul_f32 v6, v6, v76
  v_mul_f32 v7, v7, v76
  s_nop 0
  v_accvgpr_write_b32 a72, v4
  v_accvgpr_write_b32 a73, v5
  v_accvgpr_write_b32 a74, v6
  v_accvgpr_write_b32 a75, v7
  v_accvgpr_read_b32 v4, a92
  v_accvgpr_read_b32 v5, a93
  v_accvgpr_read_b32 v6, a94
  v_accvgpr_read_b32 v7, a95
  s_nop 0
  v_mul_f32 v4, v4, v76
  v_mul_f32 v5, v5, v76
  v_mul_f32 v6, v6, v76
  v_mul_f32 v7, v7, v76
  s_nop 0
  v_accvgpr_write_b32 a92, v4
  v_accvgpr_write_b32 a93, v5
  v_accvgpr_write_b32 a94, v6
  v_accvgpr_write_b32 a95, v7
  v_mov_b32 v76, 1.0
  s_nop 0
  v_accvgpr_write_b32 a107, v76
  v_accvgpr_read_b32 v76, a108
  v_accvgpr_read_b32 v4, a16
  v_accvgpr_read_b32 v5, a17
  v_accvgpr_read_b32 v6, a18
  v_accvgpr_read_b32 v7, a19
  s_nop 0
  v_mul_f32 v4, v4, v76
  v_mul_f32 v5, v5, v76
  v_mul_f32 v6, v6, v76
  v_mul_f32 v7, v7, v76
  s_nop 0
  v_accvgpr_write_b32 a16, v4
  v_accvgpr_write_b32 a17, v5
  v_accvgpr_write_b32 a18, v6
  v_accvgpr_write_b32 a19, v7
  v_accvgpr_read_b32 v4, a36
  v_accvgpr_read_b32 v5, a37
  v_accvgpr_read_b32 v6, a38
  v_accvgpr_read_b32 v7, a39
  s_nop 0
  v_mul_f32 v4, v4, v76
  v_mul_f32 v5, v5, v76
  v_mul_f32 v6, v6, v76
  v_mul_f32 v7, v7, v76
  s_nop 0
  v_accvgpr_write_b32 a36, v4
  v_accvgpr_write_b32 a37, v5
  v_accvgpr_write_b32 a38, v6
  v_accvgpr_write_b32 a39, v7
  v_accvgpr_read_b32 v4, a56
  v_accvgpr_read_b32 v5, a57
  v_accvgpr_read_b32 v6, a58
  v_accvgpr_read_b32 v7, a59
  s_nop 0
  v_mul_f32 v4, v4, v76
  v_mul_f32 v5, v5, v76
  v_mul_f32 v6, v6, v76
  v_mul_f32 v7, v7, v76
  s_nop 0
  v_accvgpr_write_b32 a56, v4
  v_accvgpr_write_b32 a57, v5
  v_accvgpr_write_b32 a58, v6
  v_accvgpr_write_b32 a59, v7
  v_accvgpr_read_b32 v4, a76
  v_accvgpr_read_b32 v5, a77
  v_accvgpr_read_b32 v6, a78
  v_accvgpr_read_b32 v7, a79
  s_nop 0
  v_mul_f32 v4, v4, v76
  v_mul_f32 v5, v5, v76
  v_mul_f32 v6, v6, v76
  v_mul_f32 v7, v7, v76
  s_nop 0
  v_accvgpr_write_b32 a76, v4
  v_accvgpr_write_b32 a77, v5
  v_accvgpr_write_b32 a78, v6
  v_accvgpr_write_b32 a79, v7
  v_accvgpr_read_b32 v4, a96
  v_accvgpr_read_b32 v5, a97
  v_accvgpr_read_b32 v6, a98
  v_accvgpr_read_b32 v7, a99
  s_nop 0
  v_mul_f32 v4, v4, v76
  v_mul_f32 v5, v5, v76
  v_mul_f32 v6, v6, v76
  v_mul_f32 v7, v7, v76
  s_nop 0
  v_accvgpr_write_b32 a96, v4
  v_accvgpr_write_b32 a97, v5
  v_accvgpr_write_b32 a98, v6
  v_accvgpr_write_b32 a99, v7
  v_mov_b32 v76, 1.0
  s_nop 0
  v_accvgpr_write_b32 a108, v76
  s_mov_b32 s47, 0
  s_nop 3
  s_branch BO_q14
RP_q140:
  v_cmp_lt_f32 vcc, s48, v77
  s_nop 1
  v_cndmask_b32 v76, v88, v76, vcc
  v_sub_f32 v77, v88, v76
  v_exp_f32 v77, v77
  v_mov_b32 v88, v76
  v_accvgpr_read_b32 v78, a104
  s_nop 0
  v_mul_f32 v77, v77, v78
  s_nop 0
  v_accvgpr_write_b32 a104, v77
  v_cmp_lt_f32 vcc, s48, v81
  s_nop 1
  v_cndmask_b32 v80, v89, v80, vcc
  v_sub_f32 v81, v89, v80
  v_exp_f32 v81, v81
  v_mov_b32 v89, v80
  v_accvgpr_read_b32 v82, a105
  s_nop 0
  v_mul_f32 v81, v81, v82
  s_nop 0
  v_accvgpr_write_b32 a105, v81
  v_cmp_lt_f32 vcc, s48, v85
  s_nop 1
  v_cndmask_b32 v84, v90, v84, vcc
  v_sub_f32 v85, v90, v84
  v_exp_f32 v85, v85
  v_mov_b32 v90, v84
  v_accvgpr_read_b32 v86, a106
  s_nop 0
  v_mul_f32 v85, v85, v86
  s_nop 0
  v_accvgpr_write_b32 a106, v85
  s_mov_b32 s47, 1
  s_nop 1
  s_branch BP_q140
RP_q141:
  v_cmp_lt_f32 vcc, s48, v77
  s_nop 1
  v_cndmask_b32 v76, v91, v76, vcc
  v_sub_f32 v77, v91, v76
  v_exp_f32 v77, v77
  v_mov_b32 v91, v76
  v_accvgpr_read_b32 v78, a107
  s_nop 0
  v_mul_f32 v77, v77, v78
  s_nop 0
  v_accvgpr_write_b32 a107, v77
  v_cmp_lt_f32 vcc, s48, v81
  s_nop 1
  v_cndmask_b32 v80, v92, v80, vcc
  v_sub_f32 v81, v92, v80
  v_exp_f32 v81, v81
  v_mov_b32 v92, v80
  v_accvgpr_read_b32 v82, a108
  s_nop 0
  v_mul_f32 v81, v81, v82
  s_nop 0
  v_accvgpr_write_b32 a108, v81
  s_mov_b32 s47, 1
  s_nop 1
  s_branch BP_q141
RO_q15:
  s_nop 15
  v_accvgpr_read_b32 v76, a104
  v_accvgpr_read_b32 v4, a0
  v_accvgpr_read_b32 v5, a1
  v_accvgpr_read_b32 v6, a2
  v_accvgpr_read_b32 v7, a3
  s_nop 0
  v_mul_f32 v4, v4, v76
  v_mul_f32 v5, v5, v76
  v_mul_f32 v6, v6, v76
  v_mul_f32 v7, v7, v76
  s_nop 0
  v_accvgpr_write_b32 a0, v4
  v_accvgpr_write_b32 a1, v5
  v_accvgpr_write_b32 a2, v6
  v_accvgpr_write_b32 a3, v7
  v_accvgpr_read_b32 v4, a20
  v_accvgpr_read_b32 v5, a21
  v_accvgpr_read_b32 v6, a22
  v_accvgpr_read_b32 v7, a23
  s_nop 0
  v_mul_f32 v4, v4, v76
  v_mul_f32 v5, v5, v76
  v_mul_f32 v6, v6, v76
  v_mul_f32 v7, v7, v76
  s_nop 0
  v_accvgpr_write_b32 a20, v4
  v_accvgpr_write_b32 a21, v5
  v_accvgpr_write_b32 a22, v6
  v_accvgpr_write_b32 a23, v7
  v_accvgpr_read_b32 v4, a40
  v_accvgpr_read_b32 v5, a41
  v_accvgpr_read_b32 v6, a42
  v_accvgpr_read_b32 v7, a43
  s_nop 0
  v_mul_f32 v4, v4, v76
  v_mul_f32 v5, v5, v76
  v_mul_f32 v6, v6, v76
  v_mul_f32 v7, v7, v76
  s_nop 0
  v_accvgpr_write_b32 a40, v4
  v_accvgpr_write_b32 a41, v5
  v_accvgpr_write_b32 a42, v6
  v_accvgpr_write_b32 a43, v7
  v_accvgpr_read_b32 v4, a60
  v_accvgpr_read_b32 v5, a61
  v_accvgpr_read_b32 v6, a62
  v_accvgpr_read_b32 v7, a63
  s_nop 0
  v_mul_f32 v4, v4, v76
  v_mul_f32 v5, v5, v76
  v_mul_f32 v6, v6, v76
  v_mul_f32 v7, v7, v76
  s_nop 0
  v_accvgpr_write_b32 a60, v4
  v_accvgpr_write_b32 a61, v5
  v_accvgpr_write_b32 a62, v6
  v_accvgpr_write_b32 a63, v7
  v_accvgpr_read_b32 v4, a80
  v_accvgpr_read_b32 v5, a81
  v_accvgpr_read_b32 v6, a82
  v_accvgpr_read_b32 v7, a83
  s_nop 0
  v_mul_f32 v4, v4, v76
  v_mul_f32 v5, v5, v76
  v_mul_f32 v6, v6, v76
  v_mul_f32 v7, v7, v76
  s_nop 0
  v_accvgpr_write_b32 a80, v4
  v_accvgpr_write_b32 a81, v5
  v_accvgpr_write_b32 a82, v6
  v_accvgpr_write_b32 a83, v7
  v_mov_b32 v76, 1.0
  s_nop 0
  v_accvgpr_write_b32 a104, v76
  v_accvgpr_read_b32 v76, a105
  v_accvgpr_read_b32 v4, a4
  v_accvgpr_read_b32 v5, a5
  v_accvgpr_read_b32 v6, a6
  v_accvgpr_read_b32 v7, a7
  s_nop 0
  v_mul_f32 v4, v4, v76
  v_mul_f32 v5, v5, v76
  v_mul_f32 v6, v6, v76
  v_mul_f32 v7, v7, v76
  s_nop 0
  v_accvgpr_write_b32 a4, v4
  v_accvgpr_write_b32 a5, v5
  v_accvgpr_write_b32 a6, v6
  v_accvgpr_write_b32 a7, v7
  v_accvgpr_read_b32 v4, a24
  v_accvgpr_read_b32 v5, a25
  v_accvgpr_read_b32 v6, a26
  v_accvgpr_read_b32 v7, a27
  s_nop 0
  v_mul_f32 v4, v4, v76
  v_mul_f32 v5, v5, v76
  v_mul_f32 v6, v6, v76
  v_mul_f32 v7, v7, v76
  s_nop 0
  v_accvgpr_write_b32 a24, v4
  v_accvgpr_write_b32 a25, v5
  v_accvgpr_write_b32 a26, v6
  v_accvgpr_write_b32 a27, v7
  v_accvgpr_read_b32 v4, a44
  v_accvgpr_read_b32 v5, a45
  v_accvgpr_read_b32 v6, a46
  v_accvgpr_read_b32 v7, a47
  s_nop 0
  v_mul_f32 v4, v4, v76
  v_mul_f32 v5, v5, v76
  v_mul_f32 v6, v6, v76
  v_mul_f32 v7, v7, v76
  s_nop 0
  v_accvgpr_write_b32 a44, v4
  v_accvgpr_write_b32 a45, v5
  v_accvgpr_write_b32 a46, v6
  v_accvgpr_write_b32 a47, v7
  v_accvgpr_read_b32 v4, a64
  v_accvgpr_read_b32 v5, a65
  v_accvgpr_read_b32 v6, a66
  v_accvgpr_read_b32 v7, a67
  s_nop 0
  v_mul_f32 v4, v4, v76
  v_mul_f32 v5, v5, v76
  v_mul_f32 v6, v6, v76
  v_mul_f32 v7, v7, v76
  s_nop 0
  v_accvgpr_write_b32 a64, v4
  v_accvgpr_write_b32 a65, v5
  v_accvgpr_write_b32 a66, v6
  v_accvgpr_write_b32 a67, v7
  v_accvgpr_read_b32 v4, a84
  v_accvgpr_read_b32 v5, a85
  v_accvgpr_read_b32 v6, a86
  v_accvgpr_read_b32 v7, a87
  s_nop 0
  v_mul_f32 v4, v4, v76
  v_mul_f32 v5, v5, v76
  v_mul_f32 v6, v6, v76
  v_mul_f32 v7, v7, v76
  s_nop 0
  v_accvgpr_write_b32 a84, v4
  v_accvgpr_write_b32 a85, v5
  v_accvgpr_write_b32 a86, v6
  v_accvgpr_write_b32 a87, v7
  v_mov_b32 v76, 1.0
  s_nop 0
  v_accvgpr_write_b32 a105, v76
  v_accvgpr_read_b32 v76, a106
  v_accvgpr_read_b32 v4, a8
  v_accvgpr_read_b32 v5, a9
  v_accvgpr_read_b32 v6, a10
  v_accvgpr_read_b32 v7, a11
  s_nop 0
  v_mul_f32 v4, v4, v76
  v_mul_f32 v5, v5, v76
  v_mul_f32 v6, v6, v76
  v_mul_f32 v7, v7, v76
  s_nop 0
  v_accvgpr_write_b32 a8, v4
  v_accvgpr_write_b32 a9, v5
  v_accvgpr_write_b32 a10, v6
  v_accvgpr_write_b32 a11, v7
  v_accvgpr_read_b32 v4, a28
  v_accvgpr_read_b32 v5, a29
  v_accvgpr_read_b32 v6, a30
  v_accvgpr_read_b32 v7, a31
  s_nop 0
  v_mul_f32 v4, v4, v76
  v_mul_f32 v5, v5, v76
  v_mul_f32 v6, v6, v76
  v_mul_f32 v7, v7, v76
  s_nop 0
  v_accvgpr_write_b32 a28, v4
  v_accvgpr_write_b32 a29, v5
  v_accvgpr_write_b32 a30, v6
  v_accvgpr_write_b32 a31, v7
  v_accvgpr_read_b32 v4, a48
  v_accvgpr_read_b32 v5, a49
  v_accvgpr_read_b32 v6, a50
  v_accvgpr_read_b32 v7, a51
  s_nop 0
  v_mul_f32 v4, v4, v76
  v_mul_f32 v5, v5, v76
  v_mul_f32 v6, v6, v76
  v_mul_f32 v7, v7, v76
  s_nop 0
  v_accvgpr_write_b32 a48, v4
  v_accvgpr_write_b32 a49, v5
  v_accvgpr_write_b32 a50, v6
  v_accvgpr_write_b32 a51, v7
  v_accvgpr_read_b32 v4, a68
  v_accvgpr_read_b32 v5, a69
  v_accvgpr_read_b32 v6, a70
  v_accvgpr_read_b32 v7, a71
  s_nop 0
  v_mul_f32 v4, v4, v76
  v_mul_f32 v5, v5, v76
  v_mul_f32 v6, v6, v76
  v_mul_f32 v7, v7, v76
  s_nop 0
  v_accvgpr_write_b32 a68, v4
  v_accvgpr_write_b32 a69, v5
  v_accvgpr_write_b32 a70, v6
  v_accvgpr_write_b32 a71, v7
  v_accvgpr_read_b32 v4, a88
  v_accvgpr_read_b32 v5, a89
  v_accvgpr_read_b32 v6, a90
  v_accvgpr_read_b32 v7, a91
  s_nop 0
  v_mul_f32 v4, v4, v76
  v_mul_f32 v5, v5, v76
  v_mul_f32 v6, v6, v76
  v_mul_f32 v7, v7, v76
  s_nop 0
  v_accvgpr_write_b32 a88, v4
  v_accvgpr_write_b32 a89, v5
  v_accvgpr_write_b32 a90, v6
  v_accvgpr_write_b32 a91, v7
  v_mov_b32 v76, 1.0
  s_nop 0
  v_accvgpr_write_b32 a106, v76
  v_accvgpr_read_b32 v76, a107
  v_accvgpr_read_b32 v4, a12
  v_accvgpr_read_b32 v5, a13
  v_accvgpr_read_b32 v6, a14
  v_accvgpr_read_b32 v7, a15
  s_nop 0
  v_mul_f32 v4, v4, v76
  v_mul_f32 v5, v5, v76
  v_mul_f32 v6, v6, v76
  v_mul_f32 v7, v7, v76
  s_nop 0
  v_accvgpr_write_b32 a12, v4
  v_accvgpr_write_b32 a13, v5
  v_accvgpr_write_b32 a14, v6
  v_accvgpr_write_b32 a15, v7
  v_accvgpr_read_b32 v4, a32
  v_accvgpr_read_b32 v5, a33
  v_accvgpr_read_b32 v6, a34
  v_accvgpr_read_b32 v7, a35
  s_nop 0
  v_mul_f32 v4, v4, v76
  v_mul_f32 v5, v5, v76
  v_mul_f32 v6, v6, v76
  v_mul_f32 v7, v7, v76
  s_nop 0
  v_accvgpr_write_b32 a32, v4
  v_accvgpr_write_b32 a33, v5
  v_accvgpr_write_b32 a34, v6
  v_accvgpr_write_b32 a35, v7
  v_accvgpr_read_b32 v4, a52
  v_accvgpr_read_b32 v5, a53
  v_accvgpr_read_b32 v6, a54
  v_accvgpr_read_b32 v7, a55
  s_nop 0
  v_mul_f32 v4, v4, v76
  v_mul_f32 v5, v5, v76
  v_mul_f32 v6, v6, v76
  v_mul_f32 v7, v7, v76
  s_nop 0
  v_accvgpr_write_b32 a52, v4
  v_accvgpr_write_b32 a53, v5
  v_accvgpr_write_b32 a54, v6
  v_accvgpr_write_b32 a55, v7
  v_accvgpr_read_b32 v4, a72
  v_accvgpr_read_b32 v5, a73
  v_accvgpr_read_b32 v6, a74
  v_accvgpr_read_b32 v7, a75
  s_nop 0
  v_mul_f32 v4, v4, v76
  v_mul_f32 v5, v5, v76
  v_mul_f32 v6, v6, v76
  v_mul_f32 v7, v7, v76
  s_nop 0
  v_accvgpr_write_b32 a72, v4
  v_accvgpr_write_b32 a73, v5
  v_accvgpr_write_b32 a74, v6
  v_accvgpr_write_b32 a75, v7
  v_accvgpr_read_b32 v4, a92
  v_accvgpr_read_b32 v5, a93
  v_accvgpr_read_b32 v6, a94
  v_accvgpr_read_b32 v7, a95
  s_nop 0
  v_mul_f32 v4, v4, v76
  v_mul_f32 v5, v5, v76
  v_mul_f32 v6, v6, v76
  v_mul_f32 v7, v7, v76
  s_nop 0
  v_accvgpr_write_b32 a92, v4
  v_accvgpr_write_b32 a93, v5
  v_accvgpr_write_b32 a94, v6
  v_accvgpr_write_b32 a95, v7
  v_mov_b32 v76, 1.0
  s_nop 0
  v_accvgpr_write_b32 a107, v76
  v_accvgpr_read_b32 v76, a108
  v_accvgpr_read_b32 v4, a16
  v_accvgpr_read_b32 v5, a17
  v_accvgpr_read_b32 v6, a18
  v_accvgpr_read_b32 v7, a19
  s_nop 0
  v_mul_f32 v4, v4, v76
  v_mul_f32 v5, v5, v76
  v_mul_f32 v6, v6, v76
  v_mul_f32 v7, v7, v76
  s_nop 0
  v_accvgpr_write_b32 a16, v4
  v_accvgpr_write_b32 a17, v5
  v_accvgpr_write_b32 a18, v6
  v_accvgpr_write_b32 a19, v7
  v_accvgpr_read_b32 v4, a36
  v_accvgpr_read_b32 v5, a37
  v_accvgpr_read_b32 v6, a38
  v_accvgpr_read_b32 v7, a39
  s_nop 0
  v_mul_f32 v4, v4, v76
  v_mul_f32 v5, v5, v76
  v_mul_f32 v6, v6, v76
  v_mul_f32 v7, v7, v76
  s_nop 0
  v_accvgpr_write_b32 a36, v4
  v_accvgpr_write_b32 a37, v5
  v_accvgpr_write_b32 a38, v6
  v_accvgpr_write_b32 a39, v7
  v_accvgpr_read_b32 v4, a56
  v_accvgpr_read_b32 v5, a57
  v_accvgpr_read_b32 v6, a58
  v_accvgpr_read_b32 v7, a59
  s_nop 0
  v_mul_f32 v4, v4, v76
  v_mul_f32 v5, v5, v76
  v_mul_f32 v6, v6, v76
  v_mul_f32 v7, v7, v76
  s_nop 0
  v_accvgpr_write_b32 a56, v4
  v_accvgpr_write_b32 a57, v5
  v_accvgpr_write_b32 a58, v6
  v_accvgpr_write_b32 a59, v7
  v_accvgpr_read_b32 v4, a76
  v_accvgpr_read_b32 v5, a77
  v_accvgpr_read_b32 v6, a78
  v_accvgpr_read_b32 v7, a79
  s_nop 0
  v_mul_f32 v4, v4, v76
  v_mul_f32 v5, v5, v76
  v_mul_f32 v6, v6, v76
  v_mul_f32 v7, v7, v76
  s_nop 0
  v_accvgpr_write_b32 a76, v4
  v_accvgpr_write_b32 a77, v5
  v_accvgpr_write_b32 a78, v6
  v_accvgpr_write_b32 a79, v7
  v_accvgpr_read_b32 v4, a96
  v_accvgpr_read_b32 v5, a97
  v_accvgpr_read_b32 v6, a98
  v_accvgpr_read_b32 v7, a99
  s_nop 0
  v_mul_f32 v4, v4, v76
  v_mul_f32 v5, v5, v76
  v_mul_f32 v6, v6, v76
  v_mul_f32 v7, v7, v76
  s_nop 0
  v_accvgpr_write_b32 a96, v4
  v_accvgpr_write_b32 a97, v5
  v_accvgpr_write_b32 a98, v6
  v_accvgpr_write_b32 a99, v7
  v_mov_b32 v76, 1.0
  s_nop 0
  v_accvgpr_write_b32 a108, v76
  s_mov_b32 s47, 0
  s_nop 3
  s_branch BO_q15

.globl gqa_reduce_kernel
.p2align 8
.type gqa_reduce_kernel,@function
gqa_reduce_kernel:
  s_cmp_ge_u32 s2, 252
  s_cbranch_scc1 L_REND
  s_load_dwordx2 s[4:5], s[0:1], 40
  s_load_dwordx2 s[6:7], s[0:1], 56
  s_lshl_b32 s3, s2, 8
  v_add_u32 v1, s3, v0
  v_lshlrev_b32 v2, 4, v1
  s_mov_b32 s17, 0xffff0000
  s_waitcnt lgkmcnt(0)
  s_mov_b32 s8, s6
  s_mov_b32 s9, s7
  s_mov_b32 s10, 16515072
  s_mov_b32 s11, 0x00020000
  s_mov_b32 s12, s4
  s_mov_b32 s13, s5
  s_mov_b32 s14, 1032192
  s_mov_b32 s15, 0x00020000
  s_mov_b32 s16, 0
  buffer_load_dwordx4 v[16:19], v2, s[8:11], s16 offen
  s_add_u32 s16, s16, 1032192
  buffer_load_dwordx4 v[20:23], v2, s[8:11], s16 offen
  s_add_u32 s16, s16, 1032192
  buffer_load_dwordx4 v[24:27], v2, s[8:11], s16 offen
  s_add_u32 s16, s16, 1032192
  buffer_load_dwordx4 v[28:31], v2, s[8:11], s16 offen
  s_add_u32 s16, s16, 1032192
  buffer_load_dwordx4 v[32:35], v2, s[8:11], s16 offen
  s_add_u32 s16, s16, 1032192
  buffer_load_dwordx4 v[36:39], v2, s[8:11], s16 offen
  s_add_u32 s16, s16, 1032192
  buffer_load_dwordx4 v[40:43], v2, s[8:11], s16 offen
  s_add_u32 s16, s16, 1032192
  buffer_load_dwordx4 v[44:47], v2, s[8:11], s16 offen
  s_add_u32 s16, s16, 1032192
  buffer_load_dwordx4 v[48:51], v2, s[8:11], s16 offen
  s_add_u32 s16, s16, 1032192
  buffer_load_dwordx4 v[52:55], v2, s[8:11], s16 offen
  s_add_u32 s16, s16, 1032192
  buffer_load_dwordx4 v[56:59], v2, s[8:11], s16 offen
  s_add_u32 s16, s16, 1032192
  buffer_load_dwordx4 v[60:63], v2, s[8:11], s16 offen
  s_add_u32 s16, s16, 1032192
  buffer_load_dwordx4 v[64:67], v2, s[8:11], s16 offen
  s_add_u32 s16, s16, 1032192
  buffer_load_dwordx4 v[68:71], v2, s[8:11], s16 offen
  s_add_u32 s16, s16, 1032192
  buffer_load_dwordx4 v[72:75], v2, s[8:11], s16 offen
  s_add_u32 s16, s16, 1032192
  buffer_load_dwordx4 v[76:79], v2, s[8:11], s16 offen
  s_waitcnt vmcnt(15)
  v_lshlrev_b32 v4, 16, v16
  v_and_b32 v5, s17, v16
  v_lshlrev_b32 v6, 16, v17
  v_and_b32 v7, s17, v17
  v_lshlrev_b32 v8, 16, v18
  v_and_b32 v9, s17, v18
  v_lshlrev_b32 v10, 16, v19
  v_and_b32 v11, s17, v19
  s_waitcnt vmcnt(14)
  v_lshlrev_b32 v12, 16, v20
  v_and_b32 v13, s17, v20
  v_add_f32 v4, v4, v12
  v_add_f32 v5, v5, v13
  v_lshlrev_b32 v12, 16, v21
  v_and_b32 v13, s17, v21
  v_add_f32 v6, v6, v12
  v_add_f32 v7, v7, v13
  v_lshlrev_b32 v12, 16, v22
  v_and_b32 v13, s17, v22
  v_add_f32 v8, v8, v12
  v_add_f32 v9, v9, v13
  v_lshlrev_b32 v12, 16, v23
  v_and_b32 v13, s17, v23
  v_add_f32 v10, v10, v12
  v_add_f32 v11, v11, v13
  s_waitcnt vmcnt(13)
  v_lshlrev_b32 v12, 16, v24
  v_and_b32 v13, s17, v24
  v_add_f32 v4, v4, v12
  v_add_f32 v5, v5, v13
  v_lshlrev_b32 v12, 16, v25
  v_and_b32 v13, s17, v25
  v_add_f32 v6, v6, v12
  v_add_f32 v7, v7, v13
  v_lshlrev_b32 v12, 16, v26
  v_and_b32 v13, s17, v26
  v_add_f32 v8, v8, v12
  v_add_f32 v9, v9, v13
  v_lshlrev_b32 v12, 16, v27
  v_and_b32 v13, s17, v27
  v_add_f32 v10, v10, v12
  v_add_f32 v11, v11, v13
  s_waitcnt vmcnt(12)
  v_lshlrev_b32 v12, 16, v28
  v_and_b32 v13, s17, v28
  v_add_f32 v4, v4, v12
  v_add_f32 v5, v5, v13
  v_lshlrev_b32 v12, 16, v29
  v_and_b32 v13, s17, v29
  v_add_f32 v6, v6, v12
  v_add_f32 v7, v7, v13
  v_lshlrev_b32 v12, 16, v30
  v_and_b32 v13, s17, v30
  v_add_f32 v8, v8, v12
  v_add_f32 v9, v9, v13
  v_lshlrev_b32 v12, 16, v31
  v_and_b32 v13, s17, v31
  v_add_f32 v10, v10, v12
  v_add_f32 v11, v11, v13
  s_waitcnt vmcnt(11)
  v_lshlrev_b32 v12, 16, v32
  v_and_b32 v13, s17, v32
  v_add_f32 v4, v4, v12
  v_add_f32 v5, v5, v13
  v_lshlrev_b32 v12, 16, v33
  v_and_b32 v13, s17, v33
  v_add_f32 v6, v6, v12
  v_add_f32 v7, v7, v13
  v_lshlrev_b32 v12, 16, v34
  v_and_b32 v13, s17, v34
  v_add_f32 v8, v8, v12
  v_add_f32 v9, v9, v13
  v_lshlrev_b32 v12, 16, v35
  v_and_b32 v13, s17, v35
  v_add_f32 v10, v10, v12
  v_add_f32 v11, v11, v13
  s_waitcnt vmcnt(10)
  v_lshlrev_b32 v12, 16, v36
  v_and_b32 v13, s17, v36
  v_add_f32 v4, v4, v12
  v_add_f32 v5, v5, v13
  v_lshlrev_b32 v12, 16, v37
  v_and_b32 v13, s17, v37
  v_add_f32 v6, v6, v12
  v_add_f32 v7, v7, v13
  v_lshlrev_b32 v12, 16, v38
  v_and_b32 v13, s17, v38
  v_add_f32 v8, v8, v12
  v_add_f32 v9, v9, v13
  v_lshlrev_b32 v12, 16, v39
  v_and_b32 v13, s17, v39
  v_add_f32 v10, v10, v12
  v_add_f32 v11, v11, v13
  s_waitcnt vmcnt(9)
  v_lshlrev_b32 v12, 16, v40
  v_and_b32 v13, s17, v40
  v_add_f32 v4, v4, v12
  v_add_f32 v5, v5, v13
  v_lshlrev_b32 v12, 16, v41
  v_and_b32 v13, s17, v41
  v_add_f32 v6, v6, v12
  v_add_f32 v7, v7, v13
  v_lshlrev_b32 v12, 16, v42
  v_and_b32 v13, s17, v42
  v_add_f32 v8, v8, v12
  v_add_f32 v9, v9, v13
  v_lshlrev_b32 v12, 16, v43
  v_and_b32 v13, s17, v43
  v_add_f32 v10, v10, v12
  v_add_f32 v11, v11, v13
  s_waitcnt vmcnt(8)
  v_lshlrev_b32 v12, 16, v44
  v_and_b32 v13, s17, v44
  v_add_f32 v4, v4, v12
  v_add_f32 v5, v5, v13
  v_lshlrev_b32 v12, 16, v45
  v_and_b32 v13, s17, v45
  v_add_f32 v6, v6, v12
  v_add_f32 v7, v7, v13
  v_lshlrev_b32 v12, 16, v46
  v_and_b32 v13, s17, v46
  v_add_f32 v8, v8, v12
  v_add_f32 v9, v9, v13
  v_lshlrev_b32 v12, 16, v47
  v_and_b32 v13, s17, v47
  v_add_f32 v10, v10, v12
  v_add_f32 v11, v11, v13
  s_waitcnt vmcnt(7)
  v_lshlrev_b32 v12, 16, v48
  v_and_b32 v13, s17, v48
  v_add_f32 v4, v4, v12
  v_add_f32 v5, v5, v13
  v_lshlrev_b32 v12, 16, v49
  v_and_b32 v13, s17, v49
  v_add_f32 v6, v6, v12
  v_add_f32 v7, v7, v13
  v_lshlrev_b32 v12, 16, v50
  v_and_b32 v13, s17, v50
  v_add_f32 v8, v8, v12
  v_add_f32 v9, v9, v13
  v_lshlrev_b32 v12, 16, v51
  v_and_b32 v13, s17, v51
  v_add_f32 v10, v10, v12
  v_add_f32 v11, v11, v13
  s_waitcnt vmcnt(6)
  v_lshlrev_b32 v12, 16, v52
  v_and_b32 v13, s17, v52
  v_add_f32 v4, v4, v12
  v_add_f32 v5, v5, v13
  v_lshlrev_b32 v12, 16, v53
  v_and_b32 v13, s17, v53
  v_add_f32 v6, v6, v12
  v_add_f32 v7, v7, v13
  v_lshlrev_b32 v12, 16, v54
  v_and_b32 v13, s17, v54
  v_add_f32 v8, v8, v12
  v_add_f32 v9, v9, v13
  v_lshlrev_b32 v12, 16, v55
  v_and_b32 v13, s17, v55
  v_add_f32 v10, v10, v12
  v_add_f32 v11, v11, v13
  s_waitcnt vmcnt(5)
  v_lshlrev_b32 v12, 16, v56
  v_and_b32 v13, s17, v56
  v_add_f32 v4, v4, v12
  v_add_f32 v5, v5, v13
  v_lshlrev_b32 v12, 16, v57
  v_and_b32 v13, s17, v57
  v_add_f32 v6, v6, v12
  v_add_f32 v7, v7, v13
  v_lshlrev_b32 v12, 16, v58
  v_and_b32 v13, s17, v58
  v_add_f32 v8, v8, v12
  v_add_f32 v9, v9, v13
  v_lshlrev_b32 v12, 16, v59
  v_and_b32 v13, s17, v59
  v_add_f32 v10, v10, v12
  v_add_f32 v11, v11, v13
  s_waitcnt vmcnt(4)
  v_lshlrev_b32 v12, 16, v60
  v_and_b32 v13, s17, v60
  v_add_f32 v4, v4, v12
  v_add_f32 v5, v5, v13
  v_lshlrev_b32 v12, 16, v61
  v_and_b32 v13, s17, v61
  v_add_f32 v6, v6, v12
  v_add_f32 v7, v7, v13
  v_lshlrev_b32 v12, 16, v62
  v_and_b32 v13, s17, v62
  v_add_f32 v8, v8, v12
  v_add_f32 v9, v9, v13
  v_lshlrev_b32 v12, 16, v63
  v_and_b32 v13, s17, v63
  v_add_f32 v10, v10, v12
  v_add_f32 v11, v11, v13
  s_waitcnt vmcnt(3)
  v_lshlrev_b32 v12, 16, v64
  v_and_b32 v13, s17, v64
  v_add_f32 v4, v4, v12
  v_add_f32 v5, v5, v13
  v_lshlrev_b32 v12, 16, v65
  v_and_b32 v13, s17, v65
  v_add_f32 v6, v6, v12
  v_add_f32 v7, v7, v13
  v_lshlrev_b32 v12, 16, v66
  v_and_b32 v13, s17, v66
  v_add_f32 v8, v8, v12
  v_add_f32 v9, v9, v13
  v_lshlrev_b32 v12, 16, v67
  v_and_b32 v13, s17, v67
  v_add_f32 v10, v10, v12
  v_add_f32 v11, v11, v13
  s_waitcnt vmcnt(2)
  v_lshlrev_b32 v12, 16, v68
  v_and_b32 v13, s17, v68
  v_add_f32 v4, v4, v12
  v_add_f32 v5, v5, v13
  v_lshlrev_b32 v12, 16, v69
  v_and_b32 v13, s17, v69
  v_add_f32 v6, v6, v12
  v_add_f32 v7, v7, v13
  v_lshlrev_b32 v12, 16, v70
  v_and_b32 v13, s17, v70
  v_add_f32 v8, v8, v12
  v_add_f32 v9, v9, v13
  v_lshlrev_b32 v12, 16, v71
  v_and_b32 v13, s17, v71
  v_add_f32 v10, v10, v12
  v_add_f32 v11, v11, v13
  s_waitcnt vmcnt(1)
  v_lshlrev_b32 v12, 16, v72
  v_and_b32 v13, s17, v72
  v_add_f32 v4, v4, v12
  v_add_f32 v5, v5, v13
  v_lshlrev_b32 v12, 16, v73
  v_and_b32 v13, s17, v73
  v_add_f32 v6, v6, v12
  v_add_f32 v7, v7, v13
  v_lshlrev_b32 v12, 16, v74
  v_and_b32 v13, s17, v74
  v_add_f32 v8, v8, v12
  v_add_f32 v9, v9, v13
  v_lshlrev_b32 v12, 16, v75
  v_and_b32 v13, s17, v75
  v_add_f32 v10, v10, v12
  v_add_f32 v11, v11, v13
  s_waitcnt vmcnt(0)
  v_lshlrev_b32 v12, 16, v76
  v_and_b32 v13, s17, v76
  v_add_f32 v4, v4, v12
  v_add_f32 v5, v5, v13
  v_lshlrev_b32 v12, 16, v77
  v_and_b32 v13, s17, v77
  v_add_f32 v6, v6, v12
  v_add_f32 v7, v7, v13
  v_lshlrev_b32 v12, 16, v78
  v_and_b32 v13, s17, v78
  v_add_f32 v8, v8, v12
  v_add_f32 v9, v9, v13
  v_lshlrev_b32 v12, 16, v79
  v_and_b32 v13, s17, v79
  v_add_f32 v10, v10, v12
  v_add_f32 v11, v11, v13
  v_cvt_pk_bf16_f32 v84, v4, v5
  v_cvt_pk_bf16_f32 v85, v6, v7
  v_cvt_pk_bf16_f32 v86, v8, v9
  v_cvt_pk_bf16_f32 v87, v10, v11
  buffer_store_dwordx4 v[84:87], v2, s[12:15], 0 offen
L_REND:
  s_endpgm

.section .rodata,"a"
.p2align 6
.amdhsa_kernel gqa_attn_kernel
  .amdhsa_next_free_vgpr 256
  .amdhsa_next_free_sgpr 100
  .amdhsa_accum_offset 96
  .amdhsa_group_segment_fixed_size 0
  .amdhsa_kernarg_size 64
  .amdhsa_user_sgpr_count 2
  .amdhsa_user_sgpr_kernarg_segment_ptr 1
  .amdhsa_system_sgpr_workgroup_id_x 1
.end_amdhsa_kernel
.p2align 6
.amdhsa_kernel gqa_reduce_kernel
  .amdhsa_next_free_vgpr 88
  .amdhsa_next_free_sgpr 32
  .amdhsa_accum_offset 88
  .amdhsa_group_segment_fixed_size 0
  .amdhsa_kernarg_size 64
  .amdhsa_user_sgpr_count 2
  .amdhsa_user_sgpr_kernarg_segment_ptr 1
  .amdhsa_system_sgpr_workgroup_id_x 1
.end_amdhsa_kernel
```
